```python
import torch

def _softmax(x, axis=-1):
    return torch.softmax(x, dim=axis)
def _gelu(x):
    return torch.nn.functional.gelu(x, approximate="tanh")
def _silu(x):
    return torch.nn.functional.silu(x)
def _sigmoid(x):
    return torch.sigmoid(x)
def _layernorm(x, axis=-1, eps=1e-5):
    m = x.mean(dim=axis, keepdim=True)
    v = x.var(dim=axis, keepdim=True, unbiased=False)
    return (x - m) / torch.sqrt(v + eps)
def _scatter_add(tgt, idx, src, axis=0):
    return tgt.clone().index_add_(axis, idx, src)
def _segment_sum(src, seg, n):
    out = torch.zeros((n,) + src.shape[1:], dtype=src.dtype)
    return out.index_add_(0, seg, src)
def _pad(x, pw):
    flat = tuple(v for pair in reversed(pw) for v in pair)
    return torch.nn.functional.pad(x, flat)

kernel_name = 'concat_heads__gqa_block_cached__mha_block_cached__near_ridge'

def setup_inputs():

    _w = (lambda a: (lambda t: t.to(torch.bfloat16) if t.is_floating_point() else t)(torch.as_tensor(a)))
    def _A_setup():
        B, Sq, D = 16, 80, 448
        Hq, Hkv, Sk, Dh = 16, 8, 1024, 256
        assert Hq % Hkv == 0, (Hq, Hkv)
        return {
            "x": _w((lambda *s: torch.randn(*s, dtype=torch.bfloat16) * 0.8)(B, Sq, D)),
            "k_cache": _w((lambda *s: torch.randn(*s, dtype=torch.bfloat16) * 0.8)(B, Hkv, Sk, Dh)),
            "v_cache": _w((lambda *s: torch.randn(*s, dtype=torch.bfloat16) * 0.05)(B, Hkv, Sk, Dh)),
            "wq": _w((lambda *s: torch.randn(*s, dtype=torch.bfloat16) * 0.8)(D, Hq * Dh) * (D ** -0.5)),
            "wo": _w((lambda *s: torch.randn(*s, dtype=torch.bfloat16) * 0.05)(Hq * Dh, D) * ((Hq * Dh) ** -0.5)),
        }
    _A_in = _A_setup()

    def _B_setup():
        B, Sq, D = 16, 80, 448
        H, Sk, Dh = 16, 1024, 256
        return {
            "x": _w((lambda *s: torch.randn(*s, dtype=torch.bfloat16) * 0.8)(B, Sq, D)),
            "k_cache": _w((lambda *s: torch.randn(*s, dtype=torch.bfloat16) * 0.8)(B, H, Sk, Dh)),
            "v_cache": _w((lambda *s: torch.randn(*s, dtype=torch.bfloat16) * 0.05)(B, H, Sk, Dh)),
            "wq": _w((lambda *s: torch.randn(*s, dtype=torch.bfloat16) * 0.8)(D, H * Dh) * (D ** -0.5)),
            "wo": _w((lambda *s: torch.randn(*s, dtype=torch.bfloat16) * 0.05)(H * Dh, D) * ((H * Dh) ** -0.5)),
        }
    _B_in = _B_setup()

    return {
        "A_x": _A_in["x"],
        "A_k_cache": _A_in["k_cache"],
        "A_v_cache": _A_in["v_cache"],
        "A_wq": _A_in["wq"],
        "A_wo": _A_in["wo"],
        "B_x": _B_in["x"],
        "B_k_cache": _B_in["k_cache"],
        "B_v_cache": _B_in["v_cache"],
        "B_wq": _B_in["wq"],
        "B_wo": _B_in["wo"],
    }

def reference(A_x, A_k_cache, A_v_cache, A_wq, A_wo, B_x, B_k_cache, B_v_cache, B_wq, B_wo):
    def _A_ref(x, k_cache, v_cache, wq, wo):
        B, Sq, D = x.shape
        Hq, Dh = 16, 256
        Hkv = k_cache.shape[1]
        rep = Hq // Hkv
        q = (lambda x, *d: x.permute(*d))((x @ wq).reshape(B, Sq, Hq, Dh), 0, 2, 1, 3)
        k = (lambda x, n, axis: torch.repeat_interleave(x, n, dim=axis))(k_cache, rep, axis=1)
        v = (lambda x, n, axis: torch.repeat_interleave(x, n, dim=axis))(v_cache, rep, axis=1)
        scores = torch.einsum("bhqd,bhkd->bhqk", q, k) * (Dh ** -0.5)
        p = _softmax(scores, axis=-1)
        o = torch.einsum("bhqk,bhkd->bhqd", p, v)
        return (lambda x, *d: x.permute(*d))(o, 0, 2, 1, 3).reshape(B, Sq, Hq * Dh) @ wo

    def _B_ref(x, k_cache, v_cache, wq, wo):
        B, Sq, D = x.shape
        H, Dh = 16, 256
        q = (lambda x, *d: x.permute(*d))((x @ wq).reshape(B, Sq, H, Dh), 0, 2, 1, 3)
        scores = torch.einsum("bhqd,bhkd->bhqk", q, k_cache) * (Dh ** -0.5)
        p = _softmax(scores, axis=-1)
        o = torch.einsum("bhqk,bhkd->bhqd", p, v_cache)
        return (lambda x, *d: x.permute(*d))(o, 0, 2, 1, 3).reshape(B, Sq, H * Dh) @ wo

    a = _A_ref(A_x, A_k_cache, A_v_cache, A_wq, A_wo)
    b = _B_ref(B_x, B_k_cache, B_v_cache, B_wq, B_wo)
    return torch.concatenate([a, b], axis=-1)
```

```asm
; @launch kernel=attn_kernel grid=(256,1,1) block=(512,1,1) lds=163840
; @launch kernel=reduce_proj_kernel grid=(1280,1,1) block=(128,1,1) lds=0
.amdgcn_target "amdgcn-amd-amdhsa--gfx950"
.text
.globl attn_kernel
.p2align 8
.type attn_kernel,@function
attn_kernel:
  s_cmp_ge_u32 s2, 256
  s_cbranch_scc1 L_attn_kernel_done
  s_load_dwordx4 s[52:55], s[0:1], 0
  s_load_dwordx4 s[56:59], s[0:1], 16
  s_load_dwordx4 s[60:63], s[0:1], 40
  s_load_dwordx4 s[64:67], s[0:1], 56
  s_load_dwordx2 s[68:69], s[0:1], 96
  s_load_dwordx2 s[36:37], s[0:1], 32
  s_load_dwordx2 s[38:39], s[0:1], 72
  v_readfirstlane_b32 s16, v0
  v_and_b32 v255, 63, v0
  s_lshr_b32 s16, s16, 6
  s_lshr_b32 s19, s2, 3
  s_and_b32 s19, s19, 1
  s_lshr_b32 s70, s2, 4
  s_lshl_b32 s70, s70, 3
  s_and_b32 s49, s2, 7
  s_or_b32 s70, s70, s49
  s_lshr_b32 s71, s16, 2
  s_lshr_b32 s17, s16, 1
  s_and_b32 s17, s17, 1
  s_and_b32 s18, s16, 1
  s_lshl_b32 s72, s70, s19
  s_and_b32 s73, s17, s19
  s_add_u32 s72, s72, s73
  s_lshl_b32 s72, s72, 19
  s_lshl_b32 s29, s19, 8
  s_lshl_b32 s73, s70, 1
  s_add_u32 s29, s29, s73
  s_add_u32 s29, s29, s17
  s_lshl_b32 s48, s19, 7
  s_add_u32 s48, s48, s70
  s_mul_i32 s48, s48, 71680
  s_add_u32 s48, s48, 0x3000000
  s_mov_b32 s20, 0
  s_lshl_b32 s73, s17, 1
  s_add_u32 s73, s73, s18
  s_lshl_b32 s73, s73, 14
  s_lshl_b32 s76, s18, 15
  s_lshl_b32 s75, s17, 12
  s_add_u32 s75, s75, s76
  s_cmp_eq_u32 s19, 1
  s_cselect_b32 s76, s73, s76
  s_cselect_b32 s22, s73, s75
  s_lshl_b32 s73, s71, 16
  s_add_u32 s76, s76, s73
  s_add_u32 s22, s22, s73
  s_lshl_b32 s30, s16, 2
  s_add_u32 s30, s30, 151552
  s_mov_b32 s27, 0x3db8aa3b
  s_mov_b32 s28, 0x41000000
  s_mov_b32 s26, 0xff7fffff
  s_lshl_b32 s45, s16, 14
  s_lshl_b32 s44, s49, 10
  s_lshl_b32 s73, s16, 7
  s_add_u32 s44, s44, s73
  s_waitcnt lgkmcnt(0)
  s_cmp_eq_u32 s19, 1
  s_cselect_b64 s[52:53], s[60:61], s[52:53]
  s_cselect_b64 s[54:55], s[62:63], s[54:55]
  s_cselect_b64 s[56:57], s[64:65], s[56:57]
  s_cselect_b64 s[58:59], s[66:67], s[58:59]
  s_cmp_eq_u32 s71, 0
  s_cselect_b64 s[54:55], s[54:55], s[56:57]
  s_add_u32 s4, s54, s72
  s_addc_u32 s5, s55, 0
  s_mov_b32 s6, 0x80000
  s_mov_b32 s7, 0x20000
  s_mov_b32 s12, s68
  s_mov_b32 s13, s69
  s_mov_b32 s14, 0x20000000
  s_mov_b32 s15, 0x20000
  s_mov_b32 s8, s58
  s_mov_b32 s9, s59
  s_mov_b32 s10, 3670016
  s_mov_b32 s11, 0x20000
  s_lshr_b32 s51, s70, 3
  s_mul_i32 s73, s51, 71680
  s_add_u32 s40, s52, s73
  s_addc_u32 s41, s53, 0
  s_mov_b32 s42, 71680
  s_mov_b32 s43, 0x20000
  s_cmp_lg_u32 s71, 0
  s_cbranch_scc1 L_attn_kernel_pv
  s_setprio 3
  v_lshrrev_b32 v250, 4, v255
  v_and_b32 v251, 15, v255
  v_lshlrev_b32 v252, 1, v250
  v_xor_b32 v251, v251, v252
  v_lshlrev_b32 v250, 13, v250
  v_lshl_add_u32 v244, v251, 4, v250
  v_xor_b32 v245, 128, v244
  s_lshl_b32 s44, s49, 10
  s_lshl_b32 s46, s16, 8
  s_add_u32 s44, s44, s46
  s_lshl_b32 s45, s16, 15
  s_mul_i32 s46, s16, 20
  s_add_u32 s46, s46, 0
  v_lshrrev_b32 v250, 3, v255
  v_add_u32 v250, s46, v250
  v_bfe_u32 v251, v250, 1, 3
  v_and_b32 v252, 7, v255
  v_xor_b32 v251, v251, v252
  v_mul_u32_u24 v250, 896, v250
  v_lshl_add_u32 v246, v251, 4, v250
  s_mul_i32 s46, s16, 20
  s_add_u32 s46, s46, 8
  v_lshrrev_b32 v250, 3, v255
  v_add_u32 v250, s46, v250
  v_bfe_u32 v251, v250, 1, 3
  v_and_b32 v252, 7, v255
  v_xor_b32 v251, v251, v252
  v_mul_u32_u24 v250, 896, v250
  v_lshl_add_u32 v247, v251, 4, v250
  s_mul_i32 s46, s16, 20
  s_add_u32 s46, s46, 16
  v_lshrrev_b32 v250, 3, v255
  v_add_u32 v250, s46, v250
  v_bfe_u32 v251, v250, 1, 3
  v_and_b32 v252, 7, v255
  v_xor_b32 v251, v251, v252
  v_mul_u32_u24 v250, 896, v250
  v_lshl_add_u32 v248, v251, 4, v250
  s_mul_i32 s47, s16, 2560
  s_mov_b32 s46, 0
  s_add_u32 m0, s47, 131072
  s_nop 0
  buffer_load_dwordx4 v246, s[40:43], s46 offen lds
  s_add_u32 m0, s47, 132096
  s_nop 0
  buffer_load_dwordx4 v247, s[40:43], s46 offen lds
  s_add_u32 m0, s47, 133120
  s_mov_b32 exec_hi, 0
  buffer_load_dwordx4 v248, s[40:43], s46 offen lds
  s_mov_b32 exec_hi, -1
  s_add_u32 m0, s45, 0
  s_add_u32 s46, s44, 0
  buffer_load_dwordx4 v244, s[8:11], s46 offen lds
  s_add_u32 m0, s45, 1024
  s_add_u32 s46, s44, 32768
  buffer_load_dwordx4 v244, s[8:11], s46 offen lds
  s_add_u32 m0, s45, 2048
  s_add_u32 s46, s44, 65536
  buffer_load_dwordx4 v245, s[8:11], s46 offen lds
  s_add_u32 m0, s45, 3072
  s_add_u32 s46, s44, 98304
  buffer_load_dwordx4 v245, s[8:11], s46 offen lds
  s_add_u32 m0, s45, 4096
  s_add_u32 s46, s44, 131072
  buffer_load_dwordx4 v244, s[8:11], s46 offen lds
  s_add_u32 m0, s45, 5120
  s_add_u32 s46, s44, 163840
  buffer_load_dwordx4 v244, s[8:11], s46 offen lds
  s_add_u32 m0, s45, 6144
  s_add_u32 s46, s44, 196608
  buffer_load_dwordx4 v245, s[8:11], s46 offen lds
  s_add_u32 m0, s45, 7168
  s_add_u32 s46, s44, 229376
  buffer_load_dwordx4 v245, s[8:11], s46 offen lds
  s_add_u32 m0, s45, 16384
  s_add_u32 s46, s44, 262144
  buffer_load_dwordx4 v244, s[8:11], s46 offen lds
  s_add_u32 m0, s45, 17408
  s_add_u32 s46, s44, 294912
  buffer_load_dwordx4 v244, s[8:11], s46 offen lds
  s_add_u32 m0, s45, 18432
  s_add_u32 s46, s44, 327680
  buffer_load_dwordx4 v245, s[8:11], s46 offen lds
  s_add_u32 m0, s45, 19456
  s_add_u32 s46, s44, 360448
  buffer_load_dwordx4 v245, s[8:11], s46 offen lds
  s_add_u32 m0, s45, 20480
  s_add_u32 s46, s44, 393216
  buffer_load_dwordx4 v244, s[8:11], s46 offen lds
  s_add_u32 m0, s45, 21504
  s_add_u32 s46, s44, 425984
  buffer_load_dwordx4 v244, s[8:11], s46 offen lds
  s_add_u32 m0, s45, 22528
  s_add_u32 s46, s44, 458752
  buffer_load_dwordx4 v245, s[8:11], s46 offen lds
  s_add_u32 m0, s45, 23552
  s_add_u32 s46, s44, 491520
  buffer_load_dwordx4 v245, s[8:11], s46 offen lds
  s_mul_i32 s47, s16, 2560
  s_mov_b32 s46, 128
  s_add_u32 m0, s47, 141312
  s_nop 0
  buffer_load_dwordx4 v246, s[40:43], s46 offen lds
  s_add_u32 m0, s47, 142336
  s_nop 0
  buffer_load_dwordx4 v247, s[40:43], s46 offen lds
  s_add_u32 m0, s47, 143360
  s_mov_b32 exec_hi, 0
  buffer_load_dwordx4 v248, s[40:43], s46 offen lds
  s_mov_b32 exec_hi, -1
  s_add_u32 m0, s45, 8192
  s_add_u32 s46, s44, 524288
  buffer_load_dwordx4 v244, s[8:11], s46 offen lds
  s_add_u32 m0, s45, 9216
  s_add_u32 s46, s44, 557056
  buffer_load_dwordx4 v244, s[8:11], s46 offen lds
  s_add_u32 m0, s45, 10240
  s_add_u32 s46, s44, 589824
  buffer_load_dwordx4 v245, s[8:11], s46 offen lds
  s_add_u32 m0, s45, 11264
  s_add_u32 s46, s44, 622592
  buffer_load_dwordx4 v245, s[8:11], s46 offen lds
  s_add_u32 m0, s45, 12288
  s_add_u32 s46, s44, 655360
  buffer_load_dwordx4 v244, s[8:11], s46 offen lds
  s_add_u32 m0, s45, 13312
  s_add_u32 s46, s44, 688128
  buffer_load_dwordx4 v244, s[8:11], s46 offen lds
  s_add_u32 m0, s45, 14336
  s_add_u32 s46, s44, 720896
  buffer_load_dwordx4 v245, s[8:11], s46 offen lds
  s_add_u32 m0, s45, 15360
  s_add_u32 s46, s44, 753664
  buffer_load_dwordx4 v245, s[8:11], s46 offen lds
  s_mul_i32 s47, s16, 2560
  s_mov_b32 s46, 256
  s_add_u32 m0, s47, 151552
  s_nop 0
  buffer_load_dwordx4 v246, s[40:43], s46 offen lds
  s_add_u32 m0, s47, 152576
  s_nop 0
  buffer_load_dwordx4 v247, s[40:43], s46 offen lds
  s_add_u32 m0, s47, 153600
  s_mov_b32 exec_hi, 0
  buffer_load_dwordx4 v248, s[40:43], s46 offen lds
  s_mov_b32 exec_hi, -1
  s_add_u32 m0, s45, 24576
  s_add_u32 s46, s44, 786432
  buffer_load_dwordx4 v244, s[8:11], s46 offen lds
  s_add_u32 m0, s45, 25600
  s_add_u32 s46, s44, 819200
  buffer_load_dwordx4 v244, s[8:11], s46 offen lds
  s_add_u32 m0, s45, 26624
  s_add_u32 s46, s44, 851968
  buffer_load_dwordx4 v245, s[8:11], s46 offen lds
  s_add_u32 m0, s45, 27648
  s_add_u32 s46, s44, 884736
  buffer_load_dwordx4 v245, s[8:11], s46 offen lds
  s_add_u32 m0, s45, 28672
  s_add_u32 s46, s44, 917504
  buffer_load_dwordx4 v244, s[8:11], s46 offen lds
  s_add_u32 m0, s45, 29696
  s_add_u32 s46, s44, 950272
  buffer_load_dwordx4 v244, s[8:11], s46 offen lds
  s_add_u32 m0, s45, 30720
  s_add_u32 s46, s44, 983040
  buffer_load_dwordx4 v245, s[8:11], s46 offen lds
  s_add_u32 m0, s45, 31744
  s_add_u32 s46, s44, 1015808
  buffer_load_dwordx4 v245, s[8:11], s46 offen lds
  v_and_b32 v226, 15, v255
  v_lshrrev_b32 v227, 4, v255
  v_lshrrev_b32 v228, 5, v255
  v_and_b32 v229, 31, v255
  v_xor_b32 v229, v229, v228
  v_lshlrev_b32 v229, 4, v229
  v_lshl_add_u32 v229, v228, 9, v229
  s_lshl_b32 s73, s18, 13
  v_add_u32 v229, s73, v229
  s_lshl_b32 s73, s17, 7
  s_cmp_eq_u32 s19, 1
  s_cselect_b32 s73, 0, s73
  v_xor_b32 v221, s73, v229
  v_lshlrev_b32 v229, 9, v226
  v_add_u32 v229, s76, v229
  v_add_u32 v217, 0, v227
  v_xor_b32 v217, v217, v226
  v_lshl_add_u32 v217, v217, 4, v229
  v_add_u32 v218, 4, v227
  v_xor_b32 v218, v218, v226
  v_lshl_add_u32 v218, v218, 4, v229
  v_add_u32 v219, 8, v227
  v_xor_b32 v219, v219, v226
  v_lshl_add_u32 v219, v219, 4, v229
  v_add_u32 v220, 12, v227
  v_xor_b32 v220, v220, v226
  v_lshl_add_u32 v220, v220, 4, v229
  s_waitcnt vmcnt(30)
  s_barrier
  s_waitcnt vmcnt(22)
  s_barrier
  s_add_u32 m0, s45, 0
  s_add_u32 s46, s44, 1048576
  buffer_load_dwordx4 v244, s[8:11], s46 offen lds
  s_add_u32 m0, s45, 1024
  s_add_u32 s46, s44, 1081344
  buffer_load_dwordx4 v244, s[8:11], s46 offen lds
  s_add_u32 m0, s45, 2048
  s_add_u32 s46, s44, 1114112
  buffer_load_dwordx4 v245, s[8:11], s46 offen lds
  s_add_u32 m0, s45, 3072
  s_add_u32 s46, s44, 1146880
  buffer_load_dwordx4 v245, s[8:11], s46 offen lds
  s_add_u32 m0, s45, 4096
  s_add_u32 s46, s44, 1179648
  buffer_load_dwordx4 v244, s[8:11], s46 offen lds
  s_add_u32 m0, s45, 5120
  s_add_u32 s46, s44, 1212416
  buffer_load_dwordx4 v244, s[8:11], s46 offen lds
  s_add_u32 m0, s45, 6144
  s_add_u32 s46, s44, 1245184
  buffer_load_dwordx4 v245, s[8:11], s46 offen lds
  s_add_u32 m0, s45, 7168
  s_add_u32 s46, s44, 1277952
  buffer_load_dwordx4 v245, s[8:11], s46 offen lds
  s_waitcnt vmcnt(19)
  s_barrier
  s_add_u32 m0, s45, 16384
  s_add_u32 s46, s44, 1310720
  buffer_load_dwordx4 v244, s[8:11], s46 offen lds
  s_add_u32 m0, s45, 17408
  s_add_u32 s46, s44, 1343488
  buffer_load_dwordx4 v244, s[8:11], s46 offen lds
  s_add_u32 m0, s45, 18432
  s_add_u32 s46, s44, 1376256
  buffer_load_dwordx4 v245, s[8:11], s46 offen lds
  s_add_u32 m0, s45, 19456
  s_add_u32 s46, s44, 1409024
  buffer_load_dwordx4 v245, s[8:11], s46 offen lds
  s_add_u32 m0, s45, 20480
  s_add_u32 s46, s44, 1441792
  buffer_load_dwordx4 v244, s[8:11], s46 offen lds
  s_add_u32 m0, s45, 21504
  s_add_u32 s46, s44, 1474560
  buffer_load_dwordx4 v244, s[8:11], s46 offen lds
  s_add_u32 m0, s45, 22528
  s_add_u32 s46, s44, 1507328
  buffer_load_dwordx4 v245, s[8:11], s46 offen lds
  s_add_u32 m0, s45, 23552
  s_add_u32 s46, s44, 1540096
  buffer_load_dwordx4 v245, s[8:11], s46 offen lds
  s_mul_i32 s47, s16, 2560
  s_mov_b32 s46, 384
  s_add_u32 m0, s47, 131072
  s_nop 0
  buffer_load_dwordx4 v246, s[40:43], s46 offen lds
  s_add_u32 m0, s47, 132096
  s_nop 0
  buffer_load_dwordx4 v247, s[40:43], s46 offen lds
  s_waitcnt vmcnt(18)
  s_barrier
  s_add_u32 m0, s45, 8192
  s_add_u32 s46, s44, 1572864
  buffer_load_dwordx4 v244, s[8:11], s46 offen lds
  s_add_u32 m0, s45, 9216
  s_add_u32 s46, s44, 1605632
  buffer_load_dwordx4 v244, s[8:11], s46 offen lds
  s_add_u32 m0, s45, 10240
  s_add_u32 s46, s44, 1638400
  buffer_load_dwordx4 v245, s[8:11], s46 offen lds
  s_add_u32 m0, s45, 11264
  s_add_u32 s46, s44, 1671168
  buffer_load_dwordx4 v245, s[8:11], s46 offen lds
  s_add_u32 m0, s45, 12288
  s_add_u32 s46, s44, 1703936
  buffer_load_dwordx4 v244, s[8:11], s46 offen lds
  s_add_u32 m0, s45, 13312
  s_add_u32 s46, s44, 1736704
  buffer_load_dwordx4 v244, s[8:11], s46 offen lds
  s_add_u32 m0, s45, 14336
  s_add_u32 s46, s44, 1769472
  buffer_load_dwordx4 v245, s[8:11], s46 offen lds
  s_add_u32 m0, s45, 15360
  s_add_u32 s46, s44, 1802240
  buffer_load_dwordx4 v245, s[8:11], s46 offen lds
  s_mul_i32 s47, s16, 2560
  s_mov_b32 s46, 384
  s_add_u32 m0, s47, 133120
  s_mov_b32 exec_hi, 0
  buffer_load_dwordx4 v248, s[40:43], s46 offen lds
  s_mov_b32 exec_hi, -1
  s_waitcnt vmcnt(19)
  s_barrier
  s_add_u32 m0, s45, 24576
  s_add_u32 s46, s44, 1835008
  buffer_load_dwordx4 v244, s[8:11], s46 offen lds
  s_add_u32 m0, s45, 25600
  s_add_u32 s46, s44, 1867776
  buffer_load_dwordx4 v244, s[8:11], s46 offen lds
  s_add_u32 m0, s45, 26624
  s_add_u32 s46, s44, 1900544
  buffer_load_dwordx4 v245, s[8:11], s46 offen lds
  s_add_u32 m0, s45, 27648
  s_add_u32 s46, s44, 1933312
  buffer_load_dwordx4 v245, s[8:11], s46 offen lds
  s_add_u32 m0, s45, 28672
  s_add_u32 s46, s44, 1966080
  buffer_load_dwordx4 v244, s[8:11], s46 offen lds
  s_add_u32 m0, s45, 29696
  s_add_u32 s46, s44, 1998848
  buffer_load_dwordx4 v244, s[8:11], s46 offen lds
  s_add_u32 m0, s45, 30720
  s_add_u32 s46, s44, 2031616
  buffer_load_dwordx4 v245, s[8:11], s46 offen lds
  s_add_u32 m0, s45, 31744
  s_add_u32 s46, s44, 2064384
  buffer_load_dwordx4 v245, s[8:11], s46 offen lds
  s_mul_i32 s47, s16, 2560
  s_mov_b32 s46, 512
  s_add_u32 m0, s47, 141312
  s_nop 0
  buffer_load_dwordx4 v246, s[40:43], s46 offen lds
  s_add_u32 m0, s47, 142336
  s_nop 0
  buffer_load_dwordx4 v247, s[40:43], s46 offen lds
  s_waitcnt vmcnt(21)
  s_barrier
  s_add_u32 m0, s45, 0
  s_add_u32 s46, s44, 2097152
  buffer_load_dwordx4 v244, s[8:11], s46 offen lds
  s_add_u32 m0, s45, 1024
  s_add_u32 s46, s44, 2129920
  buffer_load_dwordx4 v244, s[8:11], s46 offen lds
  s_add_u32 m0, s45, 2048
  s_add_u32 s46, s44, 2162688
  buffer_load_dwordx4 v245, s[8:11], s46 offen lds
  s_add_u32 m0, s45, 3072
  s_add_u32 s46, s44, 2195456
  buffer_load_dwordx4 v245, s[8:11], s46 offen lds
  s_add_u32 m0, s45, 4096
  s_add_u32 s46, s44, 2228224
  buffer_load_dwordx4 v244, s[8:11], s46 offen lds
  s_add_u32 m0, s45, 5120
  s_add_u32 s46, s44, 2260992
  buffer_load_dwordx4 v244, s[8:11], s46 offen lds
  s_add_u32 m0, s45, 6144
  s_add_u32 s46, s44, 2293760
  buffer_load_dwordx4 v245, s[8:11], s46 offen lds
  s_add_u32 m0, s45, 7168
  s_add_u32 s46, s44, 2326528
  buffer_load_dwordx4 v245, s[8:11], s46 offen lds
  s_mul_i32 s47, s16, 2560
  s_mov_b32 s46, 512
  s_add_u32 m0, s47, 143360
  s_mov_b32 exec_hi, 0
  buffer_load_dwordx4 v248, s[40:43], s46 offen lds
  s_mov_b32 exec_hi, -1
  s_waitcnt vmcnt(19)
  s_barrier
  s_add_u32 m0, s45, 16384
  s_add_u32 s46, s44, 2359296
  buffer_load_dwordx4 v244, s[8:11], s46 offen lds
  s_add_u32 m0, s45, 17408
  s_add_u32 s46, s44, 2392064
  buffer_load_dwordx4 v244, s[8:11], s46 offen lds
  s_add_u32 m0, s45, 18432
  s_add_u32 s46, s44, 2424832
  buffer_load_dwordx4 v245, s[8:11], s46 offen lds
  s_add_u32 m0, s45, 19456
  s_add_u32 s46, s44, 2457600
  buffer_load_dwordx4 v245, s[8:11], s46 offen lds
  s_add_u32 m0, s45, 20480
  s_add_u32 s46, s44, 2490368
  buffer_load_dwordx4 v244, s[8:11], s46 offen lds
  s_add_u32 m0, s45, 21504
  s_add_u32 s46, s44, 2523136
  buffer_load_dwordx4 v244, s[8:11], s46 offen lds
  s_add_u32 m0, s45, 22528
  s_add_u32 s46, s44, 2555904
  buffer_load_dwordx4 v245, s[8:11], s46 offen lds
  s_add_u32 m0, s45, 23552
  s_add_u32 s46, s44, 2588672
  buffer_load_dwordx4 v245, s[8:11], s46 offen lds
  s_mul_i32 s47, s16, 2560
  s_mov_b32 s46, 640
  s_add_u32 m0, s47, 151552
  s_nop 0
  buffer_load_dwordx4 v246, s[40:43], s46 offen lds
  s_add_u32 m0, s47, 152576
  s_nop 0
  buffer_load_dwordx4 v247, s[40:43], s46 offen lds
  s_waitcnt vmcnt(21)
  s_barrier
  s_add_u32 m0, s45, 8192
  s_add_u32 s46, s44, 2621440
  buffer_load_dwordx4 v244, s[8:11], s46 offen lds
  s_add_u32 m0, s45, 9216
  s_add_u32 s46, s44, 2654208
  buffer_load_dwordx4 v244, s[8:11], s46 offen lds
  s_add_u32 m0, s45, 10240
  s_add_u32 s46, s44, 2686976
  buffer_load_dwordx4 v245, s[8:11], s46 offen lds
  s_add_u32 m0, s45, 11264
  s_add_u32 s46, s44, 2719744
  buffer_load_dwordx4 v245, s[8:11], s46 offen lds
  s_add_u32 m0, s45, 12288
  s_add_u32 s46, s44, 2752512
  buffer_load_dwordx4 v244, s[8:11], s46 offen lds
  s_add_u32 m0, s45, 13312
  s_add_u32 s46, s44, 2785280
  buffer_load_dwordx4 v244, s[8:11], s46 offen lds
  s_add_u32 m0, s45, 14336
  s_add_u32 s46, s44, 2818048
  buffer_load_dwordx4 v245, s[8:11], s46 offen lds
  s_add_u32 m0, s45, 15360
  s_add_u32 s46, s44, 2850816
  buffer_load_dwordx4 v245, s[8:11], s46 offen lds
  s_mul_i32 s47, s16, 2560
  s_mov_b32 s46, 640
  s_add_u32 m0, s47, 153600
  s_mov_b32 exec_hi, 0
  buffer_load_dwordx4 v248, s[40:43], s46 offen lds
  s_mov_b32 exec_hi, -1
  s_waitcnt vmcnt(19)
  s_barrier
  s_add_u32 m0, s45, 24576
  s_add_u32 s46, s44, 2883584
  buffer_load_dwordx4 v244, s[8:11], s46 offen lds
  s_add_u32 m0, s45, 25600
  s_add_u32 s46, s44, 2916352
  buffer_load_dwordx4 v244, s[8:11], s46 offen lds
  s_add_u32 m0, s45, 26624
  s_add_u32 s46, s44, 2949120
  buffer_load_dwordx4 v245, s[8:11], s46 offen lds
  s_add_u32 m0, s45, 27648
  s_add_u32 s46, s44, 2981888
  buffer_load_dwordx4 v245, s[8:11], s46 offen lds
  s_add_u32 m0, s45, 28672
  s_add_u32 s46, s44, 3014656
  buffer_load_dwordx4 v244, s[8:11], s46 offen lds
  s_add_u32 m0, s45, 29696
  s_add_u32 s46, s44, 3047424
  buffer_load_dwordx4 v244, s[8:11], s46 offen lds
  s_add_u32 m0, s45, 30720
  s_add_u32 s46, s44, 3080192
  buffer_load_dwordx4 v245, s[8:11], s46 offen lds
  s_add_u32 m0, s45, 31744
  s_add_u32 s46, s44, 3112960
  buffer_load_dwordx4 v245, s[8:11], s46 offen lds
  s_mul_i32 s47, s16, 2560
  s_mov_b32 s46, 768
  s_add_u32 m0, s47, 131072
  s_nop 0
  buffer_load_dwordx4 v246, s[40:43], s46 offen lds
  s_add_u32 m0, s47, 132096
  s_nop 0
  buffer_load_dwordx4 v247, s[40:43], s46 offen lds
  s_waitcnt vmcnt(21)
  s_barrier
  s_add_u32 m0, s45, 0
  s_add_u32 s46, s44, 3145728
  buffer_load_dwordx4 v244, s[8:11], s46 offen lds
  s_add_u32 m0, s45, 1024
  s_add_u32 s46, s44, 3178496
  buffer_load_dwordx4 v244, s[8:11], s46 offen lds
  s_add_u32 m0, s45, 2048
  s_add_u32 s46, s44, 3211264
  buffer_load_dwordx4 v245, s[8:11], s46 offen lds
  s_add_u32 m0, s45, 3072
  s_add_u32 s46, s44, 3244032
  buffer_load_dwordx4 v245, s[8:11], s46 offen lds
  s_add_u32 m0, s45, 4096
  s_add_u32 s46, s44, 3276800
  buffer_load_dwordx4 v244, s[8:11], s46 offen lds
  s_add_u32 m0, s45, 5120
  s_add_u32 s46, s44, 3309568
  buffer_load_dwordx4 v244, s[8:11], s46 offen lds
  s_add_u32 m0, s45, 6144
  s_add_u32 s46, s44, 3342336
  buffer_load_dwordx4 v245, s[8:11], s46 offen lds
  s_add_u32 m0, s45, 7168
  s_add_u32 s46, s44, 3375104
  buffer_load_dwordx4 v245, s[8:11], s46 offen lds
  s_mul_i32 s47, s16, 2560
  s_mov_b32 s46, 768
  s_add_u32 m0, s47, 133120
  s_mov_b32 exec_hi, 0
  buffer_load_dwordx4 v248, s[40:43], s46 offen lds
  s_mov_b32 exec_hi, -1
  s_waitcnt vmcnt(19)
  s_barrier
  s_add_u32 m0, s45, 16384
  s_add_u32 s46, s44, 3407872
  buffer_load_dwordx4 v244, s[8:11], s46 offen lds
  s_add_u32 m0, s45, 17408
  s_add_u32 s46, s44, 3440640
  buffer_load_dwordx4 v244, s[8:11], s46 offen lds
  s_add_u32 m0, s45, 18432
  s_add_u32 s46, s44, 3473408
  buffer_load_dwordx4 v245, s[8:11], s46 offen lds
  s_add_u32 m0, s45, 19456
  s_add_u32 s46, s44, 3506176
  buffer_load_dwordx4 v245, s[8:11], s46 offen lds
  s_add_u32 m0, s45, 20480
  s_add_u32 s46, s44, 3538944
  buffer_load_dwordx4 v244, s[8:11], s46 offen lds
  s_add_u32 m0, s45, 21504
  s_add_u32 s46, s44, 3571712
  buffer_load_dwordx4 v244, s[8:11], s46 offen lds
  s_add_u32 m0, s45, 22528
  s_add_u32 s46, s44, 3604480
  buffer_load_dwordx4 v245, s[8:11], s46 offen lds
  s_add_u32 m0, s45, 23552
  s_add_u32 s46, s44, 3637248
  buffer_load_dwordx4 v245, s[8:11], s46 offen lds
  s_waitcnt vmcnt(19)
  s_barrier
  s_waitcnt vmcnt(8)
  s_barrier
  s_cmp_eq_u32 s19, 0
  s_cbranch_scc1 L_fk_a_1
  s_and_b32 s21, s20, 31
  s_lshl_b32 s21, s21, 14
  s_add_u32 m0, s22, 8192
  s_add_u32 s20, s20, 1
  buffer_load_dwordx4 v221, s[4:7], s21 offen nt lds
  v_xor_b32 v223, 32, v221
  buffer_load_dwordx4 v223, s[4:7], s21 offen offset:1024 nt lds
  v_xor_b32 v222, 64, v221
  buffer_load_dwordx4 v222, s[4:7], s21 offen offset:2048 nt lds
  v_xor_b32 v223, 96, v221
  buffer_load_dwordx4 v223, s[4:7], s21 offen offset:3072 nt lds
  s_add_u32 m0, s22, 12288
  s_add_u32 s21, s21, 4096
  v_xor_b32 v222, 128, v221
  buffer_load_dwordx4 v222, s[4:7], s21 offen nt lds
  v_xor_b32 v223, 160, v221
  buffer_load_dwordx4 v223, s[4:7], s21 offen offset:1024 nt lds
  v_xor_b32 v222, 192, v221
  buffer_load_dwordx4 v222, s[4:7], s21 offen offset:2048 nt lds
  v_xor_b32 v223, 224, v221
  buffer_load_dwordx4 v223, s[4:7], s21 offen offset:3072 nt lds
  s_waitcnt vmcnt(8)
  s_branch L_fk_d_2
L_fk_a_1:
  s_and_b32 s21, s20, 31
  s_lshl_b32 s21, s21, 14
  s_lshl_b32 s31, s17, 12
  s_add_u32 s21, s21, s31
  s_add_u32 m0, s22, 8192
  s_add_u32 s20, s20, 1
  buffer_load_dwordx4 v221, s[4:7], s21 offen nt lds
  v_xor_b32 v223, 32, v221
  buffer_load_dwordx4 v223, s[4:7], s21 offen offset:1024 nt lds
  v_xor_b32 v222, 64, v221
  buffer_load_dwordx4 v222, s[4:7], s21 offen offset:2048 nt lds
  v_xor_b32 v223, 96, v221
  buffer_load_dwordx4 v223, s[4:7], s21 offen offset:3072 nt lds
  s_waitcnt vmcnt(4)
L_fk_d_2:
  s_barrier
  s_barrier
  s_barrier
  s_setprio 0
  s_cmp_eq_u32 s19, 0
  s_cbranch_scc1 L_k1_3
  s_and_b32 s21, s20, 31
  s_lshl_b32 s21, s21, 14
  s_add_u32 m0, s22, 0
  s_add_u32 s20, s20, 1
  buffer_load_dwordx4 v221, s[4:7], s21 offen nt lds
  v_xor_b32 v223, 32, v221
  buffer_load_dwordx4 v223, s[4:7], s21 offen offset:1024 nt lds
  v_xor_b32 v222, 64, v221
  buffer_load_dwordx4 v222, s[4:7], s21 offen offset:2048 nt lds
  v_xor_b32 v223, 96, v221
  buffer_load_dwordx4 v223, s[4:7], s21 offen offset:3072 nt lds
  s_add_u32 m0, s22, 4096
  s_add_u32 s21, s21, 4096
  v_xor_b32 v222, 128, v221
  buffer_load_dwordx4 v222, s[4:7], s21 offen nt lds
  v_xor_b32 v223, 160, v221
  buffer_load_dwordx4 v223, s[4:7], s21 offen offset:1024 nt lds
  v_xor_b32 v222, 192, v221
  buffer_load_dwordx4 v222, s[4:7], s21 offen offset:2048 nt lds
  v_xor_b32 v223, 224, v221
  buffer_load_dwordx4 v223, s[4:7], s21 offen offset:3072 nt lds
L_k1_3:
  s_cmp_eq_u32 s19, 1
  s_cselect_b64 s[8:9], s[38:39], s[36:37]
  s_mov_b32 s10, 3670016
  s_mov_b32 s11, 0x20000
  s_barrier
  v_lshlrev_b32 v226, 4, v255
  s_mul_i32 s73, s17, 40960
  s_add_u32 s73, s73, 65536
  v_add_u32 v227, s73, v226
  ds_read_b128 v[0:3], v227 offset:0
  ds_read_b128 v[4:7], v227 offset:1024
  ds_read_b128 v[8:11], v227 offset:2048
  ds_read_b128 v[12:15], v227 offset:3072
  ds_read_b128 v[16:19], v227 offset:4096
  ds_read_b128 v[20:23], v227 offset:5120
  ds_read_b128 v[24:27], v227 offset:6144
  ds_read_b128 v[28:31], v227 offset:7168
  s_waitcnt lgkmcnt(4)
  ds_read_b128 v[32:35], v227 offset:8192
  ds_read_b128 v[36:39], v227 offset:9216
  ds_read_b128 v[40:43], v227 offset:10240
  ds_read_b128 v[44:47], v227 offset:11264
  ds_read_b128 v[48:51], v227 offset:12288
  ds_read_b128 v[52:55], v227 offset:13312
  ds_read_b128 v[56:59], v227 offset:14336
  ds_read_b128 v[60:63], v227 offset:15360
  s_waitcnt lgkmcnt(4)
  ds_read_b128 v[64:67], v227 offset:16384
  ds_read_b128 v[68:71], v227 offset:17408
  ds_read_b128 v[72:75], v227 offset:18432
  ds_read_b128 v[76:79], v227 offset:19456
  ds_read_b128 v[80:83], v227 offset:20480
  ds_read_b128 v[84:87], v227 offset:21504
  ds_read_b128 v[88:91], v227 offset:22528
  ds_read_b128 v[92:95], v227 offset:23552
  s_waitcnt lgkmcnt(4)
  ds_read_b128 v[96:99], v227 offset:24576
  ds_read_b128 v[100:103], v227 offset:25600
  ds_read_b128 v[104:107], v227 offset:26624
  ds_read_b128 v[108:111], v227 offset:27648
  ds_read_b128 v[112:115], v227 offset:28672
  ds_read_b128 v[116:119], v227 offset:29696
  ds_read_b128 v[120:123], v227 offset:30720
  ds_read_b128 v[124:127], v227 offset:31744
  s_waitcnt lgkmcnt(4)
  ds_read_b128 v[128:131], v227 offset:32768
  ds_read_b128 v[132:135], v227 offset:33792
  ds_read_b128 v[136:139], v227 offset:34816
  ds_read_b128 v[140:143], v227 offset:35840
  ds_read_b128 v[144:147], v227 offset:36864
  ds_read_b128 v[148:151], v227 offset:37888
  ds_read_b128 v[152:155], v227 offset:38912
  ds_read_b128 v[156:159], v227 offset:39936
  s_waitcnt lgkmcnt(4)
  s_mul_i32 s73, s17, 5120
  s_lshl_b32 s74, s18, 3
  s_add_u32 s73, s73, s74
  s_add_u32 s73, s73, 131072
  v_add_u32 v224, s73, v226
  v_mov_b32 v212, 0
  v_mov_b32 v213, 0
  v_mov_b32 v214, 0
  v_mov_b32 v215, 0
  v_mov_b32 v216, 0
  s_setprio 1
  s_cmp_eq_u32 s19, 0
  s_cbranch_scc1 L_attn_kernel_qkA
  s_waitcnt vmcnt(8) lgkmcnt(0)
  s_barrier
  ds_read_b128 v[180:183], v217 offset:8192
  ds_read_b128 v[184:187], v218 offset:8192
  ds_read_b128 v[188:191], v219 offset:8192
  ds_read_b128 v[192:195], v220 offset:8192
  ds_read_b128 v[196:199], v217 offset:8448
  ds_read_b128 v[200:203], v218 offset:8448
  ds_read_b128 v[204:207], v219 offset:8448
  ds_read_b128 v[208:211], v220 offset:8448
  s_waitcnt lgkmcnt(7)
  v_mfma_f32_16x16x32_bf16 v[160:163], v[180:183], v[0:3], 0
  v_mfma_f32_16x16x32_bf16 v[164:167], v[180:183], v[32:35], 0
  v_mfma_f32_16x16x32_bf16 v[168:171], v[180:183], v[64:67], 0
  v_mfma_f32_16x16x32_bf16 v[172:175], v[180:183], v[96:99], 0
  v_mfma_f32_16x16x32_bf16 v[176:179], v[180:183], v[128:131], 0
  s_waitcnt lgkmcnt(6)
  v_mfma_f32_16x16x32_bf16 v[160:163], v[184:187], v[4:7], v[160:163]
  v_mfma_f32_16x16x32_bf16 v[164:167], v[184:187], v[36:39], v[164:167]
  v_mfma_f32_16x16x32_bf16 v[168:171], v[184:187], v[68:71], v[168:171]
  v_mfma_f32_16x16x32_bf16 v[172:175], v[184:187], v[100:103], v[172:175]
  v_mfma_f32_16x16x32_bf16 v[176:179], v[184:187], v[132:135], v[176:179]
  s_waitcnt lgkmcnt(0)
  v_mfma_f32_16x16x32_bf16 v[160:163], v[188:191], v[8:11], v[160:163]
  v_mfma_f32_16x16x32_bf16 v[164:167], v[188:191], v[40:43], v[164:167]
  v_mfma_f32_16x16x32_bf16 v[168:171], v[188:191], v[72:75], v[168:171]
  v_mfma_f32_16x16x32_bf16 v[172:175], v[188:191], v[104:107], v[172:175]
  v_mfma_f32_16x16x32_bf16 v[176:179], v[188:191], v[136:139], v[176:179]
  s_and_b32 s21, s20, 31
  s_lshl_b32 s21, s21, 14
  s_add_u32 m0, s22, 8192
  s_add_u32 s20, s20, 1
  buffer_load_dwordx4 v221, s[4:7], s21 offen nt lds
  v_mfma_f32_16x16x32_bf16 v[160:163], v[192:195], v[12:15], v[160:163]
  v_mfma_f32_16x16x32_bf16 v[164:167], v[192:195], v[44:47], v[164:167]
  v_mfma_f32_16x16x32_bf16 v[168:171], v[192:195], v[76:79], v[168:171]
  v_mfma_f32_16x16x32_bf16 v[172:175], v[192:195], v[108:111], v[172:175]
  v_mfma_f32_16x16x32_bf16 v[176:179], v[192:195], v[140:143], v[176:179]
  v_xor_b32 v223, 32, v221
  buffer_load_dwordx4 v223, s[4:7], s21 offen offset:1024 nt lds
  v_mfma_f32_16x16x32_bf16 v[160:163], v[196:199], v[16:19], v[160:163]
  v_mfma_f32_16x16x32_bf16 v[164:167], v[196:199], v[48:51], v[164:167]
  v_mfma_f32_16x16x32_bf16 v[168:171], v[196:199], v[80:83], v[168:171]
  v_mfma_f32_16x16x32_bf16 v[172:175], v[196:199], v[112:115], v[172:175]
  v_mfma_f32_16x16x32_bf16 v[176:179], v[196:199], v[144:147], v[176:179]
  v_xor_b32 v222, 64, v221
  buffer_load_dwordx4 v222, s[4:7], s21 offen offset:2048 nt lds
  v_mfma_f32_16x16x32_bf16 v[160:163], v[200:203], v[20:23], v[160:163]
  v_mfma_f32_16x16x32_bf16 v[164:167], v[200:203], v[52:55], v[164:167]
  v_mfma_f32_16x16x32_bf16 v[168:171], v[200:203], v[84:87], v[168:171]
  v_mfma_f32_16x16x32_bf16 v[172:175], v[200:203], v[116:119], v[172:175]
  v_mfma_f32_16x16x32_bf16 v[176:179], v[200:203], v[148:151], v[176:179]
  v_xor_b32 v223, 96, v221
  buffer_load_dwordx4 v223, s[4:7], s21 offen offset:3072 nt lds
  v_mfma_f32_16x16x32_bf16 v[160:163], v[204:207], v[24:27], v[160:163]
  v_mfma_f32_16x16x32_bf16 v[164:167], v[204:207], v[56:59], v[164:167]
  v_mfma_f32_16x16x32_bf16 v[168:171], v[204:207], v[88:91], v[168:171]
  v_mfma_f32_16x16x32_bf16 v[172:175], v[204:207], v[120:123], v[172:175]
  v_mfma_f32_16x16x32_bf16 v[176:179], v[204:207], v[152:155], v[176:179]
  s_add_u32 m0, s22, 12288
  s_add_u32 s21, s21, 4096
  v_xor_b32 v222, 128, v221
  buffer_load_dwordx4 v222, s[4:7], s21 offen nt lds
  v_mfma_f32_16x16x32_bf16 v[160:163], v[208:211], v[28:31], v[160:163]
  v_mfma_f32_16x16x32_bf16 v[164:167], v[208:211], v[60:63], v[164:167]
  v_mfma_f32_16x16x32_bf16 v[168:171], v[208:211], v[92:95], v[168:171]
  v_mfma_f32_16x16x32_bf16 v[172:175], v[208:211], v[124:127], v[172:175]
  v_mfma_f32_16x16x32_bf16 v[176:179], v[208:211], v[156:159], v[176:179]
  v_xor_b32 v223, 160, v221
  buffer_load_dwordx4 v223, s[4:7], s21 offen offset:1024 nt lds
  v_xor_b32 v222, 192, v221
  buffer_load_dwordx4 v222, s[4:7], s21 offen offset:2048 nt lds
  s_nop 3
  v_fma_f32 v160, v160, s27, -v212
  v_fma_f32 v161, v161, s27, -v212
  v_fma_f32 v162, v162, s27, -v212
  v_fma_f32 v163, v163, s27, -v212
  v_fma_f32 v164, v164, s27, -v213
  v_fma_f32 v165, v165, s27, -v213
  v_fma_f32 v166, v166, s27, -v213
  v_fma_f32 v167, v167, s27, -v213
  v_fma_f32 v168, v168, s27, -v214
  v_fma_f32 v169, v169, s27, -v214
  v_fma_f32 v170, v170, s27, -v214
  v_fma_f32 v171, v171, s27, -v214
  v_fma_f32 v172, v172, s27, -v215
  v_fma_f32 v173, v173, s27, -v215
  v_fma_f32 v174, v174, s27, -v215
  v_fma_f32 v175, v175, s27, -v215
  v_fma_f32 v176, v176, s27, -v216
  v_fma_f32 v177, v177, s27, -v216
  v_fma_f32 v178, v178, s27, -v216
  v_fma_f32 v179, v179, s27, -v216
  v_xor_b32 v223, 224, v221
  buffer_load_dwordx4 v223, s[4:7], s21 offen offset:3072 nt lds
  v_max3_f32 v226, v160, v161, v162
  v_max3_f32 v227, v163, v164, v165
  v_max3_f32 v226, v226, v166, v167
  v_max3_f32 v227, v227, v168, v169
  v_max3_f32 v226, v226, v170, v171
  v_max3_f32 v227, v227, v172, v173
  v_max3_f32 v226, v226, v174, v175
  v_max3_f32 v227, v227, v176, v177
  v_max3_f32 v226, v226, v178, v179
  v_max_f32 v226, v226, v227
  v_cmp_lt_f32 vcc, s28, v226
  v_mov_b32 v228, s30
  v_mov_b32 v229, 1
  ds_write_b32 v228, v229 offset:0
  v_exp_f32 v230, v160
  v_exp_f32 v231, v161
  v_exp_f32 v232, v162
  v_exp_f32 v233, v163
  s_nop 0
  v_cvt_pk_bf16_f32 v234, v230, v231
  v_cvt_pk_bf16_f32 v235, v232, v233
  ds_write_b64 v224, v[234:235] offset:0
  v_exp_f32 v236, v164
  v_exp_f32 v237, v165
  v_exp_f32 v238, v166
  v_exp_f32 v239, v167
  s_nop 0
  v_cvt_pk_bf16_f32 v240, v236, v237
  v_cvt_pk_bf16_f32 v241, v238, v239
  ds_write_b64 v224, v[240:241] offset:1024
  v_exp_f32 v230, v168
  v_exp_f32 v231, v169
  v_exp_f32 v232, v170
  v_exp_f32 v233, v171
  s_nop 0
  v_cvt_pk_bf16_f32 v234, v230, v231
  v_cvt_pk_bf16_f32 v235, v232, v233
  ds_write_b64 v224, v[234:235] offset:2048
  v_exp_f32 v236, v172
  v_exp_f32 v237, v173
  v_exp_f32 v238, v174
  v_exp_f32 v239, v175
  s_nop 0
  v_cvt_pk_bf16_f32 v240, v236, v237
  v_cvt_pk_bf16_f32 v241, v238, v239
  ds_write_b64 v224, v[240:241] offset:3072
  v_exp_f32 v230, v176
  v_exp_f32 v231, v177
  v_exp_f32 v232, v178
  v_exp_f32 v233, v179
  s_nop 0
  v_cvt_pk_bf16_f32 v234, v230, v231
  v_cvt_pk_bf16_f32 v235, v232, v233
  ds_write_b64 v224, v[234:235] offset:4096
  s_waitcnt vmcnt(8) lgkmcnt(0)
  s_barrier
  s_mov_b32 s23, 14
L_qk_B_4:
  v_mov_b32 v226, 151552
  ds_read_b128 v[228:231], v226 offset:0
  ds_read_b128 v[180:183], v217
  ds_read_b128 v[184:187], v218
  ds_read_b128 v[188:191], v219
  ds_read_b128 v[192:195], v220
  ds_read_b128 v[196:199], v217 offset:256
  ds_read_b128 v[200:203], v218 offset:256
  ds_read_b128 v[204:207], v219 offset:256
  ds_read_b128 v[208:211], v220 offset:256
  s_waitcnt lgkmcnt(8)
  v_or3_b32 v228, v228, v229, v230
  v_or_b32 v228, v228, v231
  v_cmp_ne_u32 vcc, 0, v228
  s_mov_b32 s25, 0
  s_mov_b32 s24, 0
  s_cbranch_vccnz L_slow_qk_B
L_back_5:
  s_waitcnt lgkmcnt(7)
  v_mfma_f32_16x16x32_bf16 v[160:163], v[180:183], v[0:3], 0
  v_mfma_f32_16x16x32_bf16 v[164:167], v[180:183], v[32:35], 0
  v_mfma_f32_16x16x32_bf16 v[168:171], v[180:183], v[64:67], 0
  v_mfma_f32_16x16x32_bf16 v[172:175], v[180:183], v[96:99], 0
  v_mfma_f32_16x16x32_bf16 v[176:179], v[180:183], v[128:131], 0
  s_waitcnt lgkmcnt(6)
  v_mfma_f32_16x16x32_bf16 v[160:163], v[184:187], v[4:7], v[160:163]
  v_mfma_f32_16x16x32_bf16 v[164:167], v[184:187], v[36:39], v[164:167]
  v_mfma_f32_16x16x32_bf16 v[168:171], v[184:187], v[68:71], v[168:171]
  v_mfma_f32_16x16x32_bf16 v[172:175], v[184:187], v[100:103], v[172:175]
  v_mfma_f32_16x16x32_bf16 v[176:179], v[184:187], v[132:135], v[176:179]
  s_waitcnt lgkmcnt(0)
  v_mfma_f32_16x16x32_bf16 v[160:163], v[188:191], v[8:11], v[160:163]
  v_mfma_f32_16x16x32_bf16 v[164:167], v[188:191], v[40:43], v[164:167]
  v_mfma_f32_16x16x32_bf16 v[168:171], v[188:191], v[72:75], v[168:171]
  v_mfma_f32_16x16x32_bf16 v[172:175], v[188:191], v[104:107], v[172:175]
  v_mfma_f32_16x16x32_bf16 v[176:179], v[188:191], v[136:139], v[176:179]
  s_and_b32 s21, s20, 31
  s_lshl_b32 s21, s21, 14
  s_add_u32 m0, s22, 0
  s_add_u32 s20, s20, 1
  buffer_load_dwordx4 v221, s[4:7], s21 offen nt lds
  v_mfma_f32_16x16x32_bf16 v[160:163], v[192:195], v[12:15], v[160:163]
  v_mfma_f32_16x16x32_bf16 v[164:167], v[192:195], v[44:47], v[164:167]
  v_mfma_f32_16x16x32_bf16 v[168:171], v[192:195], v[76:79], v[168:171]
  v_mfma_f32_16x16x32_bf16 v[172:175], v[192:195], v[108:111], v[172:175]
  v_mfma_f32_16x16x32_bf16 v[176:179], v[192:195], v[140:143], v[176:179]
  v_xor_b32 v223, 32, v221
  buffer_load_dwordx4 v223, s[4:7], s21 offen offset:1024 nt lds
  v_mfma_f32_16x16x32_bf16 v[160:163], v[196:199], v[16:19], v[160:163]
  v_mfma_f32_16x16x32_bf16 v[164:167], v[196:199], v[48:51], v[164:167]
  v_mfma_f32_16x16x32_bf16 v[168:171], v[196:199], v[80:83], v[168:171]
  v_mfma_f32_16x16x32_bf16 v[172:175], v[196:199], v[112:115], v[172:175]
  v_mfma_f32_16x16x32_bf16 v[176:179], v[196:199], v[144:147], v[176:179]
  v_xor_b32 v222, 64, v221
  buffer_load_dwordx4 v222, s[4:7], s21 offen offset:2048 nt lds
  v_mfma_f32_16x16x32_bf16 v[160:163], v[200:203], v[20:23], v[160:163]
  v_mfma_f32_16x16x32_bf16 v[164:167], v[200:203], v[52:55], v[164:167]
  v_mfma_f32_16x16x32_bf16 v[168:171], v[200:203], v[84:87], v[168:171]
  v_mfma_f32_16x16x32_bf16 v[172:175], v[200:203], v[116:119], v[172:175]
  v_mfma_f32_16x16x32_bf16 v[176:179], v[200:203], v[148:151], v[176:179]
  v_xor_b32 v223, 96, v221
  buffer_load_dwordx4 v223, s[4:7], s21 offen offset:3072 nt lds
  v_mfma_f32_16x16x32_bf16 v[160:163], v[204:207], v[24:27], v[160:163]
  v_mfma_f32_16x16x32_bf16 v[164:167], v[204:207], v[56:59], v[164:167]
  v_mfma_f32_16x16x32_bf16 v[168:171], v[204:207], v[88:91], v[168:171]
  v_mfma_f32_16x16x32_bf16 v[172:175], v[204:207], v[120:123], v[172:175]
  v_mfma_f32_16x16x32_bf16 v[176:179], v[204:207], v[152:155], v[176:179]
  s_add_u32 m0, s22, 4096
  s_add_u32 s21, s21, 4096
  v_xor_b32 v222, 128, v221
  buffer_load_dwordx4 v222, s[4:7], s21 offen nt lds
  v_mfma_f32_16x16x32_bf16 v[160:163], v[208:211], v[28:31], v[160:163]
  v_mfma_f32_16x16x32_bf16 v[164:167], v[208:211], v[60:63], v[164:167]
  v_mfma_f32_16x16x32_bf16 v[168:171], v[208:211], v[92:95], v[168:171]
  v_mfma_f32_16x16x32_bf16 v[172:175], v[208:211], v[124:127], v[172:175]
  v_mfma_f32_16x16x32_bf16 v[176:179], v[208:211], v[156:159], v[176:179]
  v_xor_b32 v223, 160, v221
  buffer_load_dwordx4 v223, s[4:7], s21 offen offset:1024 nt lds
  v_xor_b32 v222, 192, v221
  buffer_load_dwordx4 v222, s[4:7], s21 offen offset:2048 nt lds
  s_nop 3
  v_fma_f32 v160, v160, s27, -v212
  v_fma_f32 v161, v161, s27, -v212
  v_fma_f32 v162, v162, s27, -v212
  v_fma_f32 v163, v163, s27, -v212
  v_fma_f32 v164, v164, s27, -v213
  v_fma_f32 v165, v165, s27, -v213
  v_fma_f32 v166, v166, s27, -v213
  v_fma_f32 v167, v167, s27, -v213
  v_fma_f32 v168, v168, s27, -v214
  v_fma_f32 v169, v169, s27, -v214
  v_fma_f32 v170, v170, s27, -v214
  v_fma_f32 v171, v171, s27, -v214
  v_fma_f32 v172, v172, s27, -v215
  v_fma_f32 v173, v173, s27, -v215
  v_fma_f32 v174, v174, s27, -v215
  v_fma_f32 v175, v175, s27, -v215
  v_fma_f32 v176, v176, s27, -v216
  v_fma_f32 v177, v177, s27, -v216
  v_fma_f32 v178, v178, s27, -v216
  v_fma_f32 v179, v179, s27, -v216
  v_xor_b32 v223, 224, v221
  buffer_load_dwordx4 v223, s[4:7], s21 offen offset:3072 nt lds
  v_max3_f32 v226, v160, v161, v162
  v_max3_f32 v227, v163, v164, v165
  v_max3_f32 v226, v226, v166, v167
  v_max3_f32 v227, v227, v168, v169
  v_max3_f32 v226, v226, v170, v171
  v_max3_f32 v227, v227, v172, v173
  v_max3_f32 v226, v226, v174, v175
  v_max3_f32 v227, v227, v176, v177
  v_max3_f32 v226, v226, v178, v179
  v_max_f32 v226, v226, v227
  v_cmp_lt_f32 vcc, s28, v226
  v_mov_b32 v228, s30
  s_cmp_lg_u64 vcc, 0
  s_cselect_b32 s31, 1, 0
  v_mov_b32 v229, s31
  ds_write_b32 v228, v229 offset:16
  v_exp_f32 v230, v160
  v_exp_f32 v231, v161
  v_exp_f32 v232, v162
  v_exp_f32 v233, v163
  s_nop 0
  v_cvt_pk_bf16_f32 v234, v230, v231
  v_cvt_pk_bf16_f32 v235, v232, v233
  ds_write_b64 v224, v[234:235] offset:10240
  v_exp_f32 v236, v164
  v_exp_f32 v237, v165
  v_exp_f32 v238, v166
  v_exp_f32 v239, v167
  s_nop 0
  v_cvt_pk_bf16_f32 v240, v236, v237
  v_cvt_pk_bf16_f32 v241, v238, v239
  ds_write_b64 v224, v[240:241] offset:11264
  v_exp_f32 v230, v168
  v_exp_f32 v231, v169
  v_exp_f32 v232, v170
  v_exp_f32 v233, v171
  s_nop 0
  v_cvt_pk_bf16_f32 v234, v230, v231
  v_cvt_pk_bf16_f32 v235, v232, v233
  ds_write_b64 v224, v[234:235] offset:12288
  v_exp_f32 v236, v172
  v_exp_f32 v237, v173
  v_exp_f32 v238, v174
  v_exp_f32 v239, v175
  s_nop 0
  v_cvt_pk_bf16_f32 v240, v236, v237
  v_cvt_pk_bf16_f32 v241, v238, v239
  ds_write_b64 v224, v[240:241] offset:13312
  v_exp_f32 v230, v176
  v_exp_f32 v231, v177
  v_exp_f32 v232, v178
  v_exp_f32 v233, v179
  s_nop 0
  v_cvt_pk_bf16_f32 v234, v230, v231
  v_cvt_pk_bf16_f32 v235, v232, v233
  ds_write_b64 v224, v[234:235] offset:14336
  s_waitcnt vmcnt(8) lgkmcnt(0)
  s_barrier
  v_mov_b32 v226, 151552
  ds_read_b128 v[228:231], v226 offset:16
  ds_read_b128 v[180:183], v217 offset:8192
  ds_read_b128 v[184:187], v218 offset:8192
  ds_read_b128 v[188:191], v219 offset:8192
  ds_read_b128 v[192:195], v220 offset:8192
  ds_read_b128 v[196:199], v217 offset:8448
  ds_read_b128 v[200:203], v218 offset:8448
  ds_read_b128 v[204:207], v219 offset:8448
  ds_read_b128 v[208:211], v220 offset:8448
  s_waitcnt lgkmcnt(8)
  v_or3_b32 v228, v228, v229, v230
  v_or_b32 v228, v228, v231
  v_cmp_ne_u32 vcc, 0, v228
  s_mov_b32 s25, 1
  s_mov_b32 s24, 10240
  s_cbranch_vccnz L_slow_qk_B
L_back_6:
  s_waitcnt lgkmcnt(7)
  v_mfma_f32_16x16x32_bf16 v[160:163], v[180:183], v[0:3], 0
  v_mfma_f32_16x16x32_bf16 v[164:167], v[180:183], v[32:35], 0
  v_mfma_f32_16x16x32_bf16 v[168:171], v[180:183], v[64:67], 0
  v_mfma_f32_16x16x32_bf16 v[172:175], v[180:183], v[96:99], 0
  v_mfma_f32_16x16x32_bf16 v[176:179], v[180:183], v[128:131], 0
  s_waitcnt lgkmcnt(6)
  v_mfma_f32_16x16x32_bf16 v[160:163], v[184:187], v[4:7], v[160:163]
  v_mfma_f32_16x16x32_bf16 v[164:167], v[184:187], v[36:39], v[164:167]
  v_mfma_f32_16x16x32_bf16 v[168:171], v[184:187], v[68:71], v[168:171]
  v_mfma_f32_16x16x32_bf16 v[172:175], v[184:187], v[100:103], v[172:175]
  v_mfma_f32_16x16x32_bf16 v[176:179], v[184:187], v[132:135], v[176:179]
  s_waitcnt lgkmcnt(0)
  v_mfma_f32_16x16x32_bf16 v[160:163], v[188:191], v[8:11], v[160:163]
  v_mfma_f32_16x16x32_bf16 v[164:167], v[188:191], v[40:43], v[164:167]
  v_mfma_f32_16x16x32_bf16 v[168:171], v[188:191], v[72:75], v[168:171]
  v_mfma_f32_16x16x32_bf16 v[172:175], v[188:191], v[104:107], v[172:175]
  v_mfma_f32_16x16x32_bf16 v[176:179], v[188:191], v[136:139], v[176:179]
  s_and_b32 s21, s20, 31
  s_lshl_b32 s21, s21, 14
  s_add_u32 m0, s22, 8192
  s_add_u32 s20, s20, 1
  buffer_load_dwordx4 v221, s[4:7], s21 offen nt lds
  v_mfma_f32_16x16x32_bf16 v[160:163], v[192:195], v[12:15], v[160:163]
  v_mfma_f32_16x16x32_bf16 v[164:167], v[192:195], v[44:47], v[164:167]
  v_mfma_f32_16x16x32_bf16 v[168:171], v[192:195], v[76:79], v[168:171]
  v_mfma_f32_16x16x32_bf16 v[172:175], v[192:195], v[108:111], v[172:175]
  v_mfma_f32_16x16x32_bf16 v[176:179], v[192:195], v[140:143], v[176:179]
  v_xor_b32 v223, 32, v221
  buffer_load_dwordx4 v223, s[4:7], s21 offen offset:1024 nt lds
  v_mfma_f32_16x16x32_bf16 v[160:163], v[196:199], v[16:19], v[160:163]
  v_mfma_f32_16x16x32_bf16 v[164:167], v[196:199], v[48:51], v[164:167]
  v_mfma_f32_16x16x32_bf16 v[168:171], v[196:199], v[80:83], v[168:171]
  v_mfma_f32_16x16x32_bf16 v[172:175], v[196:199], v[112:115], v[172:175]
  v_mfma_f32_16x16x32_bf16 v[176:179], v[196:199], v[144:147], v[176:179]
  v_xor_b32 v222, 64, v221
  buffer_load_dwordx4 v222, s[4:7], s21 offen offset:2048 nt lds
  v_mfma_f32_16x16x32_bf16 v[160:163], v[200:203], v[20:23], v[160:163]
  v_mfma_f32_16x16x32_bf16 v[164:167], v[200:203], v[52:55], v[164:167]
  v_mfma_f32_16x16x32_bf16 v[168:171], v[200:203], v[84:87], v[168:171]
  v_mfma_f32_16x16x32_bf16 v[172:175], v[200:203], v[116:119], v[172:175]
  v_mfma_f32_16x16x32_bf16 v[176:179], v[200:203], v[148:151], v[176:179]
  v_xor_b32 v223, 96, v221
  buffer_load_dwordx4 v223, s[4:7], s21 offen offset:3072 nt lds
  v_mfma_f32_16x16x32_bf16 v[160:163], v[204:207], v[24:27], v[160:163]
  v_mfma_f32_16x16x32_bf16 v[164:167], v[204:207], v[56:59], v[164:167]
  v_mfma_f32_16x16x32_bf16 v[168:171], v[204:207], v[88:91], v[168:171]
  v_mfma_f32_16x16x32_bf16 v[172:175], v[204:207], v[120:123], v[172:175]
  v_mfma_f32_16x16x32_bf16 v[176:179], v[204:207], v[152:155], v[176:179]
  s_add_u32 m0, s22, 12288
  s_add_u32 s21, s21, 4096
  v_xor_b32 v222, 128, v221
  buffer_load_dwordx4 v222, s[4:7], s21 offen nt lds
  v_mfma_f32_16x16x32_bf16 v[160:163], v[208:211], v[28:31], v[160:163]
  v_mfma_f32_16x16x32_bf16 v[164:167], v[208:211], v[60:63], v[164:167]
  v_mfma_f32_16x16x32_bf16 v[168:171], v[208:211], v[92:95], v[168:171]
  v_mfma_f32_16x16x32_bf16 v[172:175], v[208:211], v[124:127], v[172:175]
  v_mfma_f32_16x16x32_bf16 v[176:179], v[208:211], v[156:159], v[176:179]
  v_xor_b32 v223, 160, v221
  buffer_load_dwordx4 v223, s[4:7], s21 offen offset:1024 nt lds
  v_xor_b32 v222, 192, v221
  buffer_load_dwordx4 v222, s[4:7], s21 offen offset:2048 nt lds
  s_nop 3
  v_fma_f32 v160, v160, s27, -v212
  v_fma_f32 v161, v161, s27, -v212
  v_fma_f32 v162, v162, s27, -v212
  v_fma_f32 v163, v163, s27, -v212
  v_fma_f32 v164, v164, s27, -v213
  v_fma_f32 v165, v165, s27, -v213
  v_fma_f32 v166, v166, s27, -v213
  v_fma_f32 v167, v167, s27, -v213
  v_fma_f32 v168, v168, s27, -v214
  v_fma_f32 v169, v169, s27, -v214
  v_fma_f32 v170, v170, s27, -v214
  v_fma_f32 v171, v171, s27, -v214
  v_fma_f32 v172, v172, s27, -v215
  v_fma_f32 v173, v173, s27, -v215
  v_fma_f32 v174, v174, s27, -v215
  v_fma_f32 v175, v175, s27, -v215
  v_fma_f32 v176, v176, s27, -v216
  v_fma_f32 v177, v177, s27, -v216
  v_fma_f32 v178, v178, s27, -v216
  v_fma_f32 v179, v179, s27, -v216
  v_xor_b32 v223, 224, v221
  buffer_load_dwordx4 v223, s[4:7], s21 offen offset:3072 nt lds
  v_max3_f32 v226, v160, v161, v162
  v_max3_f32 v227, v163, v164, v165
  v_max3_f32 v226, v226, v166, v167
  v_max3_f32 v227, v227, v168, v169
  v_max3_f32 v226, v226, v170, v171
  v_max3_f32 v227, v227, v172, v173
  v_max3_f32 v226, v226, v174, v175
  v_max3_f32 v227, v227, v176, v177
  v_max3_f32 v226, v226, v178, v179
  v_max_f32 v226, v226, v227
  v_cmp_lt_f32 vcc, s28, v226
  v_mov_b32 v228, s30
  s_cmp_lg_u64 vcc, 0
  s_cselect_b32 s31, 1, 0
  v_mov_b32 v229, s31
  ds_write_b32 v228, v229 offset:0
  v_exp_f32 v230, v160
  v_exp_f32 v231, v161
  v_exp_f32 v232, v162
  v_exp_f32 v233, v163
  s_nop 0
  v_cvt_pk_bf16_f32 v234, v230, v231
  v_cvt_pk_bf16_f32 v235, v232, v233
  ds_write_b64 v224, v[234:235] offset:0
  v_exp_f32 v236, v164
  v_exp_f32 v237, v165
  v_exp_f32 v238, v166
  v_exp_f32 v239, v167
  s_nop 0
  v_cvt_pk_bf16_f32 v240, v236, v237
  v_cvt_pk_bf16_f32 v241, v238, v239
  ds_write_b64 v224, v[240:241] offset:1024
  v_exp_f32 v230, v168
  v_exp_f32 v231, v169
  v_exp_f32 v232, v170
  v_exp_f32 v233, v171
  s_nop 0
  v_cvt_pk_bf16_f32 v234, v230, v231
  v_cvt_pk_bf16_f32 v235, v232, v233
  ds_write_b64 v224, v[234:235] offset:2048
  v_exp_f32 v236, v172
  v_exp_f32 v237, v173
  v_exp_f32 v238, v174
  v_exp_f32 v239, v175
  s_nop 0
  v_cvt_pk_bf16_f32 v240, v236, v237
  v_cvt_pk_bf16_f32 v241, v238, v239
  ds_write_b64 v224, v[240:241] offset:3072
  v_exp_f32 v230, v176
  v_exp_f32 v231, v177
  v_exp_f32 v232, v178
  v_exp_f32 v233, v179
  s_nop 0
  v_cvt_pk_bf16_f32 v234, v230, v231
  v_cvt_pk_bf16_f32 v235, v232, v233
  ds_write_b64 v224, v[234:235] offset:4096
  s_waitcnt vmcnt(8) lgkmcnt(0)
  s_barrier
  s_sub_u32 s23, s23, 1
  s_cmp_lg_u32 s23, 0
  s_cbranch_scc1 L_qk_B_4
  v_mov_b32 v226, 151552
  ds_read_b128 v[228:231], v226 offset:0
  ds_read_b128 v[180:183], v217
  ds_read_b128 v[184:187], v218
  ds_read_b128 v[188:191], v219
  ds_read_b128 v[192:195], v220
  ds_read_b128 v[196:199], v217 offset:256
  ds_read_b128 v[200:203], v218 offset:256
  ds_read_b128 v[204:207], v219 offset:256
  ds_read_b128 v[208:211], v220 offset:256
  s_waitcnt lgkmcnt(8)
  v_or3_b32 v228, v228, v229, v230
  v_or_b32 v228, v228, v231
  v_cmp_ne_u32 vcc, 0, v228
  s_mov_b32 s25, 2
  s_mov_b32 s24, 0
  s_cbranch_vccnz L_slow_qk_B
L_back_7:
  s_waitcnt lgkmcnt(7)
  v_mfma_f32_16x16x32_bf16 v[160:163], v[180:183], v[0:3], 0
  v_mfma_f32_16x16x32_bf16 v[164:167], v[180:183], v[32:35], 0
  v_mfma_f32_16x16x32_bf16 v[168:171], v[180:183], v[64:67], 0
  v_mfma_f32_16x16x32_bf16 v[172:175], v[180:183], v[96:99], 0
  v_mfma_f32_16x16x32_bf16 v[176:179], v[180:183], v[128:131], 0
  s_waitcnt lgkmcnt(6)
  v_mfma_f32_16x16x32_bf16 v[160:163], v[184:187], v[4:7], v[160:163]
  v_mfma_f32_16x16x32_bf16 v[164:167], v[184:187], v[36:39], v[164:167]
  v_mfma_f32_16x16x32_bf16 v[168:171], v[184:187], v[68:71], v[168:171]
  v_mfma_f32_16x16x32_bf16 v[172:175], v[184:187], v[100:103], v[172:175]
  v_mfma_f32_16x16x32_bf16 v[176:179], v[184:187], v[132:135], v[176:179]
  s_waitcnt lgkmcnt(0)
  v_mfma_f32_16x16x32_bf16 v[160:163], v[188:191], v[8:11], v[160:163]
  v_mfma_f32_16x16x32_bf16 v[164:167], v[188:191], v[40:43], v[164:167]
  v_mfma_f32_16x16x32_bf16 v[168:171], v[188:191], v[72:75], v[168:171]
  v_mfma_f32_16x16x32_bf16 v[172:175], v[188:191], v[104:107], v[172:175]
  v_mfma_f32_16x16x32_bf16 v[176:179], v[188:191], v[136:139], v[176:179]
  s_and_b32 s21, s20, 31
  s_lshl_b32 s21, s21, 14
  s_add_u32 m0, s22, 0
  s_add_u32 s20, s20, 1
  buffer_load_dwordx4 v221, s[4:7], s21 offen nt lds
  v_mfma_f32_16x16x32_bf16 v[160:163], v[192:195], v[12:15], v[160:163]
  v_mfma_f32_16x16x32_bf16 v[164:167], v[192:195], v[44:47], v[164:167]
  v_mfma_f32_16x16x32_bf16 v[168:171], v[192:195], v[76:79], v[168:171]
  v_mfma_f32_16x16x32_bf16 v[172:175], v[192:195], v[108:111], v[172:175]
  v_mfma_f32_16x16x32_bf16 v[176:179], v[192:195], v[140:143], v[176:179]
  v_xor_b32 v223, 32, v221
  buffer_load_dwordx4 v223, s[4:7], s21 offen offset:1024 nt lds
  v_mfma_f32_16x16x32_bf16 v[160:163], v[196:199], v[16:19], v[160:163]
  v_mfma_f32_16x16x32_bf16 v[164:167], v[196:199], v[48:51], v[164:167]
  v_mfma_f32_16x16x32_bf16 v[168:171], v[196:199], v[80:83], v[168:171]
  v_mfma_f32_16x16x32_bf16 v[172:175], v[196:199], v[112:115], v[172:175]
  v_mfma_f32_16x16x32_bf16 v[176:179], v[196:199], v[144:147], v[176:179]
  v_xor_b32 v222, 64, v221
  buffer_load_dwordx4 v222, s[4:7], s21 offen offset:2048 nt lds
  v_mfma_f32_16x16x32_bf16 v[160:163], v[200:203], v[20:23], v[160:163]
  v_mfma_f32_16x16x32_bf16 v[164:167], v[200:203], v[52:55], v[164:167]
  v_mfma_f32_16x16x32_bf16 v[168:171], v[200:203], v[84:87], v[168:171]
  v_mfma_f32_16x16x32_bf16 v[172:175], v[200:203], v[116:119], v[172:175]
  v_mfma_f32_16x16x32_bf16 v[176:179], v[200:203], v[148:151], v[176:179]
  v_xor_b32 v223, 96, v221
  buffer_load_dwordx4 v223, s[4:7], s21 offen offset:3072 nt lds
  v_mfma_f32_16x16x32_bf16 v[160:163], v[204:207], v[24:27], v[160:163]
  v_mfma_f32_16x16x32_bf16 v[164:167], v[204:207], v[56:59], v[164:167]
  v_mfma_f32_16x16x32_bf16 v[168:171], v[204:207], v[88:91], v[168:171]
  v_mfma_f32_16x16x32_bf16 v[172:175], v[204:207], v[120:123], v[172:175]
  v_mfma_f32_16x16x32_bf16 v[176:179], v[204:207], v[152:155], v[176:179]
  s_add_u32 m0, s22, 4096
  s_add_u32 s21, s21, 4096
  v_xor_b32 v222, 128, v221
  buffer_load_dwordx4 v222, s[4:7], s21 offen nt lds
  v_mfma_f32_16x16x32_bf16 v[160:163], v[208:211], v[28:31], v[160:163]
  v_mfma_f32_16x16x32_bf16 v[164:167], v[208:211], v[60:63], v[164:167]
  v_mfma_f32_16x16x32_bf16 v[168:171], v[208:211], v[92:95], v[168:171]
  v_mfma_f32_16x16x32_bf16 v[172:175], v[208:211], v[124:127], v[172:175]
  v_mfma_f32_16x16x32_bf16 v[176:179], v[208:211], v[156:159], v[176:179]
  v_xor_b32 v223, 160, v221
  buffer_load_dwordx4 v223, s[4:7], s21 offen offset:1024 nt lds
  v_xor_b32 v222, 192, v221
  buffer_load_dwordx4 v222, s[4:7], s21 offen offset:2048 nt lds
  s_nop 3
  v_fma_f32 v160, v160, s27, -v212
  v_fma_f32 v161, v161, s27, -v212
  v_fma_f32 v162, v162, s27, -v212
  v_fma_f32 v163, v163, s27, -v212
  v_fma_f32 v164, v164, s27, -v213
  v_fma_f32 v165, v165, s27, -v213
  v_fma_f32 v166, v166, s27, -v213
  v_fma_f32 v167, v167, s27, -v213
  v_fma_f32 v168, v168, s27, -v214
  v_fma_f32 v169, v169, s27, -v214
  v_fma_f32 v170, v170, s27, -v214
  v_fma_f32 v171, v171, s27, -v214
  v_fma_f32 v172, v172, s27, -v215
  v_fma_f32 v173, v173, s27, -v215
  v_fma_f32 v174, v174, s27, -v215
  v_fma_f32 v175, v175, s27, -v215
  v_fma_f32 v176, v176, s27, -v216
  v_fma_f32 v177, v177, s27, -v216
  v_fma_f32 v178, v178, s27, -v216
  v_fma_f32 v179, v179, s27, -v216
  v_xor_b32 v223, 224, v221
  buffer_load_dwordx4 v223, s[4:7], s21 offen offset:3072 nt lds
  v_max3_f32 v226, v160, v161, v162
  v_max3_f32 v227, v163, v164, v165
  v_max3_f32 v226, v226, v166, v167
  v_max3_f32 v227, v227, v168, v169
  v_max3_f32 v226, v226, v170, v171
  v_max3_f32 v227, v227, v172, v173
  v_max3_f32 v226, v226, v174, v175
  v_max3_f32 v227, v227, v176, v177
  v_max3_f32 v226, v226, v178, v179
  v_max_f32 v226, v226, v227
  v_cmp_lt_f32 vcc, s28, v226
  v_mov_b32 v228, s30
  s_cmp_lg_u64 vcc, 0
  s_cselect_b32 s31, 1, 0
  v_mov_b32 v229, s31
  ds_write_b32 v228, v229 offset:16
  v_exp_f32 v230, v160
  v_exp_f32 v231, v161
  v_exp_f32 v232, v162
  v_exp_f32 v233, v163
  s_nop 0
  v_cvt_pk_bf16_f32 v234, v230, v231
  v_cvt_pk_bf16_f32 v235, v232, v233
  ds_write_b64 v224, v[234:235] offset:10240
  v_exp_f32 v236, v164
  v_exp_f32 v237, v165
  v_exp_f32 v238, v166
  v_exp_f32 v239, v167
  s_nop 0
  v_cvt_pk_bf16_f32 v240, v236, v237
  v_cvt_pk_bf16_f32 v241, v238, v239
  ds_write_b64 v224, v[240:241] offset:11264
  v_exp_f32 v230, v168
  v_exp_f32 v231, v169
  v_exp_f32 v232, v170
  v_exp_f32 v233, v171
  s_nop 0
  v_cvt_pk_bf16_f32 v234, v230, v231
  v_cvt_pk_bf16_f32 v235, v232, v233
  ds_write_b64 v224, v[234:235] offset:12288
  v_exp_f32 v236, v172
  v_exp_f32 v237, v173
  v_exp_f32 v238, v174
  v_exp_f32 v239, v175
  s_nop 0
  v_cvt_pk_bf16_f32 v240, v236, v237
  v_cvt_pk_bf16_f32 v241, v238, v239
  ds_write_b64 v224, v[240:241] offset:13312
  v_exp_f32 v230, v176
  v_exp_f32 v231, v177
  v_exp_f32 v232, v178
  v_exp_f32 v233, v179
  s_nop 0
  v_cvt_pk_bf16_f32 v234, v230, v231
  v_cvt_pk_bf16_f32 v235, v232, v233
  ds_write_b64 v224, v[234:235] offset:14336
  s_waitcnt vmcnt(8) lgkmcnt(0)
  s_barrier
  v_mov_b32 v226, 151552
  ds_read_b128 v[228:231], v226 offset:16
  ds_read_b128 v[180:183], v217 offset:8192
  ds_read_b128 v[184:187], v218 offset:8192
  ds_read_b128 v[188:191], v219 offset:8192
  ds_read_b128 v[192:195], v220 offset:8192
  ds_read_b128 v[196:199], v217 offset:8448
  ds_read_b128 v[200:203], v218 offset:8448
  ds_read_b128 v[204:207], v219 offset:8448
  ds_read_b128 v[208:211], v220 offset:8448
  s_waitcnt lgkmcnt(8)
  v_or3_b32 v228, v228, v229, v230
  v_or_b32 v228, v228, v231
  v_cmp_ne_u32 vcc, 0, v228
  s_mov_b32 s25, 3
  s_mov_b32 s24, 10240
  s_cbranch_vccnz L_slow_qk_B
L_back_8:
  s_waitcnt lgkmcnt(7)
  v_mfma_f32_16x16x32_bf16 v[160:163], v[180:183], v[0:3], 0
  v_mfma_f32_16x16x32_bf16 v[164:167], v[180:183], v[32:35], 0
  v_mfma_f32_16x16x32_bf16 v[168:171], v[180:183], v[64:67], 0
  v_mfma_f32_16x16x32_bf16 v[172:175], v[180:183], v[96:99], 0
  v_mfma_f32_16x16x32_bf16 v[176:179], v[180:183], v[128:131], 0
  s_waitcnt lgkmcnt(6)
  v_mfma_f32_16x16x32_bf16 v[160:163], v[184:187], v[4:7], v[160:163]
  v_mfma_f32_16x16x32_bf16 v[164:167], v[184:187], v[36:39], v[164:167]
  v_mfma_f32_16x16x32_bf16 v[168:171], v[184:187], v[68:71], v[168:171]
  v_mfma_f32_16x16x32_bf16 v[172:175], v[184:187], v[100:103], v[172:175]
  v_mfma_f32_16x16x32_bf16 v[176:179], v[184:187], v[132:135], v[176:179]
  s_waitcnt lgkmcnt(5)
  v_mfma_f32_16x16x32_bf16 v[160:163], v[188:191], v[8:11], v[160:163]
  v_mfma_f32_16x16x32_bf16 v[164:167], v[188:191], v[40:43], v[164:167]
  v_mfma_f32_16x16x32_bf16 v[168:171], v[188:191], v[72:75], v[168:171]
  v_mfma_f32_16x16x32_bf16 v[172:175], v[188:191], v[104:107], v[172:175]
  v_mfma_f32_16x16x32_bf16 v[176:179], v[188:191], v[136:139], v[176:179]
  s_waitcnt lgkmcnt(4)
  v_mfma_f32_16x16x32_bf16 v[160:163], v[192:195], v[12:15], v[160:163]
  v_mfma_f32_16x16x32_bf16 v[164:167], v[192:195], v[44:47], v[164:167]
  v_mfma_f32_16x16x32_bf16 v[168:171], v[192:195], v[76:79], v[168:171]
  v_mfma_f32_16x16x32_bf16 v[172:175], v[192:195], v[108:111], v[172:175]
  v_mfma_f32_16x16x32_bf16 v[176:179], v[192:195], v[140:143], v[176:179]
  s_waitcnt lgkmcnt(3)
  v_mfma_f32_16x16x32_bf16 v[160:163], v[196:199], v[16:19], v[160:163]
  v_mfma_f32_16x16x32_bf16 v[164:167], v[196:199], v[48:51], v[164:167]
  v_mfma_f32_16x16x32_bf16 v[168:171], v[196:199], v[80:83], v[168:171]
  v_mfma_f32_16x16x32_bf16 v[172:175], v[196:199], v[112:115], v[172:175]
  v_mfma_f32_16x16x32_bf16 v[176:179], v[196:199], v[144:147], v[176:179]
  s_waitcnt lgkmcnt(2)
  v_mfma_f32_16x16x32_bf16 v[160:163], v[200:203], v[20:23], v[160:163]
  v_mfma_f32_16x16x32_bf16 v[164:167], v[200:203], v[52:55], v[164:167]
  v_mfma_f32_16x16x32_bf16 v[168:171], v[200:203], v[84:87], v[168:171]
  v_mfma_f32_16x16x32_bf16 v[172:175], v[200:203], v[116:119], v[172:175]
  v_mfma_f32_16x16x32_bf16 v[176:179], v[200:203], v[148:151], v[176:179]
  s_waitcnt lgkmcnt(1)
  v_mfma_f32_16x16x32_bf16 v[160:163], v[204:207], v[24:27], v[160:163]
  v_mfma_f32_16x16x32_bf16 v[164:167], v[204:207], v[56:59], v[164:167]
  v_mfma_f32_16x16x32_bf16 v[168:171], v[204:207], v[88:91], v[168:171]
  v_mfma_f32_16x16x32_bf16 v[172:175], v[204:207], v[120:123], v[172:175]
  v_mfma_f32_16x16x32_bf16 v[176:179], v[204:207], v[152:155], v[176:179]
  s_waitcnt lgkmcnt(0)
  v_mfma_f32_16x16x32_bf16 v[160:163], v[208:211], v[28:31], v[160:163]
  v_mfma_f32_16x16x32_bf16 v[164:167], v[208:211], v[60:63], v[164:167]
  v_mfma_f32_16x16x32_bf16 v[168:171], v[208:211], v[92:95], v[168:171]
  v_mfma_f32_16x16x32_bf16 v[172:175], v[208:211], v[124:127], v[172:175]
  v_mfma_f32_16x16x32_bf16 v[176:179], v[208:211], v[156:159], v[176:179]
  s_nop 3
  v_fma_f32 v160, v160, s27, -v212
  v_fma_f32 v161, v161, s27, -v212
  v_fma_f32 v162, v162, s27, -v212
  v_fma_f32 v163, v163, s27, -v212
  v_fma_f32 v164, v164, s27, -v213
  v_fma_f32 v165, v165, s27, -v213
  v_fma_f32 v166, v166, s27, -v213
  v_fma_f32 v167, v167, s27, -v213
  v_fma_f32 v168, v168, s27, -v214
  v_fma_f32 v169, v169, s27, -v214
  v_fma_f32 v170, v170, s27, -v214
  v_fma_f32 v171, v171, s27, -v214
  v_fma_f32 v172, v172, s27, -v215
  v_fma_f32 v173, v173, s27, -v215
  v_fma_f32 v174, v174, s27, -v215
  v_fma_f32 v175, v175, s27, -v215
  v_fma_f32 v176, v176, s27, -v216
  v_fma_f32 v177, v177, s27, -v216
  v_fma_f32 v178, v178, s27, -v216
  v_fma_f32 v179, v179, s27, -v216
  v_max3_f32 v226, v160, v161, v162
  v_max3_f32 v227, v163, v164, v165
  v_max3_f32 v226, v226, v166, v167
  v_max3_f32 v227, v227, v168, v169
  v_max3_f32 v226, v226, v170, v171
  v_max3_f32 v227, v227, v172, v173
  v_max3_f32 v226, v226, v174, v175
  v_max3_f32 v227, v227, v176, v177
  v_max3_f32 v226, v226, v178, v179
  v_max_f32 v226, v226, v227
  v_cmp_lt_f32 vcc, s28, v226
  v_mov_b32 v228, s30
  s_cmp_lg_u64 vcc, 0
  s_cselect_b32 s31, 1, 0
  v_mov_b32 v229, s31
  ds_write_b32 v228, v229 offset:0
  v_exp_f32 v230, v160
  v_exp_f32 v231, v161
  v_exp_f32 v232, v162
  v_exp_f32 v233, v163
  s_nop 0
  v_cvt_pk_bf16_f32 v234, v230, v231
  v_cvt_pk_bf16_f32 v235, v232, v233
  ds_write_b64 v224, v[234:235] offset:0
  v_exp_f32 v236, v164
  v_exp_f32 v237, v165
  v_exp_f32 v238, v166
  v_exp_f32 v239, v167
  s_nop 0
  v_cvt_pk_bf16_f32 v240, v236, v237
  v_cvt_pk_bf16_f32 v241, v238, v239
  ds_write_b64 v224, v[240:241] offset:1024
  v_exp_f32 v230, v168
  v_exp_f32 v231, v169
  v_exp_f32 v232, v170
  v_exp_f32 v233, v171
  s_nop 0
  v_cvt_pk_bf16_f32 v234, v230, v231
  v_cvt_pk_bf16_f32 v235, v232, v233
  ds_write_b64 v224, v[234:235] offset:2048
  v_exp_f32 v236, v172
  v_exp_f32 v237, v173
  v_exp_f32 v238, v174
  v_exp_f32 v239, v175
  s_nop 0
  v_cvt_pk_bf16_f32 v240, v236, v237
  v_cvt_pk_bf16_f32 v241, v238, v239
  ds_write_b64 v224, v[240:241] offset:3072
  v_exp_f32 v230, v176
  v_exp_f32 v231, v177
  v_exp_f32 v232, v178
  v_exp_f32 v233, v179
  s_nop 0
  v_cvt_pk_bf16_f32 v234, v230, v231
  v_cvt_pk_bf16_f32 v235, v232, v233
  ds_write_b64 v224, v[234:235] offset:4096
  s_waitcnt vmcnt(0) lgkmcnt(0)
  s_barrier
  s_mul_i32 s46, s49, 458752
  s_mul_i32 s47, s51, 28672
  s_add_u32 s46, s46, s47
  s_mul_i32 s47, s16, 7168
  s_add_u32 s46, s46, s47
  v_lshlrev_b32 v250, 7, v255
  buffer_load_dword v251, v250, s[8:11], s46 offen
  v_mov_b32 v226, 151552
  ds_read_b128 v[228:231], v226 offset:0
  ds_read_b128 v[180:183], v217
  ds_read_b128 v[184:187], v218
  ds_read_b128 v[188:191], v219
  ds_read_b128 v[192:195], v220
  ds_read_b128 v[196:199], v217 offset:256
  ds_read_b128 v[200:203], v218 offset:256
  ds_read_b128 v[204:207], v219 offset:256
  ds_read_b128 v[208:211], v220 offset:256
  s_waitcnt lgkmcnt(8)
  v_or3_b32 v228, v228, v229, v230
  v_or_b32 v228, v228, v231
  v_cmp_ne_u32 vcc, 0, v228
  s_mov_b32 s25, 4
  s_mov_b32 s24, 0
  s_cbranch_vccnz L_slow_qk_B
L_back_9:
  s_waitcnt lgkmcnt(7)
  v_mfma_f32_16x16x32_bf16 v[160:163], v[180:183], v[0:3], 0
  v_mfma_f32_16x16x32_bf16 v[164:167], v[180:183], v[32:35], 0
  v_mfma_f32_16x16x32_bf16 v[168:171], v[180:183], v[64:67], 0
  v_mfma_f32_16x16x32_bf16 v[172:175], v[180:183], v[96:99], 0
  v_mfma_f32_16x16x32_bf16 v[176:179], v[180:183], v[128:131], 0
  s_waitcnt lgkmcnt(6)
  v_mfma_f32_16x16x32_bf16 v[160:163], v[184:187], v[4:7], v[160:163]
  v_mfma_f32_16x16x32_bf16 v[164:167], v[184:187], v[36:39], v[164:167]
  v_mfma_f32_16x16x32_bf16 v[168:171], v[184:187], v[68:71], v[168:171]
  v_mfma_f32_16x16x32_bf16 v[172:175], v[184:187], v[100:103], v[172:175]
  v_mfma_f32_16x16x32_bf16 v[176:179], v[184:187], v[132:135], v[176:179]
  s_waitcnt lgkmcnt(5)
  v_mfma_f32_16x16x32_bf16 v[160:163], v[188:191], v[8:11], v[160:163]
  v_mfma_f32_16x16x32_bf16 v[164:167], v[188:191], v[40:43], v[164:167]
  v_mfma_f32_16x16x32_bf16 v[168:171], v[188:191], v[72:75], v[168:171]
  v_mfma_f32_16x16x32_bf16 v[172:175], v[188:191], v[104:107], v[172:175]
  v_mfma_f32_16x16x32_bf16 v[176:179], v[188:191], v[136:139], v[176:179]
  s_waitcnt lgkmcnt(4)
  v_mfma_f32_16x16x32_bf16 v[160:163], v[192:195], v[12:15], v[160:163]
  v_mfma_f32_16x16x32_bf16 v[164:167], v[192:195], v[44:47], v[164:167]
  v_mfma_f32_16x16x32_bf16 v[168:171], v[192:195], v[76:79], v[168:171]
  v_mfma_f32_16x16x32_bf16 v[172:175], v[192:195], v[108:111], v[172:175]
  v_mfma_f32_16x16x32_bf16 v[176:179], v[192:195], v[140:143], v[176:179]
  s_waitcnt lgkmcnt(3)
  v_mfma_f32_16x16x32_bf16 v[160:163], v[196:199], v[16:19], v[160:163]
  v_mfma_f32_16x16x32_bf16 v[164:167], v[196:199], v[48:51], v[164:167]
  v_mfma_f32_16x16x32_bf16 v[168:171], v[196:199], v[80:83], v[168:171]
  v_mfma_f32_16x16x32_bf16 v[172:175], v[196:199], v[112:115], v[172:175]
  v_mfma_f32_16x16x32_bf16 v[176:179], v[196:199], v[144:147], v[176:179]
  s_waitcnt lgkmcnt(2)
  v_mfma_f32_16x16x32_bf16 v[160:163], v[200:203], v[20:23], v[160:163]
  v_mfma_f32_16x16x32_bf16 v[164:167], v[200:203], v[52:55], v[164:167]
  v_mfma_f32_16x16x32_bf16 v[168:171], v[200:203], v[84:87], v[168:171]
  v_mfma_f32_16x16x32_bf16 v[172:175], v[200:203], v[116:119], v[172:175]
  v_mfma_f32_16x16x32_bf16 v[176:179], v[200:203], v[148:151], v[176:179]
  s_waitcnt lgkmcnt(1)
  v_mfma_f32_16x16x32_bf16 v[160:163], v[204:207], v[24:27], v[160:163]
  v_mfma_f32_16x16x32_bf16 v[164:167], v[204:207], v[56:59], v[164:167]
  v_mfma_f32_16x16x32_bf16 v[168:171], v[204:207], v[88:91], v[168:171]
  v_mfma_f32_16x16x32_bf16 v[172:175], v[204:207], v[120:123], v[172:175]
  v_mfma_f32_16x16x32_bf16 v[176:179], v[204:207], v[152:155], v[176:179]
  s_waitcnt lgkmcnt(0)
  v_mfma_f32_16x16x32_bf16 v[160:163], v[208:211], v[28:31], v[160:163]
  v_mfma_f32_16x16x32_bf16 v[164:167], v[208:211], v[60:63], v[164:167]
  v_mfma_f32_16x16x32_bf16 v[168:171], v[208:211], v[92:95], v[168:171]
  v_mfma_f32_16x16x32_bf16 v[172:175], v[208:211], v[124:127], v[172:175]
  v_mfma_f32_16x16x32_bf16 v[176:179], v[208:211], v[156:159], v[176:179]
  s_nop 3
  v_fma_f32 v160, v160, s27, -v212
  v_fma_f32 v161, v161, s27, -v212
  v_fma_f32 v162, v162, s27, -v212
  v_fma_f32 v163, v163, s27, -v212
  v_fma_f32 v164, v164, s27, -v213
  v_fma_f32 v165, v165, s27, -v213
  v_fma_f32 v166, v166, s27, -v213
  v_fma_f32 v167, v167, s27, -v213
  v_fma_f32 v168, v168, s27, -v214
  v_fma_f32 v169, v169, s27, -v214
  v_fma_f32 v170, v170, s27, -v214
  v_fma_f32 v171, v171, s27, -v214
  v_fma_f32 v172, v172, s27, -v215
  v_fma_f32 v173, v173, s27, -v215
  v_fma_f32 v174, v174, s27, -v215
  v_fma_f32 v175, v175, s27, -v215
  v_fma_f32 v176, v176, s27, -v216
  v_fma_f32 v177, v177, s27, -v216
  v_fma_f32 v178, v178, s27, -v216
  v_fma_f32 v179, v179, s27, -v216
  v_max3_f32 v226, v160, v161, v162
  v_max3_f32 v227, v163, v164, v165
  v_max3_f32 v226, v226, v166, v167
  v_max3_f32 v227, v227, v168, v169
  v_max3_f32 v226, v226, v170, v171
  v_max3_f32 v227, v227, v172, v173
  v_max3_f32 v226, v226, v174, v175
  v_max3_f32 v227, v227, v176, v177
  v_max3_f32 v226, v226, v178, v179
  v_max_f32 v226, v226, v227
  v_cmp_lt_f32 vcc, s28, v226
  v_mov_b32 v228, s30
  s_cmp_lg_u64 vcc, 0
  s_cselect_b32 s31, 1, 0
  v_mov_b32 v229, s31
  ds_write_b32 v228, v229 offset:16
  v_exp_f32 v230, v160
  v_exp_f32 v231, v161
  v_exp_f32 v232, v162
  v_exp_f32 v233, v163
  s_nop 0
  v_cvt_pk_bf16_f32 v234, v230, v231
  v_cvt_pk_bf16_f32 v235, v232, v233
  ds_write_b64 v224, v[234:235] offset:10240
  v_exp_f32 v236, v164
  v_exp_f32 v237, v165
  v_exp_f32 v238, v166
  v_exp_f32 v239, v167
  s_nop 0
  v_cvt_pk_bf16_f32 v240, v236, v237
  v_cvt_pk_bf16_f32 v241, v238, v239
  ds_write_b64 v224, v[240:241] offset:11264
  v_exp_f32 v230, v168
  v_exp_f32 v231, v169
  v_exp_f32 v232, v170
  v_exp_f32 v233, v171
  s_nop 0
  v_cvt_pk_bf16_f32 v234, v230, v231
  v_cvt_pk_bf16_f32 v235, v232, v233
  ds_write_b64 v224, v[234:235] offset:12288
  v_exp_f32 v236, v172
  v_exp_f32 v237, v173
  v_exp_f32 v238, v174
  v_exp_f32 v239, v175
  s_nop 0
  v_cvt_pk_bf16_f32 v240, v236, v237
  v_cvt_pk_bf16_f32 v241, v238, v239
  ds_write_b64 v224, v[240:241] offset:13312
  v_exp_f32 v230, v176
  v_exp_f32 v231, v177
  v_exp_f32 v232, v178
  v_exp_f32 v233, v179
  s_nop 0
  v_cvt_pk_bf16_f32 v234, v230, v231
  v_cvt_pk_bf16_f32 v235, v232, v233
  ds_write_b64 v224, v[234:235] offset:14336
  s_waitcnt lgkmcnt(0)
  s_barrier
  v_mov_b32 v226, 151552
  ds_read_b128 v[228:231], v226 offset:16
  s_waitcnt lgkmcnt(0)
  v_or3_b32 v228, v228, v229, v230
  v_or_b32 v228, v228, v231
  v_cmp_ne_u32 vcc, 0, v228
  s_mov_b32 s25, 5
  s_mov_b32 s24, 10240
  s_cbranch_vccnz L_slow_qk_B
L_back_10:
  v_lshrrev_b32 v152, 3, v255
  v_and_b32 v153, 6, v152
  v_mul_u32_u24 v152, 896, v152
  v_and_b32 v250, 7, v255
  v_xor_b32 v250, v250, v153
  v_lshl_add_u32 v250, v250, 4, v152
  s_mul_i32 s44, s49, 458752
  s_mul_i32 s46, s16, 7168
  s_add_u32 s44, s44, s46
  s_lshl_b32 s45, s16, 10
  s_add_u32 m0, s45, 0
  s_add_u32 s46, s44, 0
  buffer_load_dwordx4 v250, s[8:11], s46 offen lds
  s_add_u32 m0, s45, 4096
  s_add_u32 s46, s44, 128
  buffer_load_dwordx4 v250, s[8:11], s46 offen lds
  s_add_u32 m0, s45, 8192
  s_add_u32 s46, s44, 256
  buffer_load_dwordx4 v250, s[8:11], s46 offen lds
  s_add_u32 m0, s45, 12288
  s_add_u32 s46, s44, 384
  buffer_load_dwordx4 v250, s[8:11], s46 offen lds
  s_add_u32 m0, s45, 16384
  s_add_u32 s46, s44, 512
  buffer_load_dwordx4 v250, s[8:11], s46 offen lds
  s_add_u32 m0, s45, 20480
  s_add_u32 s46, s44, 640
  buffer_load_dwordx4 v250, s[8:11], s46 offen lds
  s_add_u32 m0, s45, 24576
  s_add_u32 s46, s44, 768
  buffer_load_dwordx4 v250, s[8:11], s46 offen lds
  s_add_u32 m0, s45, 28672
  s_add_u32 s46, s44, 28672
  buffer_load_dwordx4 v250, s[8:11], s46 offen lds
  s_add_u32 m0, s45, 32768
  s_add_u32 s46, s44, 28800
  buffer_load_dwordx4 v250, s[8:11], s46 offen lds
  s_add_u32 m0, s45, 36864
  s_add_u32 s46, s44, 28928
  buffer_load_dwordx4 v250, s[8:11], s46 offen lds
  s_add_u32 m0, s45, 40960
  s_add_u32 s46, s44, 29056
  buffer_load_dwordx4 v250, s[8:11], s46 offen lds
  s_add_u32 m0, s45, 45056
  s_add_u32 s46, s44, 29184
  buffer_load_dwordx4 v250, s[8:11], s46 offen lds
  s_add_u32 m0, s45, 49152
  s_add_u32 s46, s44, 29312
  buffer_load_dwordx4 v250, s[8:11], s46 offen lds
  s_add_u32 m0, s45, 53248
  s_add_u32 s46, s44, 29440
  buffer_load_dwordx4 v250, s[8:11], s46 offen lds
  v_and_b32 v152, 15, v255
  v_lshrrev_b32 v153, 4, v255
  v_lshrrev_b32 v154, 2, v152
  v_lshl_add_u32 v155, v153, 2, v154
  v_and_b32 v154, 6, v155
  v_lshlrev_b32 v155, 7, v155
  v_and_b32 v223, 1, v152
  v_lshl_add_u32 v155, v223, 3, v155
  v_bfe_u32 v153, v152, 1, 1
  v_xor_b32 v154, v154, v153
  s_mul_i32 s46, s16, 14
  s_add_u32 s46, s46, 0
  s_and_b32 s47, s46, 7
  s_lshr_b32 s46, s46, 3
  s_lshl_b32 s46, s46, 12
  v_xor_b32 v216, s47, v154
  v_lshl_add_u32 v216, v216, 4, v155
  v_add_u32 v216, s46, v216
  s_mul_i32 s46, s16, 14
  s_add_u32 s46, s46, 2
  s_and_b32 s47, s46, 7
  s_lshr_b32 s46, s46, 3
  s_lshl_b32 s46, s46, 12
  v_xor_b32 v217, s47, v154
  v_lshl_add_u32 v217, v217, 4, v155
  v_add_u32 v217, s46, v217
  s_mul_i32 s46, s16, 14
  s_add_u32 s46, s46, 4
  s_and_b32 s47, s46, 7
  s_lshr_b32 s46, s46, 3
  s_lshl_b32 s46, s46, 12
  v_xor_b32 v218, s47, v154
  v_lshl_add_u32 v218, v218, 4, v155
  v_add_u32 v218, s46, v218
  s_mul_i32 s46, s16, 14
  s_add_u32 s46, s46, 6
  s_and_b32 s47, s46, 7
  s_lshr_b32 s46, s46, 3
  s_lshl_b32 s46, s46, 12
  v_xor_b32 v219, s47, v154
  v_lshl_add_u32 v219, v219, 4, v155
  v_add_u32 v219, s46, v219
  s_mul_i32 s46, s16, 14
  s_add_u32 s46, s46, 8
  s_and_b32 s47, s46, 7
  s_lshr_b32 s46, s46, 3
  s_lshl_b32 s46, s46, 12
  v_xor_b32 v220, s47, v154
  v_lshl_add_u32 v220, v220, 4, v155
  v_add_u32 v220, s46, v220
  s_mul_i32 s46, s16, 14
  s_add_u32 s46, s46, 10
  s_and_b32 s47, s46, 7
  s_lshr_b32 s46, s46, 3
  s_lshl_b32 s46, s46, 12
  v_xor_b32 v221, s47, v154
  v_lshl_add_u32 v221, v221, 4, v155
  v_add_u32 v221, s46, v221
  s_mul_i32 s46, s16, 14
  s_add_u32 s46, s46, 12
  s_and_b32 s47, s46, 7
  s_lshr_b32 s46, s46, 3
  s_lshl_b32 s46, s46, 12
  v_xor_b32 v222, s47, v154
  v_lshl_add_u32 v222, v222, 4, v155
  v_add_u32 v222, s46, v222
  v_lshlrev_b32 v223, 4, v255
  v_add_u32 v223, 86016, v223
  s_waitcnt lgkmcnt(0)
  s_barrier
  s_branch L_attn_kernel_qkepi
L_attn_kernel_qkA:
  s_waitcnt vmcnt(0) lgkmcnt(0)
  s_barrier
  ds_read_b128 v[180:183], v217 offset:8192
  ds_read_b128 v[184:187], v218 offset:8192
  ds_read_b128 v[188:191], v219 offset:8192
  ds_read_b128 v[192:195], v220 offset:8192
  ds_read_b128 v[196:199], v217 offset:8448
  ds_read_b128 v[200:203], v218 offset:8448
  ds_read_b128 v[204:207], v219 offset:8448
  ds_read_b128 v[208:211], v220 offset:8448
  s_waitcnt lgkmcnt(7)
  v_mfma_f32_16x16x32_bf16 v[160:163], v[180:183], v[0:3], 0
  v_mfma_f32_16x16x32_bf16 v[164:167], v[180:183], v[32:35], 0
  v_mfma_f32_16x16x32_bf16 v[168:171], v[180:183], v[64:67], 0
  v_mfma_f32_16x16x32_bf16 v[172:175], v[180:183], v[96:99], 0
  v_mfma_f32_16x16x32_bf16 v[176:179], v[180:183], v[128:131], 0
  s_waitcnt lgkmcnt(6)
  v_mfma_f32_16x16x32_bf16 v[160:163], v[184:187], v[4:7], v[160:163]
  v_mfma_f32_16x16x32_bf16 v[164:167], v[184:187], v[36:39], v[164:167]
  v_mfma_f32_16x16x32_bf16 v[168:171], v[184:187], v[68:71], v[168:171]
  v_mfma_f32_16x16x32_bf16 v[172:175], v[184:187], v[100:103], v[172:175]
  v_mfma_f32_16x16x32_bf16 v[176:179], v[184:187], v[132:135], v[176:179]
  s_and_b32 s21, s20, 31
  s_lshl_b32 s21, s21, 14
  s_lshl_b32 s31, s17, 12
  s_add_u32 s21, s21, s31
  s_add_u32 m0, s22, 0
  s_add_u32 s20, s20, 1
  buffer_load_dwordx4 v221, s[4:7], s21 offen nt lds
  s_waitcnt lgkmcnt(5)
  v_mfma_f32_16x16x32_bf16 v[160:163], v[188:191], v[8:11], v[160:163]
  v_mfma_f32_16x16x32_bf16 v[164:167], v[188:191], v[40:43], v[164:167]
  v_mfma_f32_16x16x32_bf16 v[168:171], v[188:191], v[72:75], v[168:171]
  v_mfma_f32_16x16x32_bf16 v[172:175], v[188:191], v[104:107], v[172:175]
  v_mfma_f32_16x16x32_bf16 v[176:179], v[188:191], v[136:139], v[176:179]
  v_xor_b32 v223, 32, v221
  buffer_load_dwordx4 v223, s[4:7], s21 offen offset:1024 nt lds
  s_waitcnt lgkmcnt(4)
  v_mfma_f32_16x16x32_bf16 v[160:163], v[192:195], v[12:15], v[160:163]
  v_mfma_f32_16x16x32_bf16 v[164:167], v[192:195], v[44:47], v[164:167]
  v_mfma_f32_16x16x32_bf16 v[168:171], v[192:195], v[76:79], v[168:171]
  v_mfma_f32_16x16x32_bf16 v[172:175], v[192:195], v[108:111], v[172:175]
  v_mfma_f32_16x16x32_bf16 v[176:179], v[192:195], v[140:143], v[176:179]
  v_xor_b32 v222, 64, v221
  buffer_load_dwordx4 v222, s[4:7], s21 offen offset:2048 nt lds
  s_waitcnt lgkmcnt(3)
  v_mfma_f32_16x16x32_bf16 v[160:163], v[196:199], v[16:19], v[160:163]
  v_mfma_f32_16x16x32_bf16 v[164:167], v[196:199], v[48:51], v[164:167]
  v_mfma_f32_16x16x32_bf16 v[168:171], v[196:199], v[80:83], v[168:171]
  v_mfma_f32_16x16x32_bf16 v[172:175], v[196:199], v[112:115], v[172:175]
  v_mfma_f32_16x16x32_bf16 v[176:179], v[196:199], v[144:147], v[176:179]
  v_xor_b32 v223, 96, v221
  buffer_load_dwordx4 v223, s[4:7], s21 offen offset:3072 nt lds
  s_waitcnt lgkmcnt(2)
  v_mfma_f32_16x16x32_bf16 v[160:163], v[200:203], v[20:23], v[160:163]
  v_mfma_f32_16x16x32_bf16 v[164:167], v[200:203], v[52:55], v[164:167]
  v_mfma_f32_16x16x32_bf16 v[168:171], v[200:203], v[84:87], v[168:171]
  v_mfma_f32_16x16x32_bf16 v[172:175], v[200:203], v[116:119], v[172:175]
  v_mfma_f32_16x16x32_bf16 v[176:179], v[200:203], v[148:151], v[176:179]
  s_waitcnt lgkmcnt(1)
  v_mfma_f32_16x16x32_bf16 v[160:163], v[204:207], v[24:27], v[160:163]
  v_mfma_f32_16x16x32_bf16 v[164:167], v[204:207], v[56:59], v[164:167]
  v_mfma_f32_16x16x32_bf16 v[168:171], v[204:207], v[88:91], v[168:171]
  v_mfma_f32_16x16x32_bf16 v[172:175], v[204:207], v[120:123], v[172:175]
  v_mfma_f32_16x16x32_bf16 v[176:179], v[204:207], v[152:155], v[176:179]
  s_waitcnt lgkmcnt(0)
  v_mfma_f32_16x16x32_bf16 v[160:163], v[208:211], v[28:31], v[160:163]
  v_mfma_f32_16x16x32_bf16 v[164:167], v[208:211], v[60:63], v[164:167]
  v_mfma_f32_16x16x32_bf16 v[168:171], v[208:211], v[92:95], v[168:171]
  v_mfma_f32_16x16x32_bf16 v[172:175], v[208:211], v[124:127], v[172:175]
  v_mfma_f32_16x16x32_bf16 v[176:179], v[208:211], v[156:159], v[176:179]
  s_nop 3
  v_fma_f32 v160, v160, s27, -v212
  v_fma_f32 v161, v161, s27, -v212
  v_fma_f32 v162, v162, s27, -v212
  v_fma_f32 v163, v163, s27, -v212
  v_fma_f32 v164, v164, s27, -v213
  v_fma_f32 v165, v165, s27, -v213
  v_fma_f32 v166, v166, s27, -v213
  v_fma_f32 v167, v167, s27, -v213
  v_fma_f32 v168, v168, s27, -v214
  v_fma_f32 v169, v169, s27, -v214
  v_fma_f32 v170, v170, s27, -v214
  v_fma_f32 v171, v171, s27, -v214
  v_fma_f32 v172, v172, s27, -v215
  v_fma_f32 v173, v173, s27, -v215
  v_fma_f32 v174, v174, s27, -v215
  v_fma_f32 v175, v175, s27, -v215
  v_fma_f32 v176, v176, s27, -v216
  v_fma_f32 v177, v177, s27, -v216
  v_fma_f32 v178, v178, s27, -v216
  v_fma_f32 v179, v179, s27, -v216
  v_max3_f32 v226, v160, v161, v162
  v_max3_f32 v227, v163, v164, v165
  v_max3_f32 v226, v226, v166, v167
  v_max3_f32 v227, v227, v168, v169
  v_max3_f32 v226, v226, v170, v171
  v_max3_f32 v227, v227, v172, v173
  v_max3_f32 v226, v226, v174, v175
  v_max3_f32 v227, v227, v176, v177
  v_max3_f32 v226, v226, v178, v179
  v_max_f32 v226, v226, v227
  v_cmp_lt_f32 vcc, s28, v226
  v_mov_b32 v228, s30
  v_mov_b32 v229, 1
  ds_write_b32 v228, v229 offset:0
  v_exp_f32 v230, v160
  v_exp_f32 v231, v161
  v_exp_f32 v232, v162
  v_exp_f32 v233, v163
  s_nop 0
  v_cvt_pk_bf16_f32 v234, v230, v231
  v_cvt_pk_bf16_f32 v235, v232, v233
  ds_write_b64 v224, v[234:235] offset:0
  v_exp_f32 v236, v164
  v_exp_f32 v237, v165
  v_exp_f32 v238, v166
  v_exp_f32 v239, v167
  s_nop 0
  v_cvt_pk_bf16_f32 v240, v236, v237
  v_cvt_pk_bf16_f32 v241, v238, v239
  ds_write_b64 v224, v[240:241] offset:1024
  v_exp_f32 v230, v168
  v_exp_f32 v231, v169
  v_exp_f32 v232, v170
  v_exp_f32 v233, v171
  s_nop 0
  v_cvt_pk_bf16_f32 v234, v230, v231
  v_cvt_pk_bf16_f32 v235, v232, v233
  ds_write_b64 v224, v[234:235] offset:2048
  v_exp_f32 v236, v172
  v_exp_f32 v237, v173
  v_exp_f32 v238, v174
  v_exp_f32 v239, v175
  s_nop 0
  v_cvt_pk_bf16_f32 v240, v236, v237
  v_cvt_pk_bf16_f32 v241, v238, v239
  ds_write_b64 v224, v[240:241] offset:3072
  v_exp_f32 v230, v176
  v_exp_f32 v231, v177
  v_exp_f32 v232, v178
  v_exp_f32 v233, v179
  s_nop 0
  v_cvt_pk_bf16_f32 v234, v230, v231
  v_cvt_pk_bf16_f32 v235, v232, v233
  ds_write_b64 v224, v[234:235] offset:4096
  s_waitcnt vmcnt(0) lgkmcnt(0)
  s_barrier
  s_mov_b32 s23, 15
L_qk_A_11:
  v_mov_b32 v226, 151552
  ds_read_b128 v[228:231], v226 offset:0
  ds_read_b128 v[180:183], v217
  ds_read_b128 v[184:187], v218
  ds_read_b128 v[188:191], v219
  ds_read_b128 v[192:195], v220
  ds_read_b128 v[196:199], v217 offset:256
  ds_read_b128 v[200:203], v218 offset:256
  ds_read_b128 v[204:207], v219 offset:256
  ds_read_b128 v[208:211], v220 offset:256
  s_waitcnt lgkmcnt(8)
  v_or3_b32 v228, v228, v229, v230
  v_or_b32 v228, v228, v231
  v_cmp_ne_u32 vcc, 0, v228
  s_mov_b32 s25, 0
  s_mov_b32 s24, 0
  s_cbranch_vccnz L_slow_qk_A
L_back_12:
  s_waitcnt lgkmcnt(7)
  v_mfma_f32_16x16x32_bf16 v[160:163], v[180:183], v[0:3], 0
  v_mfma_f32_16x16x32_bf16 v[164:167], v[180:183], v[32:35], 0
  v_mfma_f32_16x16x32_bf16 v[168:171], v[180:183], v[64:67], 0
  v_mfma_f32_16x16x32_bf16 v[172:175], v[180:183], v[96:99], 0
  v_mfma_f32_16x16x32_bf16 v[176:179], v[180:183], v[128:131], 0
  s_waitcnt lgkmcnt(6)
  v_mfma_f32_16x16x32_bf16 v[160:163], v[184:187], v[4:7], v[160:163]
  v_mfma_f32_16x16x32_bf16 v[164:167], v[184:187], v[36:39], v[164:167]
  v_mfma_f32_16x16x32_bf16 v[168:171], v[184:187], v[68:71], v[168:171]
  v_mfma_f32_16x16x32_bf16 v[172:175], v[184:187], v[100:103], v[172:175]
  v_mfma_f32_16x16x32_bf16 v[176:179], v[184:187], v[132:135], v[176:179]
  s_and_b32 s21, s20, 31
  s_lshl_b32 s21, s21, 14
  s_lshl_b32 s31, s17, 12
  s_add_u32 s21, s21, s31
  s_add_u32 m0, s22, 8192
  s_add_u32 s20, s20, 1
  buffer_load_dwordx4 v221, s[4:7], s21 offen nt lds
  s_waitcnt lgkmcnt(5)
  v_mfma_f32_16x16x32_bf16 v[160:163], v[188:191], v[8:11], v[160:163]
  v_mfma_f32_16x16x32_bf16 v[164:167], v[188:191], v[40:43], v[164:167]
  v_mfma_f32_16x16x32_bf16 v[168:171], v[188:191], v[72:75], v[168:171]
  v_mfma_f32_16x16x32_bf16 v[172:175], v[188:191], v[104:107], v[172:175]
  v_mfma_f32_16x16x32_bf16 v[176:179], v[188:191], v[136:139], v[176:179]
  v_xor_b32 v223, 32, v221
  buffer_load_dwordx4 v223, s[4:7], s21 offen offset:1024 nt lds
  s_waitcnt lgkmcnt(4)
  v_mfma_f32_16x16x32_bf16 v[160:163], v[192:195], v[12:15], v[160:163]
  v_mfma_f32_16x16x32_bf16 v[164:167], v[192:195], v[44:47], v[164:167]
  v_mfma_f32_16x16x32_bf16 v[168:171], v[192:195], v[76:79], v[168:171]
  v_mfma_f32_16x16x32_bf16 v[172:175], v[192:195], v[108:111], v[172:175]
  v_mfma_f32_16x16x32_bf16 v[176:179], v[192:195], v[140:143], v[176:179]
  v_xor_b32 v222, 64, v221
  buffer_load_dwordx4 v222, s[4:7], s21 offen offset:2048 nt lds
  s_waitcnt lgkmcnt(3)
  v_mfma_f32_16x16x32_bf16 v[160:163], v[196:199], v[16:19], v[160:163]
  v_mfma_f32_16x16x32_bf16 v[164:167], v[196:199], v[48:51], v[164:167]
  v_mfma_f32_16x16x32_bf16 v[168:171], v[196:199], v[80:83], v[168:171]
  v_mfma_f32_16x16x32_bf16 v[172:175], v[196:199], v[112:115], v[172:175]
  v_mfma_f32_16x16x32_bf16 v[176:179], v[196:199], v[144:147], v[176:179]
  v_xor_b32 v223, 96, v221
  buffer_load_dwordx4 v223, s[4:7], s21 offen offset:3072 nt lds
  s_waitcnt lgkmcnt(2)
  v_mfma_f32_16x16x32_bf16 v[160:163], v[200:203], v[20:23], v[160:163]
  v_mfma_f32_16x16x32_bf16 v[164:167], v[200:203], v[52:55], v[164:167]
  v_mfma_f32_16x16x32_bf16 v[168:171], v[200:203], v[84:87], v[168:171]
  v_mfma_f32_16x16x32_bf16 v[172:175], v[200:203], v[116:119], v[172:175]
  v_mfma_f32_16x16x32_bf16 v[176:179], v[200:203], v[148:151], v[176:179]
  s_waitcnt lgkmcnt(1)
  v_mfma_f32_16x16x32_bf16 v[160:163], v[204:207], v[24:27], v[160:163]
  v_mfma_f32_16x16x32_bf16 v[164:167], v[204:207], v[56:59], v[164:167]
  v_mfma_f32_16x16x32_bf16 v[168:171], v[204:207], v[88:91], v[168:171]
  v_mfma_f32_16x16x32_bf16 v[172:175], v[204:207], v[120:123], v[172:175]
  v_mfma_f32_16x16x32_bf16 v[176:179], v[204:207], v[152:155], v[176:179]
  s_waitcnt lgkmcnt(0)
  v_mfma_f32_16x16x32_bf16 v[160:163], v[208:211], v[28:31], v[160:163]
  v_mfma_f32_16x16x32_bf16 v[164:167], v[208:211], v[60:63], v[164:167]
  v_mfma_f32_16x16x32_bf16 v[168:171], v[208:211], v[92:95], v[168:171]
  v_mfma_f32_16x16x32_bf16 v[172:175], v[208:211], v[124:127], v[172:175]
  v_mfma_f32_16x16x32_bf16 v[176:179], v[208:211], v[156:159], v[176:179]
  s_nop 3
  v_fma_f32 v160, v160, s27, -v212
  v_fma_f32 v161, v161, s27, -v212
  v_fma_f32 v162, v162, s27, -v212
  v_fma_f32 v163, v163, s27, -v212
  v_fma_f32 v164, v164, s27, -v213
  v_fma_f32 v165, v165, s27, -v213
  v_fma_f32 v166, v166, s27, -v213
  v_fma_f32 v167, v167, s27, -v213
  v_fma_f32 v168, v168, s27, -v214
  v_fma_f32 v169, v169, s27, -v214
  v_fma_f32 v170, v170, s27, -v214
  v_fma_f32 v171, v171, s27, -v214
  v_fma_f32 v172, v172, s27, -v215
  v_fma_f32 v173, v173, s27, -v215
  v_fma_f32 v174, v174, s27, -v215
  v_fma_f32 v175, v175, s27, -v215
  v_fma_f32 v176, v176, s27, -v216
  v_fma_f32 v177, v177, s27, -v216
  v_fma_f32 v178, v178, s27, -v216
  v_fma_f32 v179, v179, s27, -v216
  v_max3_f32 v226, v160, v161, v162
  v_max3_f32 v227, v163, v164, v165
  v_max3_f32 v226, v226, v166, v167
  v_max3_f32 v227, v227, v168, v169
  v_max3_f32 v226, v226, v170, v171
  v_max3_f32 v227, v227, v172, v173
  v_max3_f32 v226, v226, v174, v175
  v_max3_f32 v227, v227, v176, v177
  v_max3_f32 v226, v226, v178, v179
  v_max_f32 v226, v226, v227
  v_cmp_lt_f32 vcc, s28, v226
  v_mov_b32 v228, s30
  s_cmp_lg_u64 vcc, 0
  s_cselect_b32 s31, 1, 0
  v_mov_b32 v229, s31
  ds_write_b32 v228, v229 offset:16
  v_exp_f32 v230, v160
  v_exp_f32 v231, v161
  v_exp_f32 v232, v162
  v_exp_f32 v233, v163
  s_nop 0
  v_cvt_pk_bf16_f32 v234, v230, v231
  v_cvt_pk_bf16_f32 v235, v232, v233
  ds_write_b64 v224, v[234:235] offset:10240
  v_exp_f32 v236, v164
  v_exp_f32 v237, v165
  v_exp_f32 v238, v166
  v_exp_f32 v239, v167
  s_nop 0
  v_cvt_pk_bf16_f32 v240, v236, v237
  v_cvt_pk_bf16_f32 v241, v238, v239
  ds_write_b64 v224, v[240:241] offset:11264
  v_exp_f32 v230, v168
  v_exp_f32 v231, v169
  v_exp_f32 v232, v170
  v_exp_f32 v233, v171
  s_nop 0
  v_cvt_pk_bf16_f32 v234, v230, v231
  v_cvt_pk_bf16_f32 v235, v232, v233
  ds_write_b64 v224, v[234:235] offset:12288
  v_exp_f32 v236, v172
  v_exp_f32 v237, v173
  v_exp_f32 v238, v174
  v_exp_f32 v239, v175
  s_nop 0
  v_cvt_pk_bf16_f32 v240, v236, v237
  v_cvt_pk_bf16_f32 v241, v238, v239
  ds_write_b64 v224, v[240:241] offset:13312
  v_exp_f32 v230, v176
  v_exp_f32 v231, v177
  v_exp_f32 v232, v178
  v_exp_f32 v233, v179
  s_nop 0
  v_cvt_pk_bf16_f32 v234, v230, v231
  v_cvt_pk_bf16_f32 v235, v232, v233
  ds_write_b64 v224, v[234:235] offset:14336
  s_waitcnt vmcnt(0) lgkmcnt(0)
  s_barrier
  v_mov_b32 v226, 151552
  ds_read_b128 v[228:231], v226 offset:16
  ds_read_b128 v[180:183], v217 offset:8192
  ds_read_b128 v[184:187], v218 offset:8192
  ds_read_b128 v[188:191], v219 offset:8192
  ds_read_b128 v[192:195], v220 offset:8192
  ds_read_b128 v[196:199], v217 offset:8448
  ds_read_b128 v[200:203], v218 offset:8448
  ds_read_b128 v[204:207], v219 offset:8448
  ds_read_b128 v[208:211], v220 offset:8448
  s_waitcnt lgkmcnt(8)
  v_or3_b32 v228, v228, v229, v230
  v_or_b32 v228, v228, v231
  v_cmp_ne_u32 vcc, 0, v228
  s_mov_b32 s25, 1
  s_mov_b32 s24, 10240
  s_cbranch_vccnz L_slow_qk_A
L_back_13:
  s_waitcnt lgkmcnt(7)
  v_mfma_f32_16x16x32_bf16 v[160:163], v[180:183], v[0:3], 0
  v_mfma_f32_16x16x32_bf16 v[164:167], v[180:183], v[32:35], 0
  v_mfma_f32_16x16x32_bf16 v[168:171], v[180:183], v[64:67], 0
  v_mfma_f32_16x16x32_bf16 v[172:175], v[180:183], v[96:99], 0
  v_mfma_f32_16x16x32_bf16 v[176:179], v[180:183], v[128:131], 0
  s_waitcnt lgkmcnt(6)
  v_mfma_f32_16x16x32_bf16 v[160:163], v[184:187], v[4:7], v[160:163]
  v_mfma_f32_16x16x32_bf16 v[164:167], v[184:187], v[36:39], v[164:167]
  v_mfma_f32_16x16x32_bf16 v[168:171], v[184:187], v[68:71], v[168:171]
  v_mfma_f32_16x16x32_bf16 v[172:175], v[184:187], v[100:103], v[172:175]
  v_mfma_f32_16x16x32_bf16 v[176:179], v[184:187], v[132:135], v[176:179]
  s_and_b32 s21, s20, 31
  s_lshl_b32 s21, s21, 14
  s_lshl_b32 s31, s17, 12
  s_add_u32 s21, s21, s31
  s_add_u32 m0, s22, 0
  s_add_u32 s20, s20, 1
  buffer_load_dwordx4 v221, s[4:7], s21 offen nt lds
  s_waitcnt lgkmcnt(5)
  v_mfma_f32_16x16x32_bf16 v[160:163], v[188:191], v[8:11], v[160:163]
  v_mfma_f32_16x16x32_bf16 v[164:167], v[188:191], v[40:43], v[164:167]
  v_mfma_f32_16x16x32_bf16 v[168:171], v[188:191], v[72:75], v[168:171]
  v_mfma_f32_16x16x32_bf16 v[172:175], v[188:191], v[104:107], v[172:175]
  v_mfma_f32_16x16x32_bf16 v[176:179], v[188:191], v[136:139], v[176:179]
  v_xor_b32 v223, 32, v221
  buffer_load_dwordx4 v223, s[4:7], s21 offen offset:1024 nt lds
  s_waitcnt lgkmcnt(4)
  v_mfma_f32_16x16x32_bf16 v[160:163], v[192:195], v[12:15], v[160:163]
  v_mfma_f32_16x16x32_bf16 v[164:167], v[192:195], v[44:47], v[164:167]
  v_mfma_f32_16x16x32_bf16 v[168:171], v[192:195], v[76:79], v[168:171]
  v_mfma_f32_16x16x32_bf16 v[172:175], v[192:195], v[108:111], v[172:175]
  v_mfma_f32_16x16x32_bf16 v[176:179], v[192:195], v[140:143], v[176:179]
  v_xor_b32 v222, 64, v221
  buffer_load_dwordx4 v222, s[4:7], s21 offen offset:2048 nt lds
  s_waitcnt lgkmcnt(3)
  v_mfma_f32_16x16x32_bf16 v[160:163], v[196:199], v[16:19], v[160:163]
  v_mfma_f32_16x16x32_bf16 v[164:167], v[196:199], v[48:51], v[164:167]
  v_mfma_f32_16x16x32_bf16 v[168:171], v[196:199], v[80:83], v[168:171]
  v_mfma_f32_16x16x32_bf16 v[172:175], v[196:199], v[112:115], v[172:175]
  v_mfma_f32_16x16x32_bf16 v[176:179], v[196:199], v[144:147], v[176:179]
  v_xor_b32 v223, 96, v221
  buffer_load_dwordx4 v223, s[4:7], s21 offen offset:3072 nt lds
  s_waitcnt lgkmcnt(2)
  v_mfma_f32_16x16x32_bf16 v[160:163], v[200:203], v[20:23], v[160:163]
  v_mfma_f32_16x16x32_bf16 v[164:167], v[200:203], v[52:55], v[164:167]
  v_mfma_f32_16x16x32_bf16 v[168:171], v[200:203], v[84:87], v[168:171]
  v_mfma_f32_16x16x32_bf16 v[172:175], v[200:203], v[116:119], v[172:175]
  v_mfma_f32_16x16x32_bf16 v[176:179], v[200:203], v[148:151], v[176:179]
  s_waitcnt lgkmcnt(1)
  v_mfma_f32_16x16x32_bf16 v[160:163], v[204:207], v[24:27], v[160:163]
  v_mfma_f32_16x16x32_bf16 v[164:167], v[204:207], v[56:59], v[164:167]
  v_mfma_f32_16x16x32_bf16 v[168:171], v[204:207], v[88:91], v[168:171]
  v_mfma_f32_16x16x32_bf16 v[172:175], v[204:207], v[120:123], v[172:175]
  v_mfma_f32_16x16x32_bf16 v[176:179], v[204:207], v[152:155], v[176:179]
  s_waitcnt lgkmcnt(0)
  v_mfma_f32_16x16x32_bf16 v[160:163], v[208:211], v[28:31], v[160:163]
  v_mfma_f32_16x16x32_bf16 v[164:167], v[208:211], v[60:63], v[164:167]
  v_mfma_f32_16x16x32_bf16 v[168:171], v[208:211], v[92:95], v[168:171]
  v_mfma_f32_16x16x32_bf16 v[172:175], v[208:211], v[124:127], v[172:175]
  v_mfma_f32_16x16x32_bf16 v[176:179], v[208:211], v[156:159], v[176:179]
  s_nop 3
  v_fma_f32 v160, v160, s27, -v212
  v_fma_f32 v161, v161, s27, -v212
  v_fma_f32 v162, v162, s27, -v212
  v_fma_f32 v163, v163, s27, -v212
  v_fma_f32 v164, v164, s27, -v213
  v_fma_f32 v165, v165, s27, -v213
  v_fma_f32 v166, v166, s27, -v213
  v_fma_f32 v167, v167, s27, -v213
  v_fma_f32 v168, v168, s27, -v214
  v_fma_f32 v169, v169, s27, -v214
  v_fma_f32 v170, v170, s27, -v214
  v_fma_f32 v171, v171, s27, -v214
  v_fma_f32 v172, v172, s27, -v215
  v_fma_f32 v173, v173, s27, -v215
  v_fma_f32 v174, v174, s27, -v215
  v_fma_f32 v175, v175, s27, -v215
  v_fma_f32 v176, v176, s27, -v216
  v_fma_f32 v177, v177, s27, -v216
  v_fma_f32 v178, v178, s27, -v216
  v_fma_f32 v179, v179, s27, -v216
  v_max3_f32 v226, v160, v161, v162
  v_max3_f32 v227, v163, v164, v165
  v_max3_f32 v226, v226, v166, v167
  v_max3_f32 v227, v227, v168, v169
  v_max3_f32 v226, v226, v170, v171
  v_max3_f32 v227, v227, v172, v173
  v_max3_f32 v226, v226, v174, v175
  v_max3_f32 v227, v227, v176, v177
  v_max3_f32 v226, v226, v178, v179
  v_max_f32 v226, v226, v227
  v_cmp_lt_f32 vcc, s28, v226
  v_mov_b32 v228, s30
  s_cmp_lg_u64 vcc, 0
  s_cselect_b32 s31, 1, 0
  v_mov_b32 v229, s31
  ds_write_b32 v228, v229 offset:0
  v_exp_f32 v230, v160
  v_exp_f32 v231, v161
  v_exp_f32 v232, v162
  v_exp_f32 v233, v163
  s_nop 0
  v_cvt_pk_bf16_f32 v234, v230, v231
  v_cvt_pk_bf16_f32 v235, v232, v233
  ds_write_b64 v224, v[234:235] offset:0
  v_exp_f32 v236, v164
  v_exp_f32 v237, v165
  v_exp_f32 v238, v166
  v_exp_f32 v239, v167
  s_nop 0
  v_cvt_pk_bf16_f32 v240, v236, v237
  v_cvt_pk_bf16_f32 v241, v238, v239
  ds_write_b64 v224, v[240:241] offset:1024
  v_exp_f32 v230, v168
  v_exp_f32 v231, v169
  v_exp_f32 v232, v170
  v_exp_f32 v233, v171
  s_nop 0
  v_cvt_pk_bf16_f32 v234, v230, v231
  v_cvt_pk_bf16_f32 v235, v232, v233
  ds_write_b64 v224, v[234:235] offset:2048
  v_exp_f32 v236, v172
  v_exp_f32 v237, v173
  v_exp_f32 v238, v174
  v_exp_f32 v239, v175
  s_nop 0
  v_cvt_pk_bf16_f32 v240, v236, v237
  v_cvt_pk_bf16_f32 v241, v238, v239
  ds_write_b64 v224, v[240:241] offset:3072
  v_exp_f32 v230, v176
  v_exp_f32 v231, v177
  v_exp_f32 v232, v178
  v_exp_f32 v233, v179
  s_nop 0
  v_cvt_pk_bf16_f32 v234, v230, v231
  v_cvt_pk_bf16_f32 v235, v232, v233
  ds_write_b64 v224, v[234:235] offset:4096
  s_waitcnt vmcnt(0) lgkmcnt(0)
  s_barrier
  s_sub_u32 s23, s23, 1
  s_cmp_lg_u32 s23, 0
  s_cbranch_scc1 L_qk_A_11
  s_mul_i32 s46, s49, 458752
  s_mul_i32 s47, s51, 28672
  s_add_u32 s46, s46, s47
  s_mul_i32 s47, s16, 7168
  s_add_u32 s46, s46, s47
  v_lshlrev_b32 v250, 7, v255
  buffer_load_dword v251, v250, s[8:11], s46 offen
  v_mov_b32 v226, 151552
  ds_read_b128 v[228:231], v226 offset:0
  ds_read_b128 v[180:183], v217
  ds_read_b128 v[184:187], v218
  ds_read_b128 v[188:191], v219
  ds_read_b128 v[192:195], v220
  ds_read_b128 v[196:199], v217 offset:256
  ds_read_b128 v[200:203], v218 offset:256
  ds_read_b128 v[204:207], v219 offset:256
  ds_read_b128 v[208:211], v220 offset:256
  s_waitcnt lgkmcnt(8)
  v_or3_b32 v228, v228, v229, v230
  v_or_b32 v228, v228, v231
  v_cmp_ne_u32 vcc, 0, v228
  s_mov_b32 s25, 2
  s_mov_b32 s24, 0
  s_cbranch_vccnz L_slow_qk_A
L_back_14:
  s_waitcnt lgkmcnt(7)
  v_mfma_f32_16x16x32_bf16 v[160:163], v[180:183], v[0:3], 0
  v_mfma_f32_16x16x32_bf16 v[164:167], v[180:183], v[32:35], 0
  v_mfma_f32_16x16x32_bf16 v[168:171], v[180:183], v[64:67], 0
  v_mfma_f32_16x16x32_bf16 v[172:175], v[180:183], v[96:99], 0
  v_mfma_f32_16x16x32_bf16 v[176:179], v[180:183], v[128:131], 0
  s_waitcnt lgkmcnt(6)
  v_mfma_f32_16x16x32_bf16 v[160:163], v[184:187], v[4:7], v[160:163]
  v_mfma_f32_16x16x32_bf16 v[164:167], v[184:187], v[36:39], v[164:167]
  v_mfma_f32_16x16x32_bf16 v[168:171], v[184:187], v[68:71], v[168:171]
  v_mfma_f32_16x16x32_bf16 v[172:175], v[184:187], v[100:103], v[172:175]
  v_mfma_f32_16x16x32_bf16 v[176:179], v[184:187], v[132:135], v[176:179]
  s_waitcnt lgkmcnt(5)
  v_mfma_f32_16x16x32_bf16 v[160:163], v[188:191], v[8:11], v[160:163]
  v_mfma_f32_16x16x32_bf16 v[164:167], v[188:191], v[40:43], v[164:167]
  v_mfma_f32_16x16x32_bf16 v[168:171], v[188:191], v[72:75], v[168:171]
  v_mfma_f32_16x16x32_bf16 v[172:175], v[188:191], v[104:107], v[172:175]
  v_mfma_f32_16x16x32_bf16 v[176:179], v[188:191], v[136:139], v[176:179]
  s_waitcnt lgkmcnt(4)
  v_mfma_f32_16x16x32_bf16 v[160:163], v[192:195], v[12:15], v[160:163]
  v_mfma_f32_16x16x32_bf16 v[164:167], v[192:195], v[44:47], v[164:167]
  v_mfma_f32_16x16x32_bf16 v[168:171], v[192:195], v[76:79], v[168:171]
  v_mfma_f32_16x16x32_bf16 v[172:175], v[192:195], v[108:111], v[172:175]
  v_mfma_f32_16x16x32_bf16 v[176:179], v[192:195], v[140:143], v[176:179]
  s_waitcnt lgkmcnt(3)
  v_mfma_f32_16x16x32_bf16 v[160:163], v[196:199], v[16:19], v[160:163]
  v_mfma_f32_16x16x32_bf16 v[164:167], v[196:199], v[48:51], v[164:167]
  v_mfma_f32_16x16x32_bf16 v[168:171], v[196:199], v[80:83], v[168:171]
  v_mfma_f32_16x16x32_bf16 v[172:175], v[196:199], v[112:115], v[172:175]
  v_mfma_f32_16x16x32_bf16 v[176:179], v[196:199], v[144:147], v[176:179]
  s_waitcnt lgkmcnt(2)
  v_mfma_f32_16x16x32_bf16 v[160:163], v[200:203], v[20:23], v[160:163]
  v_mfma_f32_16x16x32_bf16 v[164:167], v[200:203], v[52:55], v[164:167]
  v_mfma_f32_16x16x32_bf16 v[168:171], v[200:203], v[84:87], v[168:171]
  v_mfma_f32_16x16x32_bf16 v[172:175], v[200:203], v[116:119], v[172:175]
  v_mfma_f32_16x16x32_bf16 v[176:179], v[200:203], v[148:151], v[176:179]
  s_waitcnt lgkmcnt(1)
  v_mfma_f32_16x16x32_bf16 v[160:163], v[204:207], v[24:27], v[160:163]
  v_mfma_f32_16x16x32_bf16 v[164:167], v[204:207], v[56:59], v[164:167]
  v_mfma_f32_16x16x32_bf16 v[168:171], v[204:207], v[88:91], v[168:171]
  v_mfma_f32_16x16x32_bf16 v[172:175], v[204:207], v[120:123], v[172:175]
  v_mfma_f32_16x16x32_bf16 v[176:179], v[204:207], v[152:155], v[176:179]
  s_waitcnt lgkmcnt(0)
  v_mfma_f32_16x16x32_bf16 v[160:163], v[208:211], v[28:31], v[160:163]
  v_mfma_f32_16x16x32_bf16 v[164:167], v[208:211], v[60:63], v[164:167]
  v_mfma_f32_16x16x32_bf16 v[168:171], v[208:211], v[92:95], v[168:171]
  v_mfma_f32_16x16x32_bf16 v[172:175], v[208:211], v[124:127], v[172:175]
  v_mfma_f32_16x16x32_bf16 v[176:179], v[208:211], v[156:159], v[176:179]
  s_nop 3
  v_fma_f32 v160, v160, s27, -v212
  v_fma_f32 v161, v161, s27, -v212
  v_fma_f32 v162, v162, s27, -v212
  v_fma_f32 v163, v163, s27, -v212
  v_fma_f32 v164, v164, s27, -v213
  v_fma_f32 v165, v165, s27, -v213
  v_fma_f32 v166, v166, s27, -v213
  v_fma_f32 v167, v167, s27, -v213
  v_fma_f32 v168, v168, s27, -v214
  v_fma_f32 v169, v169, s27, -v214
  v_fma_f32 v170, v170, s27, -v214
  v_fma_f32 v171, v171, s27, -v214
  v_fma_f32 v172, v172, s27, -v215
  v_fma_f32 v173, v173, s27, -v215
  v_fma_f32 v174, v174, s27, -v215
  v_fma_f32 v175, v175, s27, -v215
  v_fma_f32 v176, v176, s27, -v216
  v_fma_f32 v177, v177, s27, -v216
  v_fma_f32 v178, v178, s27, -v216
  v_fma_f32 v179, v179, s27, -v216
  v_max3_f32 v226, v160, v161, v162
  v_max3_f32 v227, v163, v164, v165
  v_max3_f32 v226, v226, v166, v167
  v_max3_f32 v227, v227, v168, v169
  v_max3_f32 v226, v226, v170, v171
  v_max3_f32 v227, v227, v172, v173
  v_max3_f32 v226, v226, v174, v175
  v_max3_f32 v227, v227, v176, v177
  v_max3_f32 v226, v226, v178, v179
  v_max_f32 v226, v226, v227
  v_cmp_lt_f32 vcc, s28, v226
  v_mov_b32 v228, s30
  s_cmp_lg_u64 vcc, 0
  s_cselect_b32 s31, 1, 0
  v_mov_b32 v229, s31
  ds_write_b32 v228, v229 offset:16
  v_exp_f32 v230, v160
  v_exp_f32 v231, v161
  v_exp_f32 v232, v162
  v_exp_f32 v233, v163
  s_nop 0
  v_cvt_pk_bf16_f32 v234, v230, v231
  v_cvt_pk_bf16_f32 v235, v232, v233
  ds_write_b64 v224, v[234:235] offset:10240
  v_exp_f32 v236, v164
  v_exp_f32 v237, v165
  v_exp_f32 v238, v166
  v_exp_f32 v239, v167
  s_nop 0
  v_cvt_pk_bf16_f32 v240, v236, v237
  v_cvt_pk_bf16_f32 v241, v238, v239
  ds_write_b64 v224, v[240:241] offset:11264
  v_exp_f32 v230, v168
  v_exp_f32 v231, v169
  v_exp_f32 v232, v170
  v_exp_f32 v233, v171
  s_nop 0
  v_cvt_pk_bf16_f32 v234, v230, v231
  v_cvt_pk_bf16_f32 v235, v232, v233
  ds_write_b64 v224, v[234:235] offset:12288
  v_exp_f32 v236, v172
  v_exp_f32 v237, v173
  v_exp_f32 v238, v174
  v_exp_f32 v239, v175
  s_nop 0
  v_cvt_pk_bf16_f32 v240, v236, v237
  v_cvt_pk_bf16_f32 v241, v238, v239
  ds_write_b64 v224, v[240:241] offset:13312
  v_exp_f32 v230, v176
  v_exp_f32 v231, v177
  v_exp_f32 v232, v178
  v_exp_f32 v233, v179
  s_nop 0
  v_cvt_pk_bf16_f32 v234, v230, v231
  v_cvt_pk_bf16_f32 v235, v232, v233
  ds_write_b64 v224, v[234:235] offset:14336
  s_waitcnt lgkmcnt(0)
  s_barrier
  v_mov_b32 v226, 151552
  ds_read_b128 v[228:231], v226 offset:16
  s_waitcnt lgkmcnt(0)
  v_or3_b32 v228, v228, v229, v230
  v_or_b32 v228, v228, v231
  v_cmp_ne_u32 vcc, 0, v228
  s_mov_b32 s25, 3
  s_mov_b32 s24, 10240
  s_cbranch_vccnz L_slow_qk_A
L_back_15:
  v_lshrrev_b32 v152, 3, v255
  v_and_b32 v153, 6, v152
  v_mul_u32_u24 v152, 896, v152
  v_and_b32 v250, 7, v255
  v_xor_b32 v250, v250, v153
  v_lshl_add_u32 v250, v250, 4, v152
  s_mul_i32 s44, s49, 458752
  s_mul_i32 s46, s16, 7168
  s_add_u32 s44, s44, s46
  s_lshl_b32 s45, s16, 10
  s_add_u32 m0, s45, 0
  s_add_u32 s46, s44, 0
  buffer_load_dwordx4 v250, s[8:11], s46 offen lds
  s_add_u32 m0, s45, 4096
  s_add_u32 s46, s44, 128
  buffer_load_dwordx4 v250, s[8:11], s46 offen lds
  s_add_u32 m0, s45, 8192
  s_add_u32 s46, s44, 256
  buffer_load_dwordx4 v250, s[8:11], s46 offen lds
  s_add_u32 m0, s45, 12288
  s_add_u32 s46, s44, 384
  buffer_load_dwordx4 v250, s[8:11], s46 offen lds
  s_add_u32 m0, s45, 16384
  s_add_u32 s46, s44, 512
  buffer_load_dwordx4 v250, s[8:11], s46 offen lds
  s_add_u32 m0, s45, 20480
  s_add_u32 s46, s44, 640
  buffer_load_dwordx4 v250, s[8:11], s46 offen lds
  s_add_u32 m0, s45, 24576
  s_add_u32 s46, s44, 768
  buffer_load_dwordx4 v250, s[8:11], s46 offen lds
  s_add_u32 m0, s45, 28672
  s_add_u32 s46, s44, 28672
  buffer_load_dwordx4 v250, s[8:11], s46 offen lds
  s_add_u32 m0, s45, 32768
  s_add_u32 s46, s44, 28800
  buffer_load_dwordx4 v250, s[8:11], s46 offen lds
  s_add_u32 m0, s45, 36864
  s_add_u32 s46, s44, 28928
  buffer_load_dwordx4 v250, s[8:11], s46 offen lds
  s_add_u32 m0, s45, 40960
  s_add_u32 s46, s44, 29056
  buffer_load_dwordx4 v250, s[8:11], s46 offen lds
  s_add_u32 m0, s45, 45056
  s_add_u32 s46, s44, 29184
  buffer_load_dwordx4 v250, s[8:11], s46 offen lds
  s_add_u32 m0, s45, 49152
  s_add_u32 s46, s44, 29312
  buffer_load_dwordx4 v250, s[8:11], s46 offen lds
  s_add_u32 m0, s45, 53248
  s_add_u32 s46, s44, 29440
  buffer_load_dwordx4 v250, s[8:11], s46 offen lds
  v_and_b32 v152, 15, v255
  v_lshrrev_b32 v153, 4, v255
  v_lshrrev_b32 v154, 2, v152
  v_lshl_add_u32 v155, v153, 2, v154
  v_and_b32 v154, 6, v155
  v_lshlrev_b32 v155, 7, v155
  v_and_b32 v223, 1, v152
  v_lshl_add_u32 v155, v223, 3, v155
  v_bfe_u32 v153, v152, 1, 1
  v_xor_b32 v154, v154, v153
  s_mul_i32 s46, s16, 14
  s_add_u32 s46, s46, 0
  s_and_b32 s47, s46, 7
  s_lshr_b32 s46, s46, 3
  s_lshl_b32 s46, s46, 12
  v_xor_b32 v216, s47, v154
  v_lshl_add_u32 v216, v216, 4, v155
  v_add_u32 v216, s46, v216
  s_mul_i32 s46, s16, 14
  s_add_u32 s46, s46, 2
  s_and_b32 s47, s46, 7
  s_lshr_b32 s46, s46, 3
  s_lshl_b32 s46, s46, 12
  v_xor_b32 v217, s47, v154
  v_lshl_add_u32 v217, v217, 4, v155
  v_add_u32 v217, s46, v217
  s_mul_i32 s46, s16, 14
  s_add_u32 s46, s46, 4
  s_and_b32 s47, s46, 7
  s_lshr_b32 s46, s46, 3
  s_lshl_b32 s46, s46, 12
  v_xor_b32 v218, s47, v154
  v_lshl_add_u32 v218, v218, 4, v155
  v_add_u32 v218, s46, v218
  s_mul_i32 s46, s16, 14
  s_add_u32 s46, s46, 6
  s_and_b32 s47, s46, 7
  s_lshr_b32 s46, s46, 3
  s_lshl_b32 s46, s46, 12
  v_xor_b32 v219, s47, v154
  v_lshl_add_u32 v219, v219, 4, v155
  v_add_u32 v219, s46, v219
  s_mul_i32 s46, s16, 14
  s_add_u32 s46, s46, 8
  s_and_b32 s47, s46, 7
  s_lshr_b32 s46, s46, 3
  s_lshl_b32 s46, s46, 12
  v_xor_b32 v220, s47, v154
  v_lshl_add_u32 v220, v220, 4, v155
  v_add_u32 v220, s46, v220
  s_mul_i32 s46, s16, 14
  s_add_u32 s46, s46, 10
  s_and_b32 s47, s46, 7
  s_lshr_b32 s46, s46, 3
  s_lshl_b32 s46, s46, 12
  v_xor_b32 v221, s47, v154
  v_lshl_add_u32 v221, v221, 4, v155
  v_add_u32 v221, s46, v221
  s_mul_i32 s46, s16, 14
  s_add_u32 s46, s46, 12
  s_and_b32 s47, s46, 7
  s_lshr_b32 s46, s46, 3
  s_lshl_b32 s46, s46, 12
  v_xor_b32 v222, s47, v154
  v_lshl_add_u32 v222, v222, 4, v155
  v_add_u32 v222, s46, v222
  v_lshlrev_b32 v223, 4, v255
  v_add_u32 v223, 86016, v223
  s_waitcnt lgkmcnt(0)
  s_barrier
  s_branch L_attn_kernel_qkepi
L_attn_kernel_qkepi:
  s_setprio 0
  s_add_u32 m0, s45, 57344
  s_add_u32 s46, s44, 57344
  buffer_load_dwordx4 v250, s[8:11], s46 offen lds
  s_add_u32 m0, s45, 61440
  s_add_u32 s46, s44, 57472
  buffer_load_dwordx4 v250, s[8:11], s46 offen lds
  s_add_u32 m0, s45, 65536
  s_add_u32 s46, s44, 57600
  buffer_load_dwordx4 v250, s[8:11], s46 offen lds
  s_add_u32 m0, s45, 69632
  s_add_u32 s46, s44, 57728
  buffer_load_dwordx4 v250, s[8:11], s46 offen lds
  s_add_u32 m0, s45, 73728
  s_add_u32 s46, s44, 57856
  buffer_load_dwordx4 v250, s[8:11], s46 offen lds
  s_add_u32 m0, s45, 77824
  s_add_u32 s46, s44, 57984
  buffer_load_dwordx4 v250, s[8:11], s46 offen lds
  s_add_u32 m0, s45, 81920
  s_add_u32 s46, s44, 58112
  buffer_load_dwordx4 v250, s[8:11], s46 offen lds
  s_waitcnt vmcnt(7)
  s_barrier
  ds_read_b64_tr_b16 v[140:141], v216
  ds_read_b64_tr_b16 v[142:143], v216 offset:2048
  ds_read_b64_tr_b16 v[144:145], v217
  ds_read_b64_tr_b16 v[146:147], v217 offset:2048
  ds_read_b64_tr_b16 v[148:149], v218
  ds_read_b64_tr_b16 v[150:151], v218 offset:2048
  ds_read_b64_tr_b16 v[152:153], v219
  ds_read_b64_tr_b16 v[154:155], v219 offset:2048
  ds_read_b64_tr_b16 v[156:157], v220
  ds_read_b64_tr_b16 v[158:159], v220 offset:2048
  ds_read_b64_tr_b16 v[160:161], v221
  ds_read_b64_tr_b16 v[162:163], v221 offset:2048
  s_waitcnt lgkmcnt(4)
  ds_read_b64_tr_b16 v[164:165], v222
  ds_read_b64_tr_b16 v[166:167], v222 offset:2048
  ds_read_b128 v[176:179], v223 offset:0
  ds_read_b128 v[180:183], v223 offset:4096
  ds_read_b128 v[184:187], v223 offset:8192
  ds_read_b128 v[188:191], v223 offset:12288
  ds_read_b128 v[192:195], v223 offset:16384
  s_waitcnt lgkmcnt(0)
  s_barrier
  v_mfma_f32_16x16x32_bf16 v[0:3], v[140:143], v[176:179], 0
  ds_read_b64_tr_b16 v[168:169], v216 offset:28672
  ds_read_b64_tr_b16 v[170:171], v216 offset:30720
  v_mfma_f32_16x16x32_bf16 v[4:7], v[140:143], v[180:183], 0
  v_mfma_f32_16x16x32_bf16 v[8:11], v[140:143], v[184:187], 0
  ds_read_b64_tr_b16 v[172:173], v217 offset:28672
  ds_read_b64_tr_b16 v[174:175], v217 offset:30720
  v_mfma_f32_16x16x32_bf16 v[12:15], v[140:143], v[188:191], 0
  v_mfma_f32_16x16x32_bf16 v[16:19], v[140:143], v[192:195], 0
  ds_read_b64_tr_b16 v[140:141], v218 offset:28672
  ds_read_b64_tr_b16 v[142:143], v218 offset:30720
  v_mfma_f32_16x16x32_bf16 v[20:23], v[144:147], v[176:179], 0
  v_mfma_f32_16x16x32_bf16 v[24:27], v[144:147], v[180:183], 0
  ds_read_b128 v[196:199], v223 offset:1024
  v_mfma_f32_16x16x32_bf16 v[28:31], v[144:147], v[184:187], 0
  v_mfma_f32_16x16x32_bf16 v[32:35], v[144:147], v[188:191], 0
  v_mfma_f32_16x16x32_bf16 v[36:39], v[144:147], v[192:195], 0
  ds_read_b64_tr_b16 v[144:145], v219 offset:28672
  ds_read_b64_tr_b16 v[146:147], v219 offset:30720
  v_mfma_f32_16x16x32_bf16 v[40:43], v[148:151], v[176:179], 0
  v_mfma_f32_16x16x32_bf16 v[44:47], v[148:151], v[180:183], 0
  ds_read_b128 v[200:203], v223 offset:5120
  v_mfma_f32_16x16x32_bf16 v[48:51], v[148:151], v[184:187], 0
  v_mfma_f32_16x16x32_bf16 v[52:55], v[148:151], v[188:191], 0
  v_mfma_f32_16x16x32_bf16 v[56:59], v[148:151], v[192:195], 0
  ds_read_b64_tr_b16 v[148:149], v220 offset:28672
  ds_read_b64_tr_b16 v[150:151], v220 offset:30720
  v_mfma_f32_16x16x32_bf16 v[60:63], v[152:155], v[176:179], 0
  v_mfma_f32_16x16x32_bf16 v[64:67], v[152:155], v[180:183], 0
  ds_read_b128 v[204:207], v223 offset:9216
  v_mfma_f32_16x16x32_bf16 v[68:71], v[152:155], v[184:187], 0
  v_mfma_f32_16x16x32_bf16 v[72:75], v[152:155], v[188:191], 0
  v_mfma_f32_16x16x32_bf16 v[76:79], v[152:155], v[192:195], 0
  ds_read_b64_tr_b16 v[152:153], v221 offset:28672
  ds_read_b64_tr_b16 v[154:155], v221 offset:30720
  s_waitcnt lgkmcnt(9)
  v_mfma_f32_16x16x32_bf16 v[80:83], v[156:159], v[176:179], 0
  v_mfma_f32_16x16x32_bf16 v[84:87], v[156:159], v[180:183], 0
  ds_read_b128 v[208:211], v223 offset:13312
  v_mfma_f32_16x16x32_bf16 v[88:91], v[156:159], v[184:187], 0
  v_mfma_f32_16x16x32_bf16 v[92:95], v[156:159], v[188:191], 0
  v_mfma_f32_16x16x32_bf16 v[96:99], v[156:159], v[192:195], 0
  ds_read_b64_tr_b16 v[156:157], v222 offset:28672
  ds_read_b64_tr_b16 v[158:159], v222 offset:30720
  v_mfma_f32_16x16x32_bf16 v[100:103], v[160:163], v[176:179], 0
  v_mfma_f32_16x16x32_bf16 v[104:107], v[160:163], v[180:183], 0
  ds_read_b128 v[212:215], v223 offset:17408
  v_mfma_f32_16x16x32_bf16 v[108:111], v[160:163], v[184:187], 0
  v_mfma_f32_16x16x32_bf16 v[112:115], v[160:163], v[188:191], 0
  v_mfma_f32_16x16x32_bf16 v[116:119], v[160:163], v[192:195], 0
  v_mfma_f32_16x16x32_bf16 v[120:123], v[164:167], v[176:179], 0
  v_mfma_f32_16x16x32_bf16 v[124:127], v[164:167], v[180:183], 0
  v_mfma_f32_16x16x32_bf16 v[128:131], v[164:167], v[184:187], 0
  v_mfma_f32_16x16x32_bf16 v[132:135], v[164:167], v[188:191], 0
  v_mfma_f32_16x16x32_bf16 v[136:139], v[164:167], v[192:195], 0
  s_waitcnt lgkmcnt(0)
  s_waitcnt vmcnt(0)
  s_barrier
  v_mfma_f32_16x16x32_bf16 v[0:3], v[168:171], v[196:199], v[0:3]
  ds_read_b64_tr_b16 v[160:161], v216 offset:57344
  ds_read_b64_tr_b16 v[162:163], v216 offset:59392
  v_mfma_f32_16x16x32_bf16 v[4:7], v[168:171], v[200:203], v[4:7]
  v_mfma_f32_16x16x32_bf16 v[8:11], v[168:171], v[204:207], v[8:11]
  ds_read_b64_tr_b16 v[164:165], v217 offset:57344
  ds_read_b64_tr_b16 v[166:167], v217 offset:59392
  v_mfma_f32_16x16x32_bf16 v[12:15], v[168:171], v[208:211], v[12:15]
  v_mfma_f32_16x16x32_bf16 v[16:19], v[168:171], v[212:215], v[16:19]
  ds_read_b64_tr_b16 v[168:169], v218 offset:57344
  ds_read_b64_tr_b16 v[170:171], v218 offset:59392
  v_mfma_f32_16x16x32_bf16 v[20:23], v[172:175], v[196:199], v[20:23]
  v_mfma_f32_16x16x32_bf16 v[24:27], v[172:175], v[200:203], v[24:27]
  ds_read_b128 v[176:179], v223 offset:2048
  v_mfma_f32_16x16x32_bf16 v[28:31], v[172:175], v[204:207], v[28:31]
  v_mfma_f32_16x16x32_bf16 v[32:35], v[172:175], v[208:211], v[32:35]
  v_mfma_f32_16x16x32_bf16 v[36:39], v[172:175], v[212:215], v[36:39]
  ds_read_b64_tr_b16 v[172:173], v219 offset:57344
  ds_read_b64_tr_b16 v[174:175], v219 offset:59392
  v_mfma_f32_16x16x32_bf16 v[40:43], v[140:143], v[196:199], v[40:43]
  v_mfma_f32_16x16x32_bf16 v[44:47], v[140:143], v[200:203], v[44:47]
  ds_read_b128 v[180:183], v223 offset:6144
  v_mfma_f32_16x16x32_bf16 v[48:51], v[140:143], v[204:207], v[48:51]
  v_mfma_f32_16x16x32_bf16 v[52:55], v[140:143], v[208:211], v[52:55]
  v_mfma_f32_16x16x32_bf16 v[56:59], v[140:143], v[212:215], v[56:59]
  ds_read_b64_tr_b16 v[140:141], v220 offset:57344
  ds_read_b64_tr_b16 v[142:143], v220 offset:59392
  v_mfma_f32_16x16x32_bf16 v[60:63], v[144:147], v[196:199], v[60:63]
  v_mfma_f32_16x16x32_bf16 v[64:67], v[144:147], v[200:203], v[64:67]
  ds_read_b128 v[184:187], v223 offset:10240
  v_mfma_f32_16x16x32_bf16 v[68:71], v[144:147], v[204:207], v[68:71]
  v_mfma_f32_16x16x32_bf16 v[72:75], v[144:147], v[208:211], v[72:75]
  v_mfma_f32_16x16x32_bf16 v[76:79], v[144:147], v[212:215], v[76:79]
  ds_read_b64_tr_b16 v[144:145], v221 offset:57344
  ds_read_b64_tr_b16 v[146:147], v221 offset:59392
  s_waitcnt lgkmcnt(9)
  v_mfma_f32_16x16x32_bf16 v[80:83], v[148:151], v[196:199], v[80:83]
  v_mfma_f32_16x16x32_bf16 v[84:87], v[148:151], v[200:203], v[84:87]
  ds_read_b128 v[188:191], v223 offset:14336
  v_mfma_f32_16x16x32_bf16 v[88:91], v[148:151], v[204:207], v[88:91]
  v_mfma_f32_16x16x32_bf16 v[92:95], v[148:151], v[208:211], v[92:95]
  v_mfma_f32_16x16x32_bf16 v[96:99], v[148:151], v[212:215], v[96:99]
  ds_read_b64_tr_b16 v[148:149], v222 offset:57344
  ds_read_b64_tr_b16 v[150:151], v222 offset:59392
  v_mfma_f32_16x16x32_bf16 v[100:103], v[152:155], v[196:199], v[100:103]
  v_mfma_f32_16x16x32_bf16 v[104:107], v[152:155], v[200:203], v[104:107]
  ds_read_b128 v[192:195], v223 offset:18432
  v_mfma_f32_16x16x32_bf16 v[108:111], v[152:155], v[204:207], v[108:111]
  v_mfma_f32_16x16x32_bf16 v[112:115], v[152:155], v[208:211], v[112:115]
  v_mfma_f32_16x16x32_bf16 v[116:119], v[152:155], v[212:215], v[116:119]
  v_mfma_f32_16x16x32_bf16 v[120:123], v[156:159], v[196:199], v[120:123]
  v_mfma_f32_16x16x32_bf16 v[124:127], v[156:159], v[200:203], v[124:127]
  v_mfma_f32_16x16x32_bf16 v[128:131], v[156:159], v[204:207], v[128:131]
  v_mfma_f32_16x16x32_bf16 v[132:135], v[156:159], v[208:211], v[132:135]
  v_mfma_f32_16x16x32_bf16 v[136:139], v[156:159], v[212:215], v[136:139]
  s_waitcnt lgkmcnt(0)
  s_barrier
  v_mfma_f32_16x16x32_bf16 v[0:3], v[160:163], v[176:179], v[0:3]
  ds_read_b64_tr_b16 v[152:153], v216
  ds_read_b64_tr_b16 v[154:155], v216 offset:2048
  v_mfma_f32_16x16x32_bf16 v[4:7], v[160:163], v[180:183], v[4:7]
  v_mfma_f32_16x16x32_bf16 v[8:11], v[160:163], v[184:187], v[8:11]
  ds_read_b64_tr_b16 v[156:157], v217
  ds_read_b64_tr_b16 v[158:159], v217 offset:2048
  v_mfma_f32_16x16x32_bf16 v[12:15], v[160:163], v[188:191], v[12:15]
  v_mfma_f32_16x16x32_bf16 v[16:19], v[160:163], v[192:195], v[16:19]
  ds_read_b64_tr_b16 v[160:161], v218
  ds_read_b64_tr_b16 v[162:163], v218 offset:2048
  v_mfma_f32_16x16x32_bf16 v[20:23], v[164:167], v[176:179], v[20:23]
  v_mfma_f32_16x16x32_bf16 v[24:27], v[164:167], v[180:183], v[24:27]
  ds_read_b128 v[196:199], v223 offset:3072
  v_mfma_f32_16x16x32_bf16 v[28:31], v[164:167], v[184:187], v[28:31]
  v_mfma_f32_16x16x32_bf16 v[32:35], v[164:167], v[188:191], v[32:35]
  v_mfma_f32_16x16x32_bf16 v[36:39], v[164:167], v[192:195], v[36:39]
  ds_read_b64_tr_b16 v[164:165], v219
  ds_read_b64_tr_b16 v[166:167], v219 offset:2048
  v_mfma_f32_16x16x32_bf16 v[40:43], v[168:171], v[176:179], v[40:43]
  v_mfma_f32_16x16x32_bf16 v[44:47], v[168:171], v[180:183], v[44:47]
  ds_read_b128 v[200:203], v223 offset:7168
  v_mfma_f32_16x16x32_bf16 v[48:51], v[168:171], v[184:187], v[48:51]
  v_mfma_f32_16x16x32_bf16 v[52:55], v[168:171], v[188:191], v[52:55]
  v_mfma_f32_16x16x32_bf16 v[56:59], v[168:171], v[192:195], v[56:59]
  ds_read_b64_tr_b16 v[168:169], v220
  ds_read_b64_tr_b16 v[170:171], v220 offset:2048
  v_mfma_f32_16x16x32_bf16 v[60:63], v[172:175], v[176:179], v[60:63]
  v_mfma_f32_16x16x32_bf16 v[64:67], v[172:175], v[180:183], v[64:67]
  ds_read_b128 v[204:207], v223 offset:11264
  v_mfma_f32_16x16x32_bf16 v[68:71], v[172:175], v[184:187], v[68:71]
  v_mfma_f32_16x16x32_bf16 v[72:75], v[172:175], v[188:191], v[72:75]
  v_mfma_f32_16x16x32_bf16 v[76:79], v[172:175], v[192:195], v[76:79]
  ds_read_b64_tr_b16 v[172:173], v221
  ds_read_b64_tr_b16 v[174:175], v221 offset:2048
  s_waitcnt lgkmcnt(9)
  v_mfma_f32_16x16x32_bf16 v[80:83], v[140:143], v[176:179], v[80:83]
  v_mfma_f32_16x16x32_bf16 v[84:87], v[140:143], v[180:183], v[84:87]
  ds_read_b128 v[208:211], v223 offset:15360
  v_mfma_f32_16x16x32_bf16 v[88:91], v[140:143], v[184:187], v[88:91]
  v_mfma_f32_16x16x32_bf16 v[92:95], v[140:143], v[188:191], v[92:95]
  v_mfma_f32_16x16x32_bf16 v[96:99], v[140:143], v[192:195], v[96:99]
  ds_read_b64_tr_b16 v[140:141], v222
  ds_read_b64_tr_b16 v[142:143], v222 offset:2048
  v_mfma_f32_16x16x32_bf16 v[100:103], v[144:147], v[176:179], v[100:103]
  v_mfma_f32_16x16x32_bf16 v[104:107], v[144:147], v[180:183], v[104:107]
  ds_read_b128 v[212:215], v223 offset:19456
  v_mfma_f32_16x16x32_bf16 v[108:111], v[144:147], v[184:187], v[108:111]
  v_mfma_f32_16x16x32_bf16 v[112:115], v[144:147], v[188:191], v[112:115]
  v_mfma_f32_16x16x32_bf16 v[116:119], v[144:147], v[192:195], v[116:119]
  v_mfma_f32_16x16x32_bf16 v[120:123], v[148:151], v[176:179], v[120:123]
  v_mfma_f32_16x16x32_bf16 v[124:127], v[148:151], v[180:183], v[124:127]
  v_mfma_f32_16x16x32_bf16 v[128:131], v[148:151], v[184:187], v[128:131]
  v_mfma_f32_16x16x32_bf16 v[132:135], v[148:151], v[188:191], v[132:135]
  v_mfma_f32_16x16x32_bf16 v[136:139], v[148:151], v[192:195], v[136:139]
  s_waitcnt lgkmcnt(0)
  s_barrier
  v_mfma_f32_16x16x32_bf16 v[0:3], v[152:155], v[196:199], v[0:3]
  ds_read_b64_tr_b16 v[144:145], v216 offset:28672
  ds_read_b64_tr_b16 v[146:147], v216 offset:30720
  v_mfma_f32_16x16x32_bf16 v[4:7], v[152:155], v[200:203], v[4:7]
  v_mfma_f32_16x16x32_bf16 v[8:11], v[152:155], v[204:207], v[8:11]
  ds_read_b64_tr_b16 v[148:149], v217 offset:28672
  ds_read_b64_tr_b16 v[150:151], v217 offset:30720
  v_mfma_f32_16x16x32_bf16 v[12:15], v[152:155], v[208:211], v[12:15]
  v_mfma_f32_16x16x32_bf16 v[16:19], v[152:155], v[212:215], v[16:19]
  ds_read_b64_tr_b16 v[152:153], v218 offset:28672
  ds_read_b64_tr_b16 v[154:155], v218 offset:30720
  v_mfma_f32_16x16x32_bf16 v[20:23], v[156:159], v[196:199], v[20:23]
  v_mfma_f32_16x16x32_bf16 v[24:27], v[156:159], v[200:203], v[24:27]
  ds_read_b128 v[176:179], v223 offset:20480
  v_mfma_f32_16x16x32_bf16 v[28:31], v[156:159], v[204:207], v[28:31]
  v_mfma_f32_16x16x32_bf16 v[32:35], v[156:159], v[208:211], v[32:35]
  v_mfma_f32_16x16x32_bf16 v[36:39], v[156:159], v[212:215], v[36:39]
  ds_read_b64_tr_b16 v[156:157], v219 offset:28672
  ds_read_b64_tr_b16 v[158:159], v219 offset:30720
  v_mfma_f32_16x16x32_bf16 v[40:43], v[160:163], v[196:199], v[40:43]
  v_mfma_f32_16x16x32_bf16 v[44:47], v[160:163], v[200:203], v[44:47]
  ds_read_b128 v[180:183], v223 offset:24576
  v_mfma_f32_16x16x32_bf16 v[48:51], v[160:163], v[204:207], v[48:51]
  v_mfma_f32_16x16x32_bf16 v[52:55], v[160:163], v[208:211], v[52:55]
  v_mfma_f32_16x16x32_bf16 v[56:59], v[160:163], v[212:215], v[56:59]
  ds_read_b64_tr_b16 v[160:161], v220 offset:28672
  ds_read_b64_tr_b16 v[162:163], v220 offset:30720
  v_mfma_f32_16x16x32_bf16 v[60:63], v[164:167], v[196:199], v[60:63]
  v_mfma_f32_16x16x32_bf16 v[64:67], v[164:167], v[200:203], v[64:67]
  ds_read_b128 v[184:187], v223 offset:28672
  v_mfma_f32_16x16x32_bf16 v[68:71], v[164:167], v[204:207], v[68:71]
  v_mfma_f32_16x16x32_bf16 v[72:75], v[164:167], v[208:211], v[72:75]
  v_mfma_f32_16x16x32_bf16 v[76:79], v[164:167], v[212:215], v[76:79]
  ds_read_b64_tr_b16 v[164:165], v221 offset:28672
  ds_read_b64_tr_b16 v[166:167], v221 offset:30720
  s_waitcnt lgkmcnt(9)
  v_mfma_f32_16x16x32_bf16 v[80:83], v[168:171], v[196:199], v[80:83]
  v_mfma_f32_16x16x32_bf16 v[84:87], v[168:171], v[200:203], v[84:87]
  ds_read_b128 v[188:191], v223 offset:32768
  v_mfma_f32_16x16x32_bf16 v[88:91], v[168:171], v[204:207], v[88:91]
  v_mfma_f32_16x16x32_bf16 v[92:95], v[168:171], v[208:211], v[92:95]
  v_mfma_f32_16x16x32_bf16 v[96:99], v[168:171], v[212:215], v[96:99]
  ds_read_b64_tr_b16 v[168:169], v222 offset:28672
  ds_read_b64_tr_b16 v[170:171], v222 offset:30720
  v_mfma_f32_16x16x32_bf16 v[100:103], v[172:175], v[196:199], v[100:103]
  v_mfma_f32_16x16x32_bf16 v[104:107], v[172:175], v[200:203], v[104:107]
  ds_read_b128 v[192:195], v223 offset:36864
  v_mfma_f32_16x16x32_bf16 v[108:111], v[172:175], v[204:207], v[108:111]
  v_mfma_f32_16x16x32_bf16 v[112:115], v[172:175], v[208:211], v[112:115]
  v_mfma_f32_16x16x32_bf16 v[116:119], v[172:175], v[212:215], v[116:119]
  v_mfma_f32_16x16x32_bf16 v[120:123], v[140:143], v[196:199], v[120:123]
  v_mfma_f32_16x16x32_bf16 v[124:127], v[140:143], v[200:203], v[124:127]
  v_mfma_f32_16x16x32_bf16 v[128:131], v[140:143], v[204:207], v[128:131]
  v_mfma_f32_16x16x32_bf16 v[132:135], v[140:143], v[208:211], v[132:135]
  v_mfma_f32_16x16x32_bf16 v[136:139], v[140:143], v[212:215], v[136:139]
  s_waitcnt lgkmcnt(0)
  s_barrier
  v_mfma_f32_16x16x32_bf16 v[0:3], v[144:147], v[176:179], v[0:3]
  ds_read_b64_tr_b16 v[172:173], v216 offset:57344
  ds_read_b64_tr_b16 v[174:175], v216 offset:59392
  v_mfma_f32_16x16x32_bf16 v[4:7], v[144:147], v[180:183], v[4:7]
  v_mfma_f32_16x16x32_bf16 v[8:11], v[144:147], v[184:187], v[8:11]
  ds_read_b64_tr_b16 v[140:141], v217 offset:57344
  ds_read_b64_tr_b16 v[142:143], v217 offset:59392
  v_mfma_f32_16x16x32_bf16 v[12:15], v[144:147], v[188:191], v[12:15]
  v_mfma_f32_16x16x32_bf16 v[16:19], v[144:147], v[192:195], v[16:19]
  ds_read_b64_tr_b16 v[144:145], v218 offset:57344
  ds_read_b64_tr_b16 v[146:147], v218 offset:59392
  v_mfma_f32_16x16x32_bf16 v[20:23], v[148:151], v[176:179], v[20:23]
  v_mfma_f32_16x16x32_bf16 v[24:27], v[148:151], v[180:183], v[24:27]
  ds_read_b128 v[196:199], v223 offset:21504
  v_mfma_f32_16x16x32_bf16 v[28:31], v[148:151], v[184:187], v[28:31]
  v_mfma_f32_16x16x32_bf16 v[32:35], v[148:151], v[188:191], v[32:35]
  v_mfma_f32_16x16x32_bf16 v[36:39], v[148:151], v[192:195], v[36:39]
  ds_read_b64_tr_b16 v[148:149], v219 offset:57344
  ds_read_b64_tr_b16 v[150:151], v219 offset:59392
  v_mfma_f32_16x16x32_bf16 v[40:43], v[152:155], v[176:179], v[40:43]
  v_mfma_f32_16x16x32_bf16 v[44:47], v[152:155], v[180:183], v[44:47]
  ds_read_b128 v[200:203], v223 offset:25600
  v_mfma_f32_16x16x32_bf16 v[48:51], v[152:155], v[184:187], v[48:51]
  v_mfma_f32_16x16x32_bf16 v[52:55], v[152:155], v[188:191], v[52:55]
  v_mfma_f32_16x16x32_bf16 v[56:59], v[152:155], v[192:195], v[56:59]
  ds_read_b64_tr_b16 v[152:153], v220 offset:57344
  ds_read_b64_tr_b16 v[154:155], v220 offset:59392
  v_mfma_f32_16x16x32_bf16 v[60:63], v[156:159], v[176:179], v[60:63]
  v_mfma_f32_16x16x32_bf16 v[64:67], v[156:159], v[180:183], v[64:67]
  ds_read_b128 v[204:207], v223 offset:29696
  v_mfma_f32_16x16x32_bf16 v[68:71], v[156:159], v[184:187], v[68:71]
  v_mfma_f32_16x16x32_bf16 v[72:75], v[156:159], v[188:191], v[72:75]
  v_mfma_f32_16x16x32_bf16 v[76:79], v[156:159], v[192:195], v[76:79]
  ds_read_b64_tr_b16 v[156:157], v221 offset:57344
  ds_read_b64_tr_b16 v[158:159], v221 offset:59392
  s_waitcnt lgkmcnt(9)
  v_mfma_f32_16x16x32_bf16 v[80:83], v[160:163], v[176:179], v[80:83]
  v_mfma_f32_16x16x32_bf16 v[84:87], v[160:163], v[180:183], v[84:87]
  ds_read_b128 v[208:211], v223 offset:33792
  v_mfma_f32_16x16x32_bf16 v[88:91], v[160:163], v[184:187], v[88:91]
  v_mfma_f32_16x16x32_bf16 v[92:95], v[160:163], v[188:191], v[92:95]
  v_mfma_f32_16x16x32_bf16 v[96:99], v[160:163], v[192:195], v[96:99]
  ds_read_b64_tr_b16 v[160:161], v222 offset:57344
  ds_read_b64_tr_b16 v[162:163], v222 offset:59392
  v_mfma_f32_16x16x32_bf16 v[100:103], v[164:167], v[176:179], v[100:103]
  v_mfma_f32_16x16x32_bf16 v[104:107], v[164:167], v[180:183], v[104:107]
  ds_read_b128 v[212:215], v223 offset:37888
  v_mfma_f32_16x16x32_bf16 v[108:111], v[164:167], v[184:187], v[108:111]
  v_mfma_f32_16x16x32_bf16 v[112:115], v[164:167], v[188:191], v[112:115]
  v_mfma_f32_16x16x32_bf16 v[116:119], v[164:167], v[192:195], v[116:119]
  v_mfma_f32_16x16x32_bf16 v[120:123], v[168:171], v[176:179], v[120:123]
  v_mfma_f32_16x16x32_bf16 v[124:127], v[168:171], v[180:183], v[124:127]
  v_mfma_f32_16x16x32_bf16 v[128:131], v[168:171], v[184:187], v[128:131]
  v_mfma_f32_16x16x32_bf16 v[132:135], v[168:171], v[188:191], v[132:135]
  v_mfma_f32_16x16x32_bf16 v[136:139], v[168:171], v[192:195], v[136:139]
  s_waitcnt lgkmcnt(0)
  s_barrier
  v_mfma_f32_16x16x32_bf16 v[0:3], v[172:175], v[196:199], v[0:3]
  ds_read_b64_tr_b16 v[164:165], v216
  ds_read_b64_tr_b16 v[166:167], v216 offset:2048
  v_mfma_f32_16x16x32_bf16 v[4:7], v[172:175], v[200:203], v[4:7]
  v_mfma_f32_16x16x32_bf16 v[8:11], v[172:175], v[204:207], v[8:11]
  ds_read_b64_tr_b16 v[168:169], v217
  ds_read_b64_tr_b16 v[170:171], v217 offset:2048
  v_mfma_f32_16x16x32_bf16 v[12:15], v[172:175], v[208:211], v[12:15]
  v_mfma_f32_16x16x32_bf16 v[16:19], v[172:175], v[212:215], v[16:19]
  ds_read_b64_tr_b16 v[172:173], v218
  ds_read_b64_tr_b16 v[174:175], v218 offset:2048
  v_mfma_f32_16x16x32_bf16 v[20:23], v[140:143], v[196:199], v[20:23]
  v_mfma_f32_16x16x32_bf16 v[24:27], v[140:143], v[200:203], v[24:27]
  ds_read_b128 v[176:179], v223 offset:22528
  v_mfma_f32_16x16x32_bf16 v[28:31], v[140:143], v[204:207], v[28:31]
  v_mfma_f32_16x16x32_bf16 v[32:35], v[140:143], v[208:211], v[32:35]
  v_mfma_f32_16x16x32_bf16 v[36:39], v[140:143], v[212:215], v[36:39]
  ds_read_b64_tr_b16 v[140:141], v219
  ds_read_b64_tr_b16 v[142:143], v219 offset:2048
  v_mfma_f32_16x16x32_bf16 v[40:43], v[144:147], v[196:199], v[40:43]
  v_mfma_f32_16x16x32_bf16 v[44:47], v[144:147], v[200:203], v[44:47]
  ds_read_b128 v[180:183], v223 offset:26624
  v_mfma_f32_16x16x32_bf16 v[48:51], v[144:147], v[204:207], v[48:51]
  v_mfma_f32_16x16x32_bf16 v[52:55], v[144:147], v[208:211], v[52:55]
  v_mfma_f32_16x16x32_bf16 v[56:59], v[144:147], v[212:215], v[56:59]
  ds_read_b64_tr_b16 v[144:145], v220
  ds_read_b64_tr_b16 v[146:147], v220 offset:2048
  v_mfma_f32_16x16x32_bf16 v[60:63], v[148:151], v[196:199], v[60:63]
  v_mfma_f32_16x16x32_bf16 v[64:67], v[148:151], v[200:203], v[64:67]
  ds_read_b128 v[184:187], v223 offset:30720
  v_mfma_f32_16x16x32_bf16 v[68:71], v[148:151], v[204:207], v[68:71]
  v_mfma_f32_16x16x32_bf16 v[72:75], v[148:151], v[208:211], v[72:75]
  v_mfma_f32_16x16x32_bf16 v[76:79], v[148:151], v[212:215], v[76:79]
  ds_read_b64_tr_b16 v[148:149], v221
  ds_read_b64_tr_b16 v[150:151], v221 offset:2048
  s_waitcnt lgkmcnt(9)
  v_mfma_f32_16x16x32_bf16 v[80:83], v[152:155], v[196:199], v[80:83]
  v_mfma_f32_16x16x32_bf16 v[84:87], v[152:155], v[200:203], v[84:87]
  ds_read_b128 v[188:191], v223 offset:34816
  v_mfma_f32_16x16x32_bf16 v[88:91], v[152:155], v[204:207], v[88:91]
  v_mfma_f32_16x16x32_bf16 v[92:95], v[152:155], v[208:211], v[92:95]
  v_mfma_f32_16x16x32_bf16 v[96:99], v[152:155], v[212:215], v[96:99]
  ds_read_b64_tr_b16 v[152:153], v222
  ds_read_b64_tr_b16 v[154:155], v222 offset:2048
  v_mfma_f32_16x16x32_bf16 v[100:103], v[156:159], v[196:199], v[100:103]
  v_mfma_f32_16x16x32_bf16 v[104:107], v[156:159], v[200:203], v[104:107]
  ds_read_b128 v[192:195], v223 offset:38912
  v_mfma_f32_16x16x32_bf16 v[108:111], v[156:159], v[204:207], v[108:111]
  v_mfma_f32_16x16x32_bf16 v[112:115], v[156:159], v[208:211], v[112:115]
  v_mfma_f32_16x16x32_bf16 v[116:119], v[156:159], v[212:215], v[116:119]
  v_mfma_f32_16x16x32_bf16 v[120:123], v[160:163], v[196:199], v[120:123]
  v_mfma_f32_16x16x32_bf16 v[124:127], v[160:163], v[200:203], v[124:127]
  v_mfma_f32_16x16x32_bf16 v[128:131], v[160:163], v[204:207], v[128:131]
  v_mfma_f32_16x16x32_bf16 v[132:135], v[160:163], v[208:211], v[132:135]
  v_mfma_f32_16x16x32_bf16 v[136:139], v[160:163], v[212:215], v[136:139]
  s_waitcnt lgkmcnt(0)
  s_barrier
  v_mfma_f32_16x16x32_bf16 v[0:3], v[164:167], v[176:179], v[0:3]
  ds_read_b64_tr_b16 v[156:157], v216 offset:28672
  ds_read_b64_tr_b16 v[158:159], v216 offset:30720
  v_mfma_f32_16x16x32_bf16 v[4:7], v[164:167], v[180:183], v[4:7]
  v_mfma_f32_16x16x32_bf16 v[8:11], v[164:167], v[184:187], v[8:11]
  ds_read_b64_tr_b16 v[160:161], v217 offset:28672
  ds_read_b64_tr_b16 v[162:163], v217 offset:30720
  v_mfma_f32_16x16x32_bf16 v[12:15], v[164:167], v[188:191], v[12:15]
  v_mfma_f32_16x16x32_bf16 v[16:19], v[164:167], v[192:195], v[16:19]
  ds_read_b64_tr_b16 v[164:165], v218 offset:28672
  ds_read_b64_tr_b16 v[166:167], v218 offset:30720
  v_mfma_f32_16x16x32_bf16 v[20:23], v[168:171], v[176:179], v[20:23]
  v_mfma_f32_16x16x32_bf16 v[24:27], v[168:171], v[180:183], v[24:27]
  ds_read_b128 v[196:199], v223 offset:23552
  v_mfma_f32_16x16x32_bf16 v[28:31], v[168:171], v[184:187], v[28:31]
  v_mfma_f32_16x16x32_bf16 v[32:35], v[168:171], v[188:191], v[32:35]
  v_mfma_f32_16x16x32_bf16 v[36:39], v[168:171], v[192:195], v[36:39]
  ds_read_b64_tr_b16 v[168:169], v219 offset:28672
  ds_read_b64_tr_b16 v[170:171], v219 offset:30720
  v_mfma_f32_16x16x32_bf16 v[40:43], v[172:175], v[176:179], v[40:43]
  v_mfma_f32_16x16x32_bf16 v[44:47], v[172:175], v[180:183], v[44:47]
  ds_read_b128 v[200:203], v223 offset:27648
  v_mfma_f32_16x16x32_bf16 v[48:51], v[172:175], v[184:187], v[48:51]
  v_mfma_f32_16x16x32_bf16 v[52:55], v[172:175], v[188:191], v[52:55]
  v_mfma_f32_16x16x32_bf16 v[56:59], v[172:175], v[192:195], v[56:59]
  ds_read_b64_tr_b16 v[172:173], v220 offset:28672
  ds_read_b64_tr_b16 v[174:175], v220 offset:30720
  v_mfma_f32_16x16x32_bf16 v[60:63], v[140:143], v[176:179], v[60:63]
  v_mfma_f32_16x16x32_bf16 v[64:67], v[140:143], v[180:183], v[64:67]
  ds_read_b128 v[204:207], v223 offset:31744
  v_mfma_f32_16x16x32_bf16 v[68:71], v[140:143], v[184:187], v[68:71]
  v_mfma_f32_16x16x32_bf16 v[72:75], v[140:143], v[188:191], v[72:75]
  v_mfma_f32_16x16x32_bf16 v[76:79], v[140:143], v[192:195], v[76:79]
  ds_read_b64_tr_b16 v[140:141], v221 offset:28672
  ds_read_b64_tr_b16 v[142:143], v221 offset:30720
  s_waitcnt lgkmcnt(9)
  v_mfma_f32_16x16x32_bf16 v[80:83], v[144:147], v[176:179], v[80:83]
  v_mfma_f32_16x16x32_bf16 v[84:87], v[144:147], v[180:183], v[84:87]
  ds_read_b128 v[208:211], v223 offset:35840
  v_mfma_f32_16x16x32_bf16 v[88:91], v[144:147], v[184:187], v[88:91]
  v_mfma_f32_16x16x32_bf16 v[92:95], v[144:147], v[188:191], v[92:95]
  v_mfma_f32_16x16x32_bf16 v[96:99], v[144:147], v[192:195], v[96:99]
  ds_read_b64_tr_b16 v[144:145], v222 offset:28672
  ds_read_b64_tr_b16 v[146:147], v222 offset:30720
  v_mfma_f32_16x16x32_bf16 v[100:103], v[148:151], v[176:179], v[100:103]
  v_mfma_f32_16x16x32_bf16 v[104:107], v[148:151], v[180:183], v[104:107]
  ds_read_b128 v[212:215], v223 offset:39936
  v_mfma_f32_16x16x32_bf16 v[108:111], v[148:151], v[184:187], v[108:111]
  v_mfma_f32_16x16x32_bf16 v[112:115], v[148:151], v[188:191], v[112:115]
  v_mfma_f32_16x16x32_bf16 v[116:119], v[148:151], v[192:195], v[116:119]
  v_mfma_f32_16x16x32_bf16 v[120:123], v[152:155], v[176:179], v[120:123]
  v_mfma_f32_16x16x32_bf16 v[124:127], v[152:155], v[180:183], v[124:127]
  v_mfma_f32_16x16x32_bf16 v[128:131], v[152:155], v[184:187], v[128:131]
  v_mfma_f32_16x16x32_bf16 v[132:135], v[152:155], v[188:191], v[132:135]
  v_mfma_f32_16x16x32_bf16 v[136:139], v[152:155], v[192:195], v[136:139]
  s_waitcnt lgkmcnt(0)
  s_barrier
  v_mfma_f32_16x16x32_bf16 v[0:3], v[156:159], v[196:199], v[0:3]
  ds_read_b64_tr_b16 v[148:149], v216 offset:57344
  ds_read_b64_tr_b16 v[150:151], v216 offset:59392
  v_mfma_f32_16x16x32_bf16 v[4:7], v[156:159], v[200:203], v[4:7]
  v_mfma_f32_16x16x32_bf16 v[8:11], v[156:159], v[204:207], v[8:11]
  ds_read_b64_tr_b16 v[152:153], v217 offset:57344
  ds_read_b64_tr_b16 v[154:155], v217 offset:59392
  v_mfma_f32_16x16x32_bf16 v[12:15], v[156:159], v[208:211], v[12:15]
  v_mfma_f32_16x16x32_bf16 v[16:19], v[156:159], v[212:215], v[16:19]
  ds_read_b64_tr_b16 v[156:157], v218 offset:57344
  ds_read_b64_tr_b16 v[158:159], v218 offset:59392
  v_mfma_f32_16x16x32_bf16 v[20:23], v[160:163], v[196:199], v[20:23]
  v_mfma_f32_16x16x32_bf16 v[24:27], v[160:163], v[200:203], v[24:27]
  ds_read_b128 v[176:179], v223 offset:40960
  v_mfma_f32_16x16x32_bf16 v[28:31], v[160:163], v[204:207], v[28:31]
  v_mfma_f32_16x16x32_bf16 v[32:35], v[160:163], v[208:211], v[32:35]
  v_mfma_f32_16x16x32_bf16 v[36:39], v[160:163], v[212:215], v[36:39]
  ds_read_b64_tr_b16 v[160:161], v219 offset:57344
  ds_read_b64_tr_b16 v[162:163], v219 offset:59392
  v_mfma_f32_16x16x32_bf16 v[40:43], v[164:167], v[196:199], v[40:43]
  v_mfma_f32_16x16x32_bf16 v[44:47], v[164:167], v[200:203], v[44:47]
  ds_read_b128 v[180:183], v223 offset:45056
  v_mfma_f32_16x16x32_bf16 v[48:51], v[164:167], v[204:207], v[48:51]
  v_mfma_f32_16x16x32_bf16 v[52:55], v[164:167], v[208:211], v[52:55]
  v_mfma_f32_16x16x32_bf16 v[56:59], v[164:167], v[212:215], v[56:59]
  ds_read_b64_tr_b16 v[164:165], v220 offset:57344
  ds_read_b64_tr_b16 v[166:167], v220 offset:59392
  v_mfma_f32_16x16x32_bf16 v[60:63], v[168:171], v[196:199], v[60:63]
  v_mfma_f32_16x16x32_bf16 v[64:67], v[168:171], v[200:203], v[64:67]
  ds_read_b128 v[184:187], v223 offset:49152
  v_mfma_f32_16x16x32_bf16 v[68:71], v[168:171], v[204:207], v[68:71]
  v_mfma_f32_16x16x32_bf16 v[72:75], v[168:171], v[208:211], v[72:75]
  v_mfma_f32_16x16x32_bf16 v[76:79], v[168:171], v[212:215], v[76:79]
  ds_read_b64_tr_b16 v[168:169], v221 offset:57344
  ds_read_b64_tr_b16 v[170:171], v221 offset:59392
  s_waitcnt lgkmcnt(9)
  v_mfma_f32_16x16x32_bf16 v[80:83], v[172:175], v[196:199], v[80:83]
  v_mfma_f32_16x16x32_bf16 v[84:87], v[172:175], v[200:203], v[84:87]
  ds_read_b128 v[188:191], v223 offset:53248
  v_mfma_f32_16x16x32_bf16 v[88:91], v[172:175], v[204:207], v[88:91]
  v_mfma_f32_16x16x32_bf16 v[92:95], v[172:175], v[208:211], v[92:95]
  v_mfma_f32_16x16x32_bf16 v[96:99], v[172:175], v[212:215], v[96:99]
  ds_read_b64_tr_b16 v[172:173], v222 offset:57344
  ds_read_b64_tr_b16 v[174:175], v222 offset:59392
  v_mfma_f32_16x16x32_bf16 v[100:103], v[140:143], v[196:199], v[100:103]
  v_mfma_f32_16x16x32_bf16 v[104:107], v[140:143], v[200:203], v[104:107]
  ds_read_b128 v[192:195], v223 offset:57344
  v_mfma_f32_16x16x32_bf16 v[108:111], v[140:143], v[204:207], v[108:111]
  v_mfma_f32_16x16x32_bf16 v[112:115], v[140:143], v[208:211], v[112:115]
  v_mfma_f32_16x16x32_bf16 v[116:119], v[140:143], v[212:215], v[116:119]
  v_mfma_f32_16x16x32_bf16 v[120:123], v[144:147], v[196:199], v[120:123]
  v_mfma_f32_16x16x32_bf16 v[124:127], v[144:147], v[200:203], v[124:127]
  v_mfma_f32_16x16x32_bf16 v[128:131], v[144:147], v[204:207], v[128:131]
  v_mfma_f32_16x16x32_bf16 v[132:135], v[144:147], v[208:211], v[132:135]
  v_mfma_f32_16x16x32_bf16 v[136:139], v[144:147], v[212:215], v[136:139]
  s_waitcnt lgkmcnt(0)
  s_barrier
  v_mfma_f32_16x16x32_bf16 v[0:3], v[148:151], v[176:179], v[0:3]
  ds_read_b64_tr_b16 v[140:141], v216
  ds_read_b64_tr_b16 v[142:143], v216 offset:2048
  v_mfma_f32_16x16x32_bf16 v[4:7], v[148:151], v[180:183], v[4:7]
  v_mfma_f32_16x16x32_bf16 v[8:11], v[148:151], v[184:187], v[8:11]
  ds_read_b64_tr_b16 v[144:145], v217
  ds_read_b64_tr_b16 v[146:147], v217 offset:2048
  v_mfma_f32_16x16x32_bf16 v[12:15], v[148:151], v[188:191], v[12:15]
  v_mfma_f32_16x16x32_bf16 v[16:19], v[148:151], v[192:195], v[16:19]
  ds_read_b64_tr_b16 v[148:149], v218
  ds_read_b64_tr_b16 v[150:151], v218 offset:2048
  v_mfma_f32_16x16x32_bf16 v[20:23], v[152:155], v[176:179], v[20:23]
  v_mfma_f32_16x16x32_bf16 v[24:27], v[152:155], v[180:183], v[24:27]
  ds_read_b128 v[196:199], v223 offset:41984
  v_mfma_f32_16x16x32_bf16 v[28:31], v[152:155], v[184:187], v[28:31]
  v_mfma_f32_16x16x32_bf16 v[32:35], v[152:155], v[188:191], v[32:35]
  v_mfma_f32_16x16x32_bf16 v[36:39], v[152:155], v[192:195], v[36:39]
  ds_read_b64_tr_b16 v[152:153], v219
  ds_read_b64_tr_b16 v[154:155], v219 offset:2048
  v_mfma_f32_16x16x32_bf16 v[40:43], v[156:159], v[176:179], v[40:43]
  v_mfma_f32_16x16x32_bf16 v[44:47], v[156:159], v[180:183], v[44:47]
  ds_read_b128 v[200:203], v223 offset:46080
  v_mfma_f32_16x16x32_bf16 v[48:51], v[156:159], v[184:187], v[48:51]
  v_mfma_f32_16x16x32_bf16 v[52:55], v[156:159], v[188:191], v[52:55]
  v_mfma_f32_16x16x32_bf16 v[56:59], v[156:159], v[192:195], v[56:59]
  ds_read_b64_tr_b16 v[156:157], v220
  ds_read_b64_tr_b16 v[158:159], v220 offset:2048
  v_mfma_f32_16x16x32_bf16 v[60:63], v[160:163], v[176:179], v[60:63]
  v_mfma_f32_16x16x32_bf16 v[64:67], v[160:163], v[180:183], v[64:67]
  ds_read_b128 v[204:207], v223 offset:50176
  v_mfma_f32_16x16x32_bf16 v[68:71], v[160:163], v[184:187], v[68:71]
  v_mfma_f32_16x16x32_bf16 v[72:75], v[160:163], v[188:191], v[72:75]
  v_mfma_f32_16x16x32_bf16 v[76:79], v[160:163], v[192:195], v[76:79]
  ds_read_b64_tr_b16 v[160:161], v221
  ds_read_b64_tr_b16 v[162:163], v221 offset:2048
  s_waitcnt lgkmcnt(9)
  v_mfma_f32_16x16x32_bf16 v[80:83], v[164:167], v[176:179], v[80:83]
  v_mfma_f32_16x16x32_bf16 v[84:87], v[164:167], v[180:183], v[84:87]
  ds_read_b128 v[208:211], v223 offset:54272
  v_mfma_f32_16x16x32_bf16 v[88:91], v[164:167], v[184:187], v[88:91]
  v_mfma_f32_16x16x32_bf16 v[92:95], v[164:167], v[188:191], v[92:95]
  v_mfma_f32_16x16x32_bf16 v[96:99], v[164:167], v[192:195], v[96:99]
  ds_read_b64_tr_b16 v[164:165], v222
  ds_read_b64_tr_b16 v[166:167], v222 offset:2048
  v_mfma_f32_16x16x32_bf16 v[100:103], v[168:171], v[176:179], v[100:103]
  v_mfma_f32_16x16x32_bf16 v[104:107], v[168:171], v[180:183], v[104:107]
  ds_read_b128 v[212:215], v223 offset:58368
  v_mfma_f32_16x16x32_bf16 v[108:111], v[168:171], v[184:187], v[108:111]
  v_mfma_f32_16x16x32_bf16 v[112:115], v[168:171], v[188:191], v[112:115]
  v_mfma_f32_16x16x32_bf16 v[116:119], v[168:171], v[192:195], v[116:119]
  v_mfma_f32_16x16x32_bf16 v[120:123], v[172:175], v[176:179], v[120:123]
  v_mfma_f32_16x16x32_bf16 v[124:127], v[172:175], v[180:183], v[124:127]
  v_mfma_f32_16x16x32_bf16 v[128:131], v[172:175], v[184:187], v[128:131]
  v_mfma_f32_16x16x32_bf16 v[132:135], v[172:175], v[188:191], v[132:135]
  v_mfma_f32_16x16x32_bf16 v[136:139], v[172:175], v[192:195], v[136:139]
  s_waitcnt lgkmcnt(0)
  s_barrier
  v_mfma_f32_16x16x32_bf16 v[0:3], v[140:143], v[196:199], v[0:3]
  ds_read_b64_tr_b16 v[168:169], v216 offset:28672
  ds_read_b64_tr_b16 v[170:171], v216 offset:30720
  v_mfma_f32_16x16x32_bf16 v[4:7], v[140:143], v[200:203], v[4:7]
  v_mfma_f32_16x16x32_bf16 v[8:11], v[140:143], v[204:207], v[8:11]
  ds_read_b64_tr_b16 v[172:173], v217 offset:28672
  ds_read_b64_tr_b16 v[174:175], v217 offset:30720
  v_mfma_f32_16x16x32_bf16 v[12:15], v[140:143], v[208:211], v[12:15]
  v_mfma_f32_16x16x32_bf16 v[16:19], v[140:143], v[212:215], v[16:19]
  ds_read_b64_tr_b16 v[140:141], v218 offset:28672
  ds_read_b64_tr_b16 v[142:143], v218 offset:30720
  v_mfma_f32_16x16x32_bf16 v[20:23], v[144:147], v[196:199], v[20:23]
  v_mfma_f32_16x16x32_bf16 v[24:27], v[144:147], v[200:203], v[24:27]
  ds_read_b128 v[176:179], v223 offset:43008
  v_mfma_f32_16x16x32_bf16 v[28:31], v[144:147], v[204:207], v[28:31]
  v_mfma_f32_16x16x32_bf16 v[32:35], v[144:147], v[208:211], v[32:35]
  v_mfma_f32_16x16x32_bf16 v[36:39], v[144:147], v[212:215], v[36:39]
  ds_read_b64_tr_b16 v[144:145], v219 offset:28672
  ds_read_b64_tr_b16 v[146:147], v219 offset:30720
  v_mfma_f32_16x16x32_bf16 v[40:43], v[148:151], v[196:199], v[40:43]
  v_mfma_f32_16x16x32_bf16 v[44:47], v[148:151], v[200:203], v[44:47]
  ds_read_b128 v[180:183], v223 offset:47104
  v_mfma_f32_16x16x32_bf16 v[48:51], v[148:151], v[204:207], v[48:51]
  v_mfma_f32_16x16x32_bf16 v[52:55], v[148:151], v[208:211], v[52:55]
  v_mfma_f32_16x16x32_bf16 v[56:59], v[148:151], v[212:215], v[56:59]
  ds_read_b64_tr_b16 v[148:149], v220 offset:28672
  ds_read_b64_tr_b16 v[150:151], v220 offset:30720
  v_mfma_f32_16x16x32_bf16 v[60:63], v[152:155], v[196:199], v[60:63]
  v_mfma_f32_16x16x32_bf16 v[64:67], v[152:155], v[200:203], v[64:67]
  ds_read_b128 v[184:187], v223 offset:51200
  v_mfma_f32_16x16x32_bf16 v[68:71], v[152:155], v[204:207], v[68:71]
  v_mfma_f32_16x16x32_bf16 v[72:75], v[152:155], v[208:211], v[72:75]
  v_mfma_f32_16x16x32_bf16 v[76:79], v[152:155], v[212:215], v[76:79]
  ds_read_b64_tr_b16 v[152:153], v221 offset:28672
  ds_read_b64_tr_b16 v[154:155], v221 offset:30720
  s_waitcnt lgkmcnt(9)
  v_mfma_f32_16x16x32_bf16 v[80:83], v[156:159], v[196:199], v[80:83]
  v_mfma_f32_16x16x32_bf16 v[84:87], v[156:159], v[200:203], v[84:87]
  ds_read_b128 v[188:191], v223 offset:55296
  v_mfma_f32_16x16x32_bf16 v[88:91], v[156:159], v[204:207], v[88:91]
  v_mfma_f32_16x16x32_bf16 v[92:95], v[156:159], v[208:211], v[92:95]
  v_mfma_f32_16x16x32_bf16 v[96:99], v[156:159], v[212:215], v[96:99]
  ds_read_b64_tr_b16 v[156:157], v222 offset:28672
  ds_read_b64_tr_b16 v[158:159], v222 offset:30720
  v_mfma_f32_16x16x32_bf16 v[100:103], v[160:163], v[196:199], v[100:103]
  v_mfma_f32_16x16x32_bf16 v[104:107], v[160:163], v[200:203], v[104:107]
  ds_read_b128 v[192:195], v223 offset:59392
  v_mfma_f32_16x16x32_bf16 v[108:111], v[160:163], v[204:207], v[108:111]
  v_mfma_f32_16x16x32_bf16 v[112:115], v[160:163], v[208:211], v[112:115]
  v_mfma_f32_16x16x32_bf16 v[116:119], v[160:163], v[212:215], v[116:119]
  v_mfma_f32_16x16x32_bf16 v[120:123], v[164:167], v[196:199], v[120:123]
  v_mfma_f32_16x16x32_bf16 v[124:127], v[164:167], v[200:203], v[124:127]
  v_mfma_f32_16x16x32_bf16 v[128:131], v[164:167], v[204:207], v[128:131]
  v_mfma_f32_16x16x32_bf16 v[132:135], v[164:167], v[208:211], v[132:135]
  v_mfma_f32_16x16x32_bf16 v[136:139], v[164:167], v[212:215], v[136:139]
  s_waitcnt lgkmcnt(0)
  s_barrier
  v_mfma_f32_16x16x32_bf16 v[0:3], v[168:171], v[176:179], v[0:3]
  ds_read_b64_tr_b16 v[160:161], v216 offset:57344
  ds_read_b64_tr_b16 v[162:163], v216 offset:59392
  v_mfma_f32_16x16x32_bf16 v[4:7], v[168:171], v[180:183], v[4:7]
  v_mfma_f32_16x16x32_bf16 v[8:11], v[168:171], v[184:187], v[8:11]
  ds_read_b64_tr_b16 v[164:165], v217 offset:57344
  ds_read_b64_tr_b16 v[166:167], v217 offset:59392
  v_mfma_f32_16x16x32_bf16 v[12:15], v[168:171], v[188:191], v[12:15]
  v_mfma_f32_16x16x32_bf16 v[16:19], v[168:171], v[192:195], v[16:19]
  ds_read_b64_tr_b16 v[168:169], v218 offset:57344
  ds_read_b64_tr_b16 v[170:171], v218 offset:59392
  v_mfma_f32_16x16x32_bf16 v[20:23], v[172:175], v[176:179], v[20:23]
  v_mfma_f32_16x16x32_bf16 v[24:27], v[172:175], v[180:183], v[24:27]
  ds_read_b128 v[196:199], v223 offset:44032
  v_mfma_f32_16x16x32_bf16 v[28:31], v[172:175], v[184:187], v[28:31]
  v_mfma_f32_16x16x32_bf16 v[32:35], v[172:175], v[188:191], v[32:35]
  v_mfma_f32_16x16x32_bf16 v[36:39], v[172:175], v[192:195], v[36:39]
  ds_read_b64_tr_b16 v[172:173], v219 offset:57344
  ds_read_b64_tr_b16 v[174:175], v219 offset:59392
  v_mfma_f32_16x16x32_bf16 v[40:43], v[140:143], v[176:179], v[40:43]
  v_mfma_f32_16x16x32_bf16 v[44:47], v[140:143], v[180:183], v[44:47]
  ds_read_b128 v[200:203], v223 offset:48128
  v_mfma_f32_16x16x32_bf16 v[48:51], v[140:143], v[184:187], v[48:51]
  v_mfma_f32_16x16x32_bf16 v[52:55], v[140:143], v[188:191], v[52:55]
  v_mfma_f32_16x16x32_bf16 v[56:59], v[140:143], v[192:195], v[56:59]
  ds_read_b64_tr_b16 v[140:141], v220 offset:57344
  ds_read_b64_tr_b16 v[142:143], v220 offset:59392
  v_mfma_f32_16x16x32_bf16 v[60:63], v[144:147], v[176:179], v[60:63]
  v_mfma_f32_16x16x32_bf16 v[64:67], v[144:147], v[180:183], v[64:67]
  ds_read_b128 v[204:207], v223 offset:52224
  v_mfma_f32_16x16x32_bf16 v[68:71], v[144:147], v[184:187], v[68:71]
  v_mfma_f32_16x16x32_bf16 v[72:75], v[144:147], v[188:191], v[72:75]
  v_mfma_f32_16x16x32_bf16 v[76:79], v[144:147], v[192:195], v[76:79]
  ds_read_b64_tr_b16 v[144:145], v221 offset:57344
  ds_read_b64_tr_b16 v[146:147], v221 offset:59392
  s_waitcnt lgkmcnt(9)
  v_mfma_f32_16x16x32_bf16 v[80:83], v[148:151], v[176:179], v[80:83]
  v_mfma_f32_16x16x32_bf16 v[84:87], v[148:151], v[180:183], v[84:87]
  ds_read_b128 v[208:211], v223 offset:56320
  v_mfma_f32_16x16x32_bf16 v[88:91], v[148:151], v[184:187], v[88:91]
  v_mfma_f32_16x16x32_bf16 v[92:95], v[148:151], v[188:191], v[92:95]
  v_mfma_f32_16x16x32_bf16 v[96:99], v[148:151], v[192:195], v[96:99]
  ds_read_b64_tr_b16 v[148:149], v222 offset:57344
  ds_read_b64_tr_b16 v[150:151], v222 offset:59392
  v_mfma_f32_16x16x32_bf16 v[100:103], v[152:155], v[176:179], v[100:103]
  v_mfma_f32_16x16x32_bf16 v[104:107], v[152:155], v[180:183], v[104:107]
  ds_read_b128 v[212:215], v223 offset:60416
  v_mfma_f32_16x16x32_bf16 v[108:111], v[152:155], v[184:187], v[108:111]
  v_mfma_f32_16x16x32_bf16 v[112:115], v[152:155], v[188:191], v[112:115]
  v_mfma_f32_16x16x32_bf16 v[116:119], v[152:155], v[192:195], v[116:119]
  v_mfma_f32_16x16x32_bf16 v[120:123], v[156:159], v[176:179], v[120:123]
  v_mfma_f32_16x16x32_bf16 v[124:127], v[156:159], v[180:183], v[124:127]
  v_mfma_f32_16x16x32_bf16 v[128:131], v[156:159], v[184:187], v[128:131]
  v_mfma_f32_16x16x32_bf16 v[132:135], v[156:159], v[188:191], v[132:135]
  v_mfma_f32_16x16x32_bf16 v[136:139], v[156:159], v[192:195], v[136:139]
  s_waitcnt lgkmcnt(0)
  s_barrier
  v_mfma_f32_16x16x32_bf16 v[0:3], v[160:163], v[196:199], v[0:3]
  ds_read_b64_tr_b16 v[152:153], v216
  ds_read_b64_tr_b16 v[154:155], v216 offset:2048
  v_mfma_f32_16x16x32_bf16 v[4:7], v[160:163], v[200:203], v[4:7]
  v_mfma_f32_16x16x32_bf16 v[8:11], v[160:163], v[204:207], v[8:11]
  ds_read_b64_tr_b16 v[156:157], v217
  ds_read_b64_tr_b16 v[158:159], v217 offset:2048
  v_mfma_f32_16x16x32_bf16 v[12:15], v[160:163], v[208:211], v[12:15]
  v_mfma_f32_16x16x32_bf16 v[16:19], v[160:163], v[212:215], v[16:19]
  ds_read_b64_tr_b16 v[160:161], v218
  ds_read_b64_tr_b16 v[162:163], v218 offset:2048
  v_mfma_f32_16x16x32_bf16 v[20:23], v[164:167], v[196:199], v[20:23]
  v_mfma_f32_16x16x32_bf16 v[24:27], v[164:167], v[200:203], v[24:27]
  ds_read_b128 v[176:179], v223 offset:0
  v_mfma_f32_16x16x32_bf16 v[28:31], v[164:167], v[204:207], v[28:31]
  v_mfma_f32_16x16x32_bf16 v[32:35], v[164:167], v[208:211], v[32:35]
  v_mfma_f32_16x16x32_bf16 v[36:39], v[164:167], v[212:215], v[36:39]
  ds_read_b64_tr_b16 v[164:165], v219
  ds_read_b64_tr_b16 v[166:167], v219 offset:2048
  v_mfma_f32_16x16x32_bf16 v[40:43], v[168:171], v[196:199], v[40:43]
  v_mfma_f32_16x16x32_bf16 v[44:47], v[168:171], v[200:203], v[44:47]
  ds_read_b128 v[180:183], v223 offset:4096
  v_mfma_f32_16x16x32_bf16 v[48:51], v[168:171], v[204:207], v[48:51]
  v_mfma_f32_16x16x32_bf16 v[52:55], v[168:171], v[208:211], v[52:55]
  v_mfma_f32_16x16x32_bf16 v[56:59], v[168:171], v[212:215], v[56:59]
  ds_read_b64_tr_b16 v[168:169], v220
  ds_read_b64_tr_b16 v[170:171], v220 offset:2048
  v_mfma_f32_16x16x32_bf16 v[60:63], v[172:175], v[196:199], v[60:63]
  v_mfma_f32_16x16x32_bf16 v[64:67], v[172:175], v[200:203], v[64:67]
  ds_read_b128 v[184:187], v223 offset:8192
  v_mfma_f32_16x16x32_bf16 v[68:71], v[172:175], v[204:207], v[68:71]
  v_mfma_f32_16x16x32_bf16 v[72:75], v[172:175], v[208:211], v[72:75]
  v_mfma_f32_16x16x32_bf16 v[76:79], v[172:175], v[212:215], v[76:79]
  ds_read_b64_tr_b16 v[172:173], v221
  ds_read_b64_tr_b16 v[174:175], v221 offset:2048
  s_waitcnt lgkmcnt(9)
  v_mfma_f32_16x16x32_bf16 v[80:83], v[140:143], v[196:199], v[80:83]
  v_mfma_f32_16x16x32_bf16 v[84:87], v[140:143], v[200:203], v[84:87]
  ds_read_b128 v[188:191], v223 offset:12288
  v_mfma_f32_16x16x32_bf16 v[88:91], v[140:143], v[204:207], v[88:91]
  v_mfma_f32_16x16x32_bf16 v[92:95], v[140:143], v[208:211], v[92:95]
  v_mfma_f32_16x16x32_bf16 v[96:99], v[140:143], v[212:215], v[96:99]
  ds_read_b64_tr_b16 v[140:141], v222
  ds_read_b64_tr_b16 v[142:143], v222 offset:2048
  v_mfma_f32_16x16x32_bf16 v[100:103], v[144:147], v[196:199], v[100:103]
  v_mfma_f32_16x16x32_bf16 v[104:107], v[144:147], v[200:203], v[104:107]
  ds_read_b128 v[192:195], v223 offset:16384
  v_mfma_f32_16x16x32_bf16 v[108:111], v[144:147], v[204:207], v[108:111]
  v_mfma_f32_16x16x32_bf16 v[112:115], v[144:147], v[208:211], v[112:115]
  v_mfma_f32_16x16x32_bf16 v[116:119], v[144:147], v[212:215], v[116:119]
  v_mfma_f32_16x16x32_bf16 v[120:123], v[148:151], v[196:199], v[120:123]
  v_mfma_f32_16x16x32_bf16 v[124:127], v[148:151], v[200:203], v[124:127]
  v_mfma_f32_16x16x32_bf16 v[128:131], v[148:151], v[204:207], v[128:131]
  v_mfma_f32_16x16x32_bf16 v[132:135], v[148:151], v[208:211], v[132:135]
  v_mfma_f32_16x16x32_bf16 v[136:139], v[148:151], v[212:215], v[136:139]
  s_waitcnt lgkmcnt(0)
  s_barrier
  v_mfma_f32_16x16x32_bf16 v[0:3], v[152:155], v[176:179], v[0:3]
  ds_read_b64_tr_b16 v[144:145], v216 offset:28672
  ds_read_b64_tr_b16 v[146:147], v216 offset:30720
  v_mfma_f32_16x16x32_bf16 v[4:7], v[152:155], v[180:183], v[4:7]
  v_mfma_f32_16x16x32_bf16 v[8:11], v[152:155], v[184:187], v[8:11]
  ds_read_b64_tr_b16 v[148:149], v217 offset:28672
  ds_read_b64_tr_b16 v[150:151], v217 offset:30720
  v_mfma_f32_16x16x32_bf16 v[12:15], v[152:155], v[188:191], v[12:15]
  v_mfma_f32_16x16x32_bf16 v[16:19], v[152:155], v[192:195], v[16:19]
  ds_read_b64_tr_b16 v[152:153], v218 offset:28672
  ds_read_b64_tr_b16 v[154:155], v218 offset:30720
  v_mfma_f32_16x16x32_bf16 v[20:23], v[156:159], v[176:179], v[20:23]
  v_mfma_f32_16x16x32_bf16 v[24:27], v[156:159], v[180:183], v[24:27]
  ds_read_b128 v[196:199], v223 offset:1024
  v_mfma_f32_16x16x32_bf16 v[28:31], v[156:159], v[184:187], v[28:31]
  v_mfma_f32_16x16x32_bf16 v[32:35], v[156:159], v[188:191], v[32:35]
  v_mfma_f32_16x16x32_bf16 v[36:39], v[156:159], v[192:195], v[36:39]
  ds_read_b64_tr_b16 v[156:157], v219 offset:28672
  ds_read_b64_tr_b16 v[158:159], v219 offset:30720
  v_mfma_f32_16x16x32_bf16 v[40:43], v[160:163], v[176:179], v[40:43]
  v_mfma_f32_16x16x32_bf16 v[44:47], v[160:163], v[180:183], v[44:47]
  ds_read_b128 v[200:203], v223 offset:5120
  v_mfma_f32_16x16x32_bf16 v[48:51], v[160:163], v[184:187], v[48:51]
  v_mfma_f32_16x16x32_bf16 v[52:55], v[160:163], v[188:191], v[52:55]
  v_mfma_f32_16x16x32_bf16 v[56:59], v[160:163], v[192:195], v[56:59]
  ds_read_b64_tr_b16 v[160:161], v220 offset:28672
  ds_read_b64_tr_b16 v[162:163], v220 offset:30720
  v_mfma_f32_16x16x32_bf16 v[60:63], v[164:167], v[176:179], v[60:63]
  v_mfma_f32_16x16x32_bf16 v[64:67], v[164:167], v[180:183], v[64:67]
  ds_read_b128 v[204:207], v223 offset:9216
  v_mfma_f32_16x16x32_bf16 v[68:71], v[164:167], v[184:187], v[68:71]
  v_mfma_f32_16x16x32_bf16 v[72:75], v[164:167], v[188:191], v[72:75]
  v_mfma_f32_16x16x32_bf16 v[76:79], v[164:167], v[192:195], v[76:79]
  ds_read_b64_tr_b16 v[164:165], v221 offset:28672
  ds_read_b64_tr_b16 v[166:167], v221 offset:30720
  s_waitcnt lgkmcnt(9)
  v_mfma_f32_16x16x32_bf16 v[80:83], v[168:171], v[176:179], v[80:83]
  v_mfma_f32_16x16x32_bf16 v[84:87], v[168:171], v[180:183], v[84:87]
  ds_read_b128 v[208:211], v223 offset:13312
  v_mfma_f32_16x16x32_bf16 v[88:91], v[168:171], v[184:187], v[88:91]
  v_mfma_f32_16x16x32_bf16 v[92:95], v[168:171], v[188:191], v[92:95]
  v_mfma_f32_16x16x32_bf16 v[96:99], v[168:171], v[192:195], v[96:99]
  ds_read_b64_tr_b16 v[168:169], v222 offset:28672
  ds_read_b64_tr_b16 v[170:171], v222 offset:30720
  v_mfma_f32_16x16x32_bf16 v[100:103], v[172:175], v[176:179], v[100:103]
  v_mfma_f32_16x16x32_bf16 v[104:107], v[172:175], v[180:183], v[104:107]
  ds_read_b128 v[212:215], v223 offset:17408
  v_mfma_f32_16x16x32_bf16 v[108:111], v[172:175], v[184:187], v[108:111]
  v_mfma_f32_16x16x32_bf16 v[112:115], v[172:175], v[188:191], v[112:115]
  v_mfma_f32_16x16x32_bf16 v[116:119], v[172:175], v[192:195], v[116:119]
  v_mfma_f32_16x16x32_bf16 v[120:123], v[140:143], v[176:179], v[120:123]
  v_mfma_f32_16x16x32_bf16 v[124:127], v[140:143], v[180:183], v[124:127]
  v_mfma_f32_16x16x32_bf16 v[128:131], v[140:143], v[184:187], v[128:131]
  v_mfma_f32_16x16x32_bf16 v[132:135], v[140:143], v[188:191], v[132:135]
  v_mfma_f32_16x16x32_bf16 v[136:139], v[140:143], v[192:195], v[136:139]
  s_waitcnt lgkmcnt(0)
  s_barrier
  v_mfma_f32_16x16x32_bf16 v[0:3], v[144:147], v[196:199], v[0:3]
  ds_read_b64_tr_b16 v[172:173], v216 offset:57344
  ds_read_b64_tr_b16 v[174:175], v216 offset:59392
  v_mfma_f32_16x16x32_bf16 v[4:7], v[144:147], v[200:203], v[4:7]
  v_mfma_f32_16x16x32_bf16 v[8:11], v[144:147], v[204:207], v[8:11]
  ds_read_b64_tr_b16 v[140:141], v217 offset:57344
  ds_read_b64_tr_b16 v[142:143], v217 offset:59392
  v_mfma_f32_16x16x32_bf16 v[12:15], v[144:147], v[208:211], v[12:15]
  v_mfma_f32_16x16x32_bf16 v[16:19], v[144:147], v[212:215], v[16:19]
  ds_read_b64_tr_b16 v[144:145], v218 offset:57344
  ds_read_b64_tr_b16 v[146:147], v218 offset:59392
  v_mfma_f32_16x16x32_bf16 v[20:23], v[148:151], v[196:199], v[20:23]
  v_mfma_f32_16x16x32_bf16 v[24:27], v[148:151], v[200:203], v[24:27]
  ds_read_b128 v[176:179], v223 offset:2048
  v_mfma_f32_16x16x32_bf16 v[28:31], v[148:151], v[204:207], v[28:31]
  v_mfma_f32_16x16x32_bf16 v[32:35], v[148:151], v[208:211], v[32:35]
  v_mfma_f32_16x16x32_bf16 v[36:39], v[148:151], v[212:215], v[36:39]
  ds_read_b64_tr_b16 v[148:149], v219 offset:57344
  ds_read_b64_tr_b16 v[150:151], v219 offset:59392
  v_mfma_f32_16x16x32_bf16 v[40:43], v[152:155], v[196:199], v[40:43]
  v_mfma_f32_16x16x32_bf16 v[44:47], v[152:155], v[200:203], v[44:47]
  ds_read_b128 v[180:183], v223 offset:6144
  v_mfma_f32_16x16x32_bf16 v[48:51], v[152:155], v[204:207], v[48:51]
  v_mfma_f32_16x16x32_bf16 v[52:55], v[152:155], v[208:211], v[52:55]
  v_mfma_f32_16x16x32_bf16 v[56:59], v[152:155], v[212:215], v[56:59]
  ds_read_b64_tr_b16 v[152:153], v220 offset:57344
  ds_read_b64_tr_b16 v[154:155], v220 offset:59392
  v_mfma_f32_16x16x32_bf16 v[60:63], v[156:159], v[196:199], v[60:63]
  v_mfma_f32_16x16x32_bf16 v[64:67], v[156:159], v[200:203], v[64:67]
  ds_read_b128 v[184:187], v223 offset:10240
  v_mfma_f32_16x16x32_bf16 v[68:71], v[156:159], v[204:207], v[68:71]
  v_mfma_f32_16x16x32_bf16 v[72:75], v[156:159], v[208:211], v[72:75]
  v_mfma_f32_16x16x32_bf16 v[76:79], v[156:159], v[212:215], v[76:79]
  ds_read_b64_tr_b16 v[156:157], v221 offset:57344
  ds_read_b64_tr_b16 v[158:159], v221 offset:59392
  s_waitcnt lgkmcnt(9)
  v_mfma_f32_16x16x32_bf16 v[80:83], v[160:163], v[196:199], v[80:83]
  v_mfma_f32_16x16x32_bf16 v[84:87], v[160:163], v[200:203], v[84:87]
  ds_read_b128 v[188:191], v223 offset:14336
  v_mfma_f32_16x16x32_bf16 v[88:91], v[160:163], v[204:207], v[88:91]
  v_mfma_f32_16x16x32_bf16 v[92:95], v[160:163], v[208:211], v[92:95]
  v_mfma_f32_16x16x32_bf16 v[96:99], v[160:163], v[212:215], v[96:99]
  ds_read_b64_tr_b16 v[160:161], v222 offset:57344
  ds_read_b64_tr_b16 v[162:163], v222 offset:59392
  v_mfma_f32_16x16x32_bf16 v[100:103], v[164:167], v[196:199], v[100:103]
  v_mfma_f32_16x16x32_bf16 v[104:107], v[164:167], v[200:203], v[104:107]
  ds_read_b128 v[192:195], v223 offset:18432
  v_mfma_f32_16x16x32_bf16 v[108:111], v[164:167], v[204:207], v[108:111]
  v_mfma_f32_16x16x32_bf16 v[112:115], v[164:167], v[208:211], v[112:115]
  v_mfma_f32_16x16x32_bf16 v[116:119], v[164:167], v[212:215], v[116:119]
  v_mfma_f32_16x16x32_bf16 v[120:123], v[168:171], v[196:199], v[120:123]
  v_mfma_f32_16x16x32_bf16 v[124:127], v[168:171], v[200:203], v[124:127]
  v_mfma_f32_16x16x32_bf16 v[128:131], v[168:171], v[204:207], v[128:131]
  v_mfma_f32_16x16x32_bf16 v[132:135], v[168:171], v[208:211], v[132:135]
  v_mfma_f32_16x16x32_bf16 v[136:139], v[168:171], v[212:215], v[136:139]
  s_waitcnt lgkmcnt(0)
  s_barrier
  v_mfma_f32_16x16x32_bf16 v[0:3], v[172:175], v[176:179], v[0:3]
  ds_read_b64_tr_b16 v[164:165], v216
  ds_read_b64_tr_b16 v[166:167], v216 offset:2048
  v_mfma_f32_16x16x32_bf16 v[4:7], v[172:175], v[180:183], v[4:7]
  v_mfma_f32_16x16x32_bf16 v[8:11], v[172:175], v[184:187], v[8:11]
  ds_read_b64_tr_b16 v[168:169], v217
  ds_read_b64_tr_b16 v[170:171], v217 offset:2048
  v_mfma_f32_16x16x32_bf16 v[12:15], v[172:175], v[188:191], v[12:15]
  v_mfma_f32_16x16x32_bf16 v[16:19], v[172:175], v[192:195], v[16:19]
  ds_read_b64_tr_b16 v[172:173], v218
  ds_read_b64_tr_b16 v[174:175], v218 offset:2048
  v_mfma_f32_16x16x32_bf16 v[20:23], v[140:143], v[176:179], v[20:23]
  v_mfma_f32_16x16x32_bf16 v[24:27], v[140:143], v[180:183], v[24:27]
  ds_read_b128 v[196:199], v223 offset:3072
  v_mfma_f32_16x16x32_bf16 v[28:31], v[140:143], v[184:187], v[28:31]
  v_mfma_f32_16x16x32_bf16 v[32:35], v[140:143], v[188:191], v[32:35]
  v_mfma_f32_16x16x32_bf16 v[36:39], v[140:143], v[192:195], v[36:39]
  ds_read_b64_tr_b16 v[140:141], v219
  ds_read_b64_tr_b16 v[142:143], v219 offset:2048
  v_mfma_f32_16x16x32_bf16 v[40:43], v[144:147], v[176:179], v[40:43]
  v_mfma_f32_16x16x32_bf16 v[44:47], v[144:147], v[180:183], v[44:47]
  ds_read_b128 v[200:203], v223 offset:7168
  v_mfma_f32_16x16x32_bf16 v[48:51], v[144:147], v[184:187], v[48:51]
  v_mfma_f32_16x16x32_bf16 v[52:55], v[144:147], v[188:191], v[52:55]
  v_mfma_f32_16x16x32_bf16 v[56:59], v[144:147], v[192:195], v[56:59]
  ds_read_b64_tr_b16 v[144:145], v220
  ds_read_b64_tr_b16 v[146:147], v220 offset:2048
  v_mfma_f32_16x16x32_bf16 v[60:63], v[148:151], v[176:179], v[60:63]
  v_mfma_f32_16x16x32_bf16 v[64:67], v[148:151], v[180:183], v[64:67]
  ds_read_b128 v[204:207], v223 offset:11264
  v_mfma_f32_16x16x32_bf16 v[68:71], v[148:151], v[184:187], v[68:71]
  v_mfma_f32_16x16x32_bf16 v[72:75], v[148:151], v[188:191], v[72:75]
  v_mfma_f32_16x16x32_bf16 v[76:79], v[148:151], v[192:195], v[76:79]
  ds_read_b64_tr_b16 v[148:149], v221
  ds_read_b64_tr_b16 v[150:151], v221 offset:2048
  s_waitcnt lgkmcnt(9)
  v_mfma_f32_16x16x32_bf16 v[80:83], v[152:155], v[176:179], v[80:83]
  v_mfma_f32_16x16x32_bf16 v[84:87], v[152:155], v[180:183], v[84:87]
  ds_read_b128 v[208:211], v223 offset:15360
  v_mfma_f32_16x16x32_bf16 v[88:91], v[152:155], v[184:187], v[88:91]
  v_mfma_f32_16x16x32_bf16 v[92:95], v[152:155], v[188:191], v[92:95]
  v_mfma_f32_16x16x32_bf16 v[96:99], v[152:155], v[192:195], v[96:99]
  ds_read_b64_tr_b16 v[152:153], v222
  ds_read_b64_tr_b16 v[154:155], v222 offset:2048
  v_mfma_f32_16x16x32_bf16 v[100:103], v[156:159], v[176:179], v[100:103]
  v_mfma_f32_16x16x32_bf16 v[104:107], v[156:159], v[180:183], v[104:107]
  ds_read_b128 v[212:215], v223 offset:19456
  v_mfma_f32_16x16x32_bf16 v[108:111], v[156:159], v[184:187], v[108:111]
  v_mfma_f32_16x16x32_bf16 v[112:115], v[156:159], v[188:191], v[112:115]
  v_mfma_f32_16x16x32_bf16 v[116:119], v[156:159], v[192:195], v[116:119]
  v_mfma_f32_16x16x32_bf16 v[120:123], v[160:163], v[176:179], v[120:123]
  v_mfma_f32_16x16x32_bf16 v[124:127], v[160:163], v[180:183], v[124:127]
  v_mfma_f32_16x16x32_bf16 v[128:131], v[160:163], v[184:187], v[128:131]
  v_mfma_f32_16x16x32_bf16 v[132:135], v[160:163], v[188:191], v[132:135]
  v_mfma_f32_16x16x32_bf16 v[136:139], v[160:163], v[192:195], v[136:139]
  s_waitcnt lgkmcnt(0)
  s_barrier
  v_mfma_f32_16x16x32_bf16 v[0:3], v[164:167], v[196:199], v[0:3]
  v_mfma_f32_16x16x32_bf16 v[4:7], v[164:167], v[200:203], v[4:7]
  v_mfma_f32_16x16x32_bf16 v[8:11], v[164:167], v[204:207], v[8:11]
  v_mfma_f32_16x16x32_bf16 v[12:15], v[164:167], v[208:211], v[12:15]
  v_mfma_f32_16x16x32_bf16 v[16:19], v[164:167], v[212:215], v[16:19]
  v_mfma_f32_16x16x32_bf16 v[20:23], v[168:171], v[196:199], v[20:23]
  v_mfma_f32_16x16x32_bf16 v[24:27], v[168:171], v[200:203], v[24:27]
  v_mfma_f32_16x16x32_bf16 v[28:31], v[168:171], v[204:207], v[28:31]
  v_mfma_f32_16x16x32_bf16 v[32:35], v[168:171], v[208:211], v[32:35]
  v_mfma_f32_16x16x32_bf16 v[36:39], v[168:171], v[212:215], v[36:39]
  v_mfma_f32_16x16x32_bf16 v[40:43], v[172:175], v[196:199], v[40:43]
  v_mfma_f32_16x16x32_bf16 v[44:47], v[172:175], v[200:203], v[44:47]
  v_mfma_f32_16x16x32_bf16 v[48:51], v[172:175], v[204:207], v[48:51]
  v_mfma_f32_16x16x32_bf16 v[52:55], v[172:175], v[208:211], v[52:55]
  v_mfma_f32_16x16x32_bf16 v[56:59], v[172:175], v[212:215], v[56:59]
  v_mfma_f32_16x16x32_bf16 v[60:63], v[140:143], v[196:199], v[60:63]
  v_mfma_f32_16x16x32_bf16 v[64:67], v[140:143], v[200:203], v[64:67]
  v_mfma_f32_16x16x32_bf16 v[68:71], v[140:143], v[204:207], v[68:71]
  v_mfma_f32_16x16x32_bf16 v[72:75], v[140:143], v[208:211], v[72:75]
  v_mfma_f32_16x16x32_bf16 v[76:79], v[140:143], v[212:215], v[76:79]
  v_mfma_f32_16x16x32_bf16 v[80:83], v[144:147], v[196:199], v[80:83]
  v_mfma_f32_16x16x32_bf16 v[84:87], v[144:147], v[200:203], v[84:87]
  v_mfma_f32_16x16x32_bf16 v[88:91], v[144:147], v[204:207], v[88:91]
  v_mfma_f32_16x16x32_bf16 v[92:95], v[144:147], v[208:211], v[92:95]
  v_mfma_f32_16x16x32_bf16 v[96:99], v[144:147], v[212:215], v[96:99]
  v_mfma_f32_16x16x32_bf16 v[100:103], v[148:151], v[196:199], v[100:103]
  v_mfma_f32_16x16x32_bf16 v[104:107], v[148:151], v[200:203], v[104:107]
  v_mfma_f32_16x16x32_bf16 v[108:111], v[148:151], v[204:207], v[108:111]
  v_mfma_f32_16x16x32_bf16 v[112:115], v[148:151], v[208:211], v[112:115]
  v_mfma_f32_16x16x32_bf16 v[116:119], v[148:151], v[212:215], v[116:119]
  v_mfma_f32_16x16x32_bf16 v[120:123], v[152:155], v[196:199], v[120:123]
  v_mfma_f32_16x16x32_bf16 v[124:127], v[152:155], v[200:203], v[124:127]
  v_mfma_f32_16x16x32_bf16 v[128:131], v[152:155], v[204:207], v[128:131]
  v_mfma_f32_16x16x32_bf16 v[132:135], v[152:155], v[208:211], v[132:135]
  v_mfma_f32_16x16x32_bf16 v[136:139], v[152:155], v[212:215], v[136:139]
  s_waitcnt lgkmcnt(0)
  s_mul_i32 s46, s16, 17920
  s_add_u32 s46, s46, s48
  v_lshlrev_b32 v224, 4, v255
  v_lshlrev_b32 v225, 3, v255
  s_nop 3
  v_cvt_pk_bf16_f32 v140, v0, v1
  v_cvt_pk_bf16_f32 v141, v2, v3
  v_cvt_pk_bf16_f32 v142, v20, v21
  v_cvt_pk_bf16_f32 v143, v22, v23
  s_add_u32 s47, s46, 0
  buffer_store_dwordx4 v[140:143], v224, s[12:15], s47 offen sc1
  v_cvt_pk_bf16_f32 v144, v40, v41
  v_cvt_pk_bf16_f32 v145, v42, v43
  v_cvt_pk_bf16_f32 v146, v60, v61
  v_cvt_pk_bf16_f32 v147, v62, v63
  s_add_u32 s47, s46, 1024
  buffer_store_dwordx4 v[144:147], v224, s[12:15], s47 offen sc1
  v_cvt_pk_bf16_f32 v148, v80, v81
  v_cvt_pk_bf16_f32 v149, v82, v83
  v_cvt_pk_bf16_f32 v150, v100, v101
  v_cvt_pk_bf16_f32 v151, v102, v103
  s_add_u32 s47, s46, 2048
  buffer_store_dwordx4 v[148:151], v224, s[12:15], s47 offen sc1
  v_cvt_pk_bf16_f32 v152, v120, v121
  v_cvt_pk_bf16_f32 v153, v122, v123
  s_add_u32 s47, s46, 3072
  buffer_store_dwordx2 v[152:153], v225, s[12:15], s47 offen sc1
  v_cvt_pk_bf16_f32 v156, v4, v5
  v_cvt_pk_bf16_f32 v157, v6, v7
  v_cvt_pk_bf16_f32 v158, v24, v25
  v_cvt_pk_bf16_f32 v159, v26, v27
  s_add_u32 s47, s46, 3584
  buffer_store_dwordx4 v[156:159], v224, s[12:15], s47 offen sc1
  v_cvt_pk_bf16_f32 v160, v44, v45
  v_cvt_pk_bf16_f32 v161, v46, v47
  v_cvt_pk_bf16_f32 v162, v64, v65
  v_cvt_pk_bf16_f32 v163, v66, v67
  s_add_u32 s47, s46, 4608
  buffer_store_dwordx4 v[160:163], v224, s[12:15], s47 offen sc1
  v_cvt_pk_bf16_f32 v164, v84, v85
  v_cvt_pk_bf16_f32 v165, v86, v87
  v_cvt_pk_bf16_f32 v166, v104, v105
  v_cvt_pk_bf16_f32 v167, v106, v107
  s_add_u32 s47, s46, 5632
  buffer_store_dwordx4 v[164:167], v224, s[12:15], s47 offen sc1
  v_cvt_pk_bf16_f32 v168, v124, v125
  v_cvt_pk_bf16_f32 v169, v126, v127
  s_add_u32 s47, s46, 6656
  buffer_store_dwordx2 v[168:169], v225, s[12:15], s47 offen sc1
  v_cvt_pk_bf16_f32 v140, v8, v9
  v_cvt_pk_bf16_f32 v141, v10, v11
  v_cvt_pk_bf16_f32 v142, v28, v29
  v_cvt_pk_bf16_f32 v143, v30, v31
  s_add_u32 s47, s46, 7168
  buffer_store_dwordx4 v[140:143], v224, s[12:15], s47 offen sc1
  v_cvt_pk_bf16_f32 v144, v48, v49
  v_cvt_pk_bf16_f32 v145, v50, v51
  v_cvt_pk_bf16_f32 v146, v68, v69
  v_cvt_pk_bf16_f32 v147, v70, v71
  s_add_u32 s47, s46, 8192
  buffer_store_dwordx4 v[144:147], v224, s[12:15], s47 offen sc1
  v_cvt_pk_bf16_f32 v148, v88, v89
  v_cvt_pk_bf16_f32 v149, v90, v91
  v_cvt_pk_bf16_f32 v150, v108, v109
  v_cvt_pk_bf16_f32 v151, v110, v111
  s_add_u32 s47, s46, 9216
  buffer_store_dwordx4 v[148:151], v224, s[12:15], s47 offen sc1
  v_cvt_pk_bf16_f32 v152, v128, v129
  v_cvt_pk_bf16_f32 v153, v130, v131
  s_add_u32 s47, s46, 10240
  buffer_store_dwordx2 v[152:153], v225, s[12:15], s47 offen sc1
  v_cvt_pk_bf16_f32 v156, v12, v13
  v_cvt_pk_bf16_f32 v157, v14, v15
  v_cvt_pk_bf16_f32 v158, v32, v33
  v_cvt_pk_bf16_f32 v159, v34, v35
  s_add_u32 s47, s46, 10752
  buffer_store_dwordx4 v[156:159], v224, s[12:15], s47 offen sc1
  v_cvt_pk_bf16_f32 v160, v52, v53
  v_cvt_pk_bf16_f32 v161, v54, v55
  v_cvt_pk_bf16_f32 v162, v72, v73
  v_cvt_pk_bf16_f32 v163, v74, v75
  s_add_u32 s47, s46, 11776
  buffer_store_dwordx4 v[160:163], v224, s[12:15], s47 offen sc1
  v_cvt_pk_bf16_f32 v164, v92, v93
  v_cvt_pk_bf16_f32 v165, v94, v95
  v_cvt_pk_bf16_f32 v166, v112, v113
  v_cvt_pk_bf16_f32 v167, v114, v115
  s_add_u32 s47, s46, 12800
  buffer_store_dwordx4 v[164:167], v224, s[12:15], s47 offen sc1
  v_cvt_pk_bf16_f32 v168, v132, v133
  v_cvt_pk_bf16_f32 v169, v134, v135
  s_add_u32 s47, s46, 13824
  buffer_store_dwordx2 v[168:169], v225, s[12:15], s47 offen sc1
  v_cvt_pk_bf16_f32 v140, v16, v17
  v_cvt_pk_bf16_f32 v141, v18, v19
  v_cvt_pk_bf16_f32 v142, v36, v37
  v_cvt_pk_bf16_f32 v143, v38, v39
  s_add_u32 s47, s46, 14336
  buffer_store_dwordx4 v[140:143], v224, s[12:15], s47 offen sc1
  v_cvt_pk_bf16_f32 v144, v56, v57
  v_cvt_pk_bf16_f32 v145, v58, v59
  v_cvt_pk_bf16_f32 v146, v76, v77
  v_cvt_pk_bf16_f32 v147, v78, v79
  s_add_u32 s47, s46, 15360
  buffer_store_dwordx4 v[144:147], v224, s[12:15], s47 offen sc1
  v_cvt_pk_bf16_f32 v148, v96, v97
  v_cvt_pk_bf16_f32 v149, v98, v99
  v_cvt_pk_bf16_f32 v150, v116, v117
  v_cvt_pk_bf16_f32 v151, v118, v119
  s_add_u32 s47, s46, 16384
  buffer_store_dwordx4 v[148:151], v224, s[12:15], s47 offen sc1
  v_cvt_pk_bf16_f32 v152, v136, v137
  v_cvt_pk_bf16_f32 v153, v138, v139
  s_add_u32 s47, s46, 17408
  buffer_store_dwordx2 v[152:153], v225, s[12:15], s47 offen sc1
  s_branch L_attn_kernel_done
L_attn_kernel_pv:
  s_and_b32 s46, s16, 3
  s_lshl_b32 s46, s46, 15
  v_and_b32 v250, 15, v255
  v_lshrrev_b32 v251, 4, v255
  v_lshrrev_b32 v252, 2, v250
  v_lshl_add_u32 v253, v251, 3, v252
  v_lshlrev_b32 v253, 8, v253
  v_add_u32 v253, s46, v253
  v_and_b32 v248, 3, v250
  v_lshl_add_u32 v253, v248, 3, v253
  v_and_b32 v248, 1, v251
  v_lshl_or_b32 v252, v248, 2, v252
  v_xor_b32 v240, 0, v252
  v_lshl_add_u32 v240, v240, 5, v253
  v_xor_b32 v241, 1, v252
  v_lshl_add_u32 v241, v241, 5, v253
  v_xor_b32 v242, 2, v252
  v_lshl_add_u32 v242, v242, 5, v253
  v_xor_b32 v243, 3, v252
  v_lshl_add_u32 v243, v243, 5, v253
  v_xor_b32 v244, 4, v252
  v_lshl_add_u32 v244, v244, 5, v253
  v_xor_b32 v245, 5, v252
  v_lshl_add_u32 v245, v245, 5, v253
  v_xor_b32 v246, 6, v252
  v_lshl_add_u32 v246, v246, 5, v253
  v_xor_b32 v247, 7, v252
  v_lshl_add_u32 v247, v247, 5, v253
  v_lshrrev_b32 v252, 1, v250
  v_lshlrev_b32 v250, 7, v250
  v_add_u32 v250, 131072, v250
  v_add_u32 v248, 0, v251
  v_xor_b32 v248, v248, v252
  v_lshl_add_u32 v248, v248, 4, v250
  v_add_u32 v249, 4, v251
  v_xor_b32 v249, v249, v252
  v_lshl_add_u32 v249, v249, 4, v250
  s_mul_i32 s46, s51, 229376
  s_lshl_b32 s47, s49, 10
  s_add_u32 s46, s46, s47
  s_and_b32 s47, s16, 3
  s_lshl_b32 s47, s47, 8
  s_add_u32 s46, s46, s47
  v_lshlrev_b32 v250, 13, v255
  s_mov_b64 exec, 0xfffffff
  buffer_load_dword v254, v250, s[8:11], s46 offen
  buffer_load_dword v254, v250, s[8:11], s46 offen offset:128
  s_mov_b64 exec, -1
  s_barrier
  ds_read_b64_tr_b16 v[160:161], v240
  ds_read_b64_tr_b16 v[162:163], v240 offset:1024
  ds_read_b64_tr_b16 v[164:165], v241
  ds_read_b64_tr_b16 v[166:167], v241 offset:1024
  ds_read_b64_tr_b16 v[168:169], v242
  ds_read_b64_tr_b16 v[170:171], v242 offset:1024
  ds_read_b64_tr_b16 v[172:173], v243
  ds_read_b64_tr_b16 v[174:175], v243 offset:1024
  ds_read_b64_tr_b16 v[176:177], v244
  ds_read_b64_tr_b16 v[178:179], v244 offset:1024
  ds_read_b64_tr_b16 v[180:181], v245
  ds_read_b64_tr_b16 v[182:183], v245 offset:1024
  s_waitcnt lgkmcnt(4)
  ds_read_b64_tr_b16 v[184:185], v246
  ds_read_b64_tr_b16 v[186:187], v246 offset:1024
  ds_read_b64_tr_b16 v[188:189], v247
  ds_read_b64_tr_b16 v[190:191], v247 offset:1024
  ds_read_b128 v[200:203], v248 offset:0
  ds_read_b128 v[204:207], v248 offset:2048
  ds_read_b128 v[208:211], v248 offset:4096
  ds_read_b128 v[212:215], v248 offset:6144
  ds_read_b128 v[216:219], v248 offset:8192
  s_waitcnt lgkmcnt(0)
  s_barrier
  v_mfma_f32_16x16x32_bf16 v[0:3], v[160:163], v[200:203], 0
  ds_read_b64_tr_b16 v[192:193], v240 offset:16384
  ds_read_b64_tr_b16 v[194:195], v240 offset:17408
  v_mfma_f32_16x16x32_bf16 v[4:7], v[160:163], v[204:207], 0
  v_mfma_f32_16x16x32_bf16 v[8:11], v[160:163], v[208:211], 0
  ds_read_b64_tr_b16 v[196:197], v241 offset:16384
  ds_read_b64_tr_b16 v[198:199], v241 offset:17408
  v_mfma_f32_16x16x32_bf16 v[12:15], v[160:163], v[212:215], 0
  v_mfma_f32_16x16x32_bf16 v[16:19], v[160:163], v[216:219], 0
  ds_read_b64_tr_b16 v[160:161], v242 offset:16384
  ds_read_b64_tr_b16 v[162:163], v242 offset:17408
  v_mfma_f32_16x16x32_bf16 v[20:23], v[164:167], v[200:203], 0
  v_mfma_f32_16x16x32_bf16 v[24:27], v[164:167], v[204:207], 0
  ds_read_b128 v[220:223], v249 offset:0
  v_mfma_f32_16x16x32_bf16 v[28:31], v[164:167], v[208:211], 0
  v_mfma_f32_16x16x32_bf16 v[32:35], v[164:167], v[212:215], 0
  v_mfma_f32_16x16x32_bf16 v[36:39], v[164:167], v[216:219], 0
  ds_read_b64_tr_b16 v[164:165], v243 offset:16384
  ds_read_b64_tr_b16 v[166:167], v243 offset:17408
  v_mfma_f32_16x16x32_bf16 v[40:43], v[168:171], v[200:203], 0
  v_mfma_f32_16x16x32_bf16 v[44:47], v[168:171], v[204:207], 0
  ds_read_b128 v[224:227], v249 offset:2048
  v_mfma_f32_16x16x32_bf16 v[48:51], v[168:171], v[208:211], 0
  v_mfma_f32_16x16x32_bf16 v[52:55], v[168:171], v[212:215], 0
  v_mfma_f32_16x16x32_bf16 v[56:59], v[168:171], v[216:219], 0
  ds_read_b64_tr_b16 v[168:169], v244 offset:16384
  ds_read_b64_tr_b16 v[170:171], v244 offset:17408
  v_mfma_f32_16x16x32_bf16 v[60:63], v[172:175], v[200:203], 0
  v_mfma_f32_16x16x32_bf16 v[64:67], v[172:175], v[204:207], 0
  ds_read_b128 v[228:231], v249 offset:4096
  v_mfma_f32_16x16x32_bf16 v[68:71], v[172:175], v[208:211], 0
  v_mfma_f32_16x16x32_bf16 v[72:75], v[172:175], v[212:215], 0
  v_mfma_f32_16x16x32_bf16 v[76:79], v[172:175], v[216:219], 0
  ds_read_b64_tr_b16 v[172:173], v245 offset:16384
  ds_read_b64_tr_b16 v[174:175], v245 offset:17408
  s_waitcnt lgkmcnt(9)
  v_mfma_f32_16x16x32_bf16 v[80:83], v[176:179], v[200:203], 0
  v_mfma_f32_16x16x32_bf16 v[84:87], v[176:179], v[204:207], 0
  ds_read_b128 v[232:235], v249 offset:6144
  v_mfma_f32_16x16x32_bf16 v[88:91], v[176:179], v[208:211], 0
  v_mfma_f32_16x16x32_bf16 v[92:95], v[176:179], v[212:215], 0
  v_mfma_f32_16x16x32_bf16 v[96:99], v[176:179], v[216:219], 0
  ds_read_b64_tr_b16 v[176:177], v246 offset:16384
  ds_read_b64_tr_b16 v[178:179], v246 offset:17408
  v_mfma_f32_16x16x32_bf16 v[100:103], v[180:183], v[200:203], 0
  v_mfma_f32_16x16x32_bf16 v[104:107], v[180:183], v[204:207], 0
  ds_read_b128 v[236:239], v249 offset:8192
  v_mfma_f32_16x16x32_bf16 v[108:111], v[180:183], v[208:211], 0
  v_mfma_f32_16x16x32_bf16 v[112:115], v[180:183], v[212:215], 0
  v_mfma_f32_16x16x32_bf16 v[116:119], v[180:183], v[216:219], 0
  ds_read_b64_tr_b16 v[180:181], v247 offset:16384
  ds_read_b64_tr_b16 v[182:183], v247 offset:17408
  v_mfma_f32_16x16x32_bf16 v[120:123], v[184:187], v[200:203], 0
  v_mfma_f32_16x16x32_bf16 v[124:127], v[184:187], v[204:207], 0
  v_mfma_f32_16x16x32_bf16 v[128:131], v[184:187], v[208:211], 0
  v_mfma_f32_16x16x32_bf16 v[132:135], v[184:187], v[212:215], 0
  v_mfma_f32_16x16x32_bf16 v[136:139], v[184:187], v[216:219], 0
  v_mfma_f32_16x16x32_bf16 v[140:143], v[188:191], v[200:203], 0
  v_mfma_f32_16x16x32_bf16 v[144:147], v[188:191], v[204:207], 0
  v_mfma_f32_16x16x32_bf16 v[148:151], v[188:191], v[208:211], 0
  v_mfma_f32_16x16x32_bf16 v[152:155], v[188:191], v[212:215], 0
  v_mfma_f32_16x16x32_bf16 v[156:159], v[188:191], v[216:219], 0
  s_waitcnt lgkmcnt(0)
  s_barrier
  v_mfma_f32_16x16x32_bf16 v[0:3], v[192:195], v[220:223], v[0:3]
  ds_read_b64_tr_b16 v[184:185], v240 offset:8192
  ds_read_b64_tr_b16 v[186:187], v240 offset:9216
  v_mfma_f32_16x16x32_bf16 v[4:7], v[192:195], v[224:227], v[4:7]
  v_mfma_f32_16x16x32_bf16 v[8:11], v[192:195], v[228:231], v[8:11]
  ds_read_b64_tr_b16 v[188:189], v241 offset:8192
  ds_read_b64_tr_b16 v[190:191], v241 offset:9216
  v_mfma_f32_16x16x32_bf16 v[12:15], v[192:195], v[232:235], v[12:15]
  v_mfma_f32_16x16x32_bf16 v[16:19], v[192:195], v[236:239], v[16:19]
  ds_read_b64_tr_b16 v[192:193], v242 offset:8192
  ds_read_b64_tr_b16 v[194:195], v242 offset:9216
  v_mfma_f32_16x16x32_bf16 v[20:23], v[196:199], v[220:223], v[20:23]
  v_mfma_f32_16x16x32_bf16 v[24:27], v[196:199], v[224:227], v[24:27]
  ds_read_b128 v[200:203], v248 offset:10240
  v_mfma_f32_16x16x32_bf16 v[28:31], v[196:199], v[228:231], v[28:31]
  v_mfma_f32_16x16x32_bf16 v[32:35], v[196:199], v[232:235], v[32:35]
  v_mfma_f32_16x16x32_bf16 v[36:39], v[196:199], v[236:239], v[36:39]
  ds_read_b64_tr_b16 v[196:197], v243 offset:8192
  ds_read_b64_tr_b16 v[198:199], v243 offset:9216
  v_mfma_f32_16x16x32_bf16 v[40:43], v[160:163], v[220:223], v[40:43]
  v_mfma_f32_16x16x32_bf16 v[44:47], v[160:163], v[224:227], v[44:47]
  ds_read_b128 v[204:207], v248 offset:12288
  v_mfma_f32_16x16x32_bf16 v[48:51], v[160:163], v[228:231], v[48:51]
  v_mfma_f32_16x16x32_bf16 v[52:55], v[160:163], v[232:235], v[52:55]
  v_mfma_f32_16x16x32_bf16 v[56:59], v[160:163], v[236:239], v[56:59]
  ds_read_b64_tr_b16 v[160:161], v244 offset:8192
  ds_read_b64_tr_b16 v[162:163], v244 offset:9216
  v_mfma_f32_16x16x32_bf16 v[60:63], v[164:167], v[220:223], v[60:63]
  v_mfma_f32_16x16x32_bf16 v[64:67], v[164:167], v[224:227], v[64:67]
  ds_read_b128 v[208:211], v248 offset:14336
  v_mfma_f32_16x16x32_bf16 v[68:71], v[164:167], v[228:231], v[68:71]
  v_mfma_f32_16x16x32_bf16 v[72:75], v[164:167], v[232:235], v[72:75]
  v_mfma_f32_16x16x32_bf16 v[76:79], v[164:167], v[236:239], v[76:79]
  ds_read_b64_tr_b16 v[164:165], v245 offset:8192
  ds_read_b64_tr_b16 v[166:167], v245 offset:9216
  s_waitcnt lgkmcnt(9)
  v_mfma_f32_16x16x32_bf16 v[80:83], v[168:171], v[220:223], v[80:83]
  v_mfma_f32_16x16x32_bf16 v[84:87], v[168:171], v[224:227], v[84:87]
  ds_read_b128 v[212:215], v248 offset:16384
  v_mfma_f32_16x16x32_bf16 v[88:91], v[168:171], v[228:231], v[88:91]
  v_mfma_f32_16x16x32_bf16 v[92:95], v[168:171], v[232:235], v[92:95]
  v_mfma_f32_16x16x32_bf16 v[96:99], v[168:171], v[236:239], v[96:99]
  ds_read_b64_tr_b16 v[168:169], v246 offset:8192
  ds_read_b64_tr_b16 v[170:171], v246 offset:9216
  v_mfma_f32_16x16x32_bf16 v[100:103], v[172:175], v[220:223], v[100:103]
  v_mfma_f32_16x16x32_bf16 v[104:107], v[172:175], v[224:227], v[104:107]
  ds_read_b128 v[216:219], v248 offset:18432
  v_mfma_f32_16x16x32_bf16 v[108:111], v[172:175], v[228:231], v[108:111]
  v_mfma_f32_16x16x32_bf16 v[112:115], v[172:175], v[232:235], v[112:115]
  v_mfma_f32_16x16x32_bf16 v[116:119], v[172:175], v[236:239], v[116:119]
  ds_read_b64_tr_b16 v[172:173], v247 offset:8192
  ds_read_b64_tr_b16 v[174:175], v247 offset:9216
  v_mfma_f32_16x16x32_bf16 v[120:123], v[176:179], v[220:223], v[120:123]
  v_mfma_f32_16x16x32_bf16 v[124:127], v[176:179], v[224:227], v[124:127]
  v_mfma_f32_16x16x32_bf16 v[128:131], v[176:179], v[228:231], v[128:131]
  v_mfma_f32_16x16x32_bf16 v[132:135], v[176:179], v[232:235], v[132:135]
  v_mfma_f32_16x16x32_bf16 v[136:139], v[176:179], v[236:239], v[136:139]
  v_mfma_f32_16x16x32_bf16 v[140:143], v[180:183], v[220:223], v[140:143]
  v_mfma_f32_16x16x32_bf16 v[144:147], v[180:183], v[224:227], v[144:147]
  v_mfma_f32_16x16x32_bf16 v[148:151], v[180:183], v[228:231], v[148:151]
  v_mfma_f32_16x16x32_bf16 v[152:155], v[180:183], v[232:235], v[152:155]
  v_mfma_f32_16x16x32_bf16 v[156:159], v[180:183], v[236:239], v[156:159]
  s_waitcnt lgkmcnt(0)
  s_barrier
  v_mfma_f32_16x16x32_bf16 v[0:3], v[184:187], v[200:203], v[0:3]
  ds_read_b64_tr_b16 v[176:177], v240 offset:24576
  ds_read_b64_tr_b16 v[178:179], v240 offset:25600
  v_mfma_f32_16x16x32_bf16 v[4:7], v[184:187], v[204:207], v[4:7]
  v_mfma_f32_16x16x32_bf16 v[8:11], v[184:187], v[208:211], v[8:11]
  ds_read_b64_tr_b16 v[180:181], v241 offset:24576
  ds_read_b64_tr_b16 v[182:183], v241 offset:25600
  v_mfma_f32_16x16x32_bf16 v[12:15], v[184:187], v[212:215], v[12:15]
  v_mfma_f32_16x16x32_bf16 v[16:19], v[184:187], v[216:219], v[16:19]
  ds_read_b64_tr_b16 v[184:185], v242 offset:24576
  ds_read_b64_tr_b16 v[186:187], v242 offset:25600
  v_mfma_f32_16x16x32_bf16 v[20:23], v[188:191], v[200:203], v[20:23]
  v_mfma_f32_16x16x32_bf16 v[24:27], v[188:191], v[204:207], v[24:27]
  ds_read_b128 v[220:223], v249 offset:10240
  v_mfma_f32_16x16x32_bf16 v[28:31], v[188:191], v[208:211], v[28:31]
  v_mfma_f32_16x16x32_bf16 v[32:35], v[188:191], v[212:215], v[32:35]
  v_mfma_f32_16x16x32_bf16 v[36:39], v[188:191], v[216:219], v[36:39]
  ds_read_b64_tr_b16 v[188:189], v243 offset:24576
  ds_read_b64_tr_b16 v[190:191], v243 offset:25600
  v_mfma_f32_16x16x32_bf16 v[40:43], v[192:195], v[200:203], v[40:43]
  v_mfma_f32_16x16x32_bf16 v[44:47], v[192:195], v[204:207], v[44:47]
  ds_read_b128 v[224:227], v249 offset:12288
  v_mfma_f32_16x16x32_bf16 v[48:51], v[192:195], v[208:211], v[48:51]
  v_mfma_f32_16x16x32_bf16 v[52:55], v[192:195], v[212:215], v[52:55]
  v_mfma_f32_16x16x32_bf16 v[56:59], v[192:195], v[216:219], v[56:59]
  ds_read_b64_tr_b16 v[192:193], v244 offset:24576
  ds_read_b64_tr_b16 v[194:195], v244 offset:25600
  v_mfma_f32_16x16x32_bf16 v[60:63], v[196:199], v[200:203], v[60:63]
  v_mfma_f32_16x16x32_bf16 v[64:67], v[196:199], v[204:207], v[64:67]
  ds_read_b128 v[228:231], v249 offset:14336
  v_mfma_f32_16x16x32_bf16 v[68:71], v[196:199], v[208:211], v[68:71]
  v_mfma_f32_16x16x32_bf16 v[72:75], v[196:199], v[212:215], v[72:75]
  v_mfma_f32_16x16x32_bf16 v[76:79], v[196:199], v[216:219], v[76:79]
  ds_read_b64_tr_b16 v[196:197], v245 offset:24576
  ds_read_b64_tr_b16 v[198:199], v245 offset:25600
  s_waitcnt lgkmcnt(9)
  v_mfma_f32_16x16x32_bf16 v[80:83], v[160:163], v[200:203], v[80:83]
  v_mfma_f32_16x16x32_bf16 v[84:87], v[160:163], v[204:207], v[84:87]
  ds_read_b128 v[232:235], v249 offset:16384
  v_mfma_f32_16x16x32_bf16 v[88:91], v[160:163], v[208:211], v[88:91]
  v_mfma_f32_16x16x32_bf16 v[92:95], v[160:163], v[212:215], v[92:95]
  v_mfma_f32_16x16x32_bf16 v[96:99], v[160:163], v[216:219], v[96:99]
  ds_read_b64_tr_b16 v[160:161], v246 offset:24576
  ds_read_b64_tr_b16 v[162:163], v246 offset:25600
  v_mfma_f32_16x16x32_bf16 v[100:103], v[164:167], v[200:203], v[100:103]
  v_mfma_f32_16x16x32_bf16 v[104:107], v[164:167], v[204:207], v[104:107]
  ds_read_b128 v[236:239], v249 offset:18432
  v_mfma_f32_16x16x32_bf16 v[108:111], v[164:167], v[208:211], v[108:111]
  v_mfma_f32_16x16x32_bf16 v[112:115], v[164:167], v[212:215], v[112:115]
  v_mfma_f32_16x16x32_bf16 v[116:119], v[164:167], v[216:219], v[116:119]
  ds_read_b64_tr_b16 v[164:165], v247 offset:24576
  ds_read_b64_tr_b16 v[166:167], v247 offset:25600
  v_mfma_f32_16x16x32_bf16 v[120:123], v[168:171], v[200:203], v[120:123]
  v_mfma_f32_16x16x32_bf16 v[124:127], v[168:171], v[204:207], v[124:127]
  v_mfma_f32_16x16x32_bf16 v[128:131], v[168:171], v[208:211], v[128:131]
  v_mfma_f32_16x16x32_bf16 v[132:135], v[168:171], v[212:215], v[132:135]
  v_mfma_f32_16x16x32_bf16 v[136:139], v[168:171], v[216:219], v[136:139]
  v_mfma_f32_16x16x32_bf16 v[140:143], v[172:175], v[200:203], v[140:143]
  v_mfma_f32_16x16x32_bf16 v[144:147], v[172:175], v[204:207], v[144:147]
  v_mfma_f32_16x16x32_bf16 v[148:151], v[172:175], v[208:211], v[148:151]
  v_mfma_f32_16x16x32_bf16 v[152:155], v[172:175], v[212:215], v[152:155]
  v_mfma_f32_16x16x32_bf16 v[156:159], v[172:175], v[216:219], v[156:159]
  s_waitcnt lgkmcnt(0)
  s_barrier
  v_mfma_f32_16x16x32_bf16 v[0:3], v[176:179], v[220:223], v[0:3]
  ds_read_b64_tr_b16 v[168:169], v240
  ds_read_b64_tr_b16 v[170:171], v240 offset:1024
  v_mfma_f32_16x16x32_bf16 v[4:7], v[176:179], v[224:227], v[4:7]
  v_mfma_f32_16x16x32_bf16 v[8:11], v[176:179], v[228:231], v[8:11]
  ds_read_b64_tr_b16 v[172:173], v241
  ds_read_b64_tr_b16 v[174:175], v241 offset:1024
  v_mfma_f32_16x16x32_bf16 v[12:15], v[176:179], v[232:235], v[12:15]
  v_mfma_f32_16x16x32_bf16 v[16:19], v[176:179], v[236:239], v[16:19]
  ds_read_b64_tr_b16 v[176:177], v242
  ds_read_b64_tr_b16 v[178:179], v242 offset:1024
  v_mfma_f32_16x16x32_bf16 v[20:23], v[180:183], v[220:223], v[20:23]
  v_mfma_f32_16x16x32_bf16 v[24:27], v[180:183], v[224:227], v[24:27]
  ds_read_b128 v[200:203], v248 offset:20480
  v_mfma_f32_16x16x32_bf16 v[28:31], v[180:183], v[228:231], v[28:31]
  v_mfma_f32_16x16x32_bf16 v[32:35], v[180:183], v[232:235], v[32:35]
  v_mfma_f32_16x16x32_bf16 v[36:39], v[180:183], v[236:239], v[36:39]
  ds_read_b64_tr_b16 v[180:181], v243
  ds_read_b64_tr_b16 v[182:183], v243 offset:1024
  v_mfma_f32_16x16x32_bf16 v[40:43], v[184:187], v[220:223], v[40:43]
  v_mfma_f32_16x16x32_bf16 v[44:47], v[184:187], v[224:227], v[44:47]
  ds_read_b128 v[204:207], v248 offset:22528
  v_mfma_f32_16x16x32_bf16 v[48:51], v[184:187], v[228:231], v[48:51]
  v_mfma_f32_16x16x32_bf16 v[52:55], v[184:187], v[232:235], v[52:55]
  v_mfma_f32_16x16x32_bf16 v[56:59], v[184:187], v[236:239], v[56:59]
  ds_read_b64_tr_b16 v[184:185], v244
  ds_read_b64_tr_b16 v[186:187], v244 offset:1024
  v_mfma_f32_16x16x32_bf16 v[60:63], v[188:191], v[220:223], v[60:63]
  v_mfma_f32_16x16x32_bf16 v[64:67], v[188:191], v[224:227], v[64:67]
  ds_read_b128 v[208:211], v248 offset:24576
  v_mfma_f32_16x16x32_bf16 v[68:71], v[188:191], v[228:231], v[68:71]
  v_mfma_f32_16x16x32_bf16 v[72:75], v[188:191], v[232:235], v[72:75]
  v_mfma_f32_16x16x32_bf16 v[76:79], v[188:191], v[236:239], v[76:79]
  ds_read_b64_tr_b16 v[188:189], v245
  ds_read_b64_tr_b16 v[190:191], v245 offset:1024
  s_waitcnt lgkmcnt(9)
  v_mfma_f32_16x16x32_bf16 v[80:83], v[192:195], v[220:223], v[80:83]
  v_mfma_f32_16x16x32_bf16 v[84:87], v[192:195], v[224:227], v[84:87]
  ds_read_b128 v[212:215], v248 offset:26624
  v_mfma_f32_16x16x32_bf16 v[88:91], v[192:195], v[228:231], v[88:91]
  v_mfma_f32_16x16x32_bf16 v[92:95], v[192:195], v[232:235], v[92:95]
  v_mfma_f32_16x16x32_bf16 v[96:99], v[192:195], v[236:239], v[96:99]
  ds_read_b64_tr_b16 v[192:193], v246
  ds_read_b64_tr_b16 v[194:195], v246 offset:1024
  v_mfma_f32_16x16x32_bf16 v[100:103], v[196:199], v[220:223], v[100:103]
  v_mfma_f32_16x16x32_bf16 v[104:107], v[196:199], v[224:227], v[104:107]
  ds_read_b128 v[216:219], v248 offset:28672
  v_mfma_f32_16x16x32_bf16 v[108:111], v[196:199], v[228:231], v[108:111]
  v_mfma_f32_16x16x32_bf16 v[112:115], v[196:199], v[232:235], v[112:115]
  v_mfma_f32_16x16x32_bf16 v[116:119], v[196:199], v[236:239], v[116:119]
  ds_read_b64_tr_b16 v[196:197], v247
  ds_read_b64_tr_b16 v[198:199], v247 offset:1024
  v_mfma_f32_16x16x32_bf16 v[120:123], v[160:163], v[220:223], v[120:123]
  v_mfma_f32_16x16x32_bf16 v[124:127], v[160:163], v[224:227], v[124:127]
  v_mfma_f32_16x16x32_bf16 v[128:131], v[160:163], v[228:231], v[128:131]
  v_mfma_f32_16x16x32_bf16 v[132:135], v[160:163], v[232:235], v[132:135]
  v_mfma_f32_16x16x32_bf16 v[136:139], v[160:163], v[236:239], v[136:139]
  v_mfma_f32_16x16x32_bf16 v[140:143], v[164:167], v[220:223], v[140:143]
  v_mfma_f32_16x16x32_bf16 v[144:147], v[164:167], v[224:227], v[144:147]
  v_mfma_f32_16x16x32_bf16 v[148:151], v[164:167], v[228:231], v[148:151]
  v_mfma_f32_16x16x32_bf16 v[152:155], v[164:167], v[232:235], v[152:155]
  v_mfma_f32_16x16x32_bf16 v[156:159], v[164:167], v[236:239], v[156:159]
  s_waitcnt lgkmcnt(0)
  s_barrier
  v_mfma_f32_16x16x32_bf16 v[0:3], v[168:171], v[200:203], v[0:3]
  ds_read_b64_tr_b16 v[160:161], v240 offset:16384
  ds_read_b64_tr_b16 v[162:163], v240 offset:17408
  v_mfma_f32_16x16x32_bf16 v[4:7], v[168:171], v[204:207], v[4:7]
  v_mfma_f32_16x16x32_bf16 v[8:11], v[168:171], v[208:211], v[8:11]
  ds_read_b64_tr_b16 v[164:165], v241 offset:16384
  ds_read_b64_tr_b16 v[166:167], v241 offset:17408
  v_mfma_f32_16x16x32_bf16 v[12:15], v[168:171], v[212:215], v[12:15]
  v_mfma_f32_16x16x32_bf16 v[16:19], v[168:171], v[216:219], v[16:19]
  ds_read_b64_tr_b16 v[168:169], v242 offset:16384
  ds_read_b64_tr_b16 v[170:171], v242 offset:17408
  v_mfma_f32_16x16x32_bf16 v[20:23], v[172:175], v[200:203], v[20:23]
  v_mfma_f32_16x16x32_bf16 v[24:27], v[172:175], v[204:207], v[24:27]
  ds_read_b128 v[220:223], v249 offset:20480
  v_mfma_f32_16x16x32_bf16 v[28:31], v[172:175], v[208:211], v[28:31]
  v_mfma_f32_16x16x32_bf16 v[32:35], v[172:175], v[212:215], v[32:35]
  v_mfma_f32_16x16x32_bf16 v[36:39], v[172:175], v[216:219], v[36:39]
  ds_read_b64_tr_b16 v[172:173], v243 offset:16384
  ds_read_b64_tr_b16 v[174:175], v243 offset:17408
  v_mfma_f32_16x16x32_bf16 v[40:43], v[176:179], v[200:203], v[40:43]
  v_mfma_f32_16x16x32_bf16 v[44:47], v[176:179], v[204:207], v[44:47]
  ds_read_b128 v[224:227], v249 offset:22528
  v_mfma_f32_16x16x32_bf16 v[48:51], v[176:179], v[208:211], v[48:51]
  v_mfma_f32_16x16x32_bf16 v[52:55], v[176:179], v[212:215], v[52:55]
  v_mfma_f32_16x16x32_bf16 v[56:59], v[176:179], v[216:219], v[56:59]
  ds_read_b64_tr_b16 v[176:177], v244 offset:16384
  ds_read_b64_tr_b16 v[178:179], v244 offset:17408
  v_mfma_f32_16x16x32_bf16 v[60:63], v[180:183], v[200:203], v[60:63]
  v_mfma_f32_16x16x32_bf16 v[64:67], v[180:183], v[204:207], v[64:67]
  ds_read_b128 v[228:231], v249 offset:24576
  v_mfma_f32_16x16x32_bf16 v[68:71], v[180:183], v[208:211], v[68:71]
  v_mfma_f32_16x16x32_bf16 v[72:75], v[180:183], v[212:215], v[72:75]
  v_mfma_f32_16x16x32_bf16 v[76:79], v[180:183], v[216:219], v[76:79]
  ds_read_b64_tr_b16 v[180:181], v245 offset:16384
  ds_read_b64_tr_b16 v[182:183], v245 offset:17408
  s_waitcnt lgkmcnt(9)
  v_mfma_f32_16x16x32_bf16 v[80:83], v[184:187], v[200:203], v[80:83]
  v_mfma_f32_16x16x32_bf16 v[84:87], v[184:187], v[204:207], v[84:87]
  ds_read_b128 v[232:235], v249 offset:26624
  v_mfma_f32_16x16x32_bf16 v[88:91], v[184:187], v[208:211], v[88:91]
  v_mfma_f32_16x16x32_bf16 v[92:95], v[184:187], v[212:215], v[92:95]
  v_mfma_f32_16x16x32_bf16 v[96:99], v[184:187], v[216:219], v[96:99]
  ds_read_b64_tr_b16 v[184:185], v246 offset:16384
  ds_read_b64_tr_b16 v[186:187], v246 offset:17408
  v_mfma_f32_16x16x32_bf16 v[100:103], v[188:191], v[200:203], v[100:103]
  v_mfma_f32_16x16x32_bf16 v[104:107], v[188:191], v[204:207], v[104:107]
  ds_read_b128 v[236:239], v249 offset:28672
  v_mfma_f32_16x16x32_bf16 v[108:111], v[188:191], v[208:211], v[108:111]
  v_mfma_f32_16x16x32_bf16 v[112:115], v[188:191], v[212:215], v[112:115]
  v_mfma_f32_16x16x32_bf16 v[116:119], v[188:191], v[216:219], v[116:119]
  ds_read_b64_tr_b16 v[188:189], v247 offset:16384
  ds_read_b64_tr_b16 v[190:191], v247 offset:17408
  v_mfma_f32_16x16x32_bf16 v[120:123], v[192:195], v[200:203], v[120:123]
  v_mfma_f32_16x16x32_bf16 v[124:127], v[192:195], v[204:207], v[124:127]
  v_mfma_f32_16x16x32_bf16 v[128:131], v[192:195], v[208:211], v[128:131]
  v_mfma_f32_16x16x32_bf16 v[132:135], v[192:195], v[212:215], v[132:135]
  v_mfma_f32_16x16x32_bf16 v[136:139], v[192:195], v[216:219], v[136:139]
  v_mfma_f32_16x16x32_bf16 v[140:143], v[196:199], v[200:203], v[140:143]
  v_mfma_f32_16x16x32_bf16 v[144:147], v[196:199], v[204:207], v[144:147]
  v_mfma_f32_16x16x32_bf16 v[148:151], v[196:199], v[208:211], v[148:151]
  v_mfma_f32_16x16x32_bf16 v[152:155], v[196:199], v[212:215], v[152:155]
  v_mfma_f32_16x16x32_bf16 v[156:159], v[196:199], v[216:219], v[156:159]
  s_waitcnt lgkmcnt(0)
  s_barrier
  v_mfma_f32_16x16x32_bf16 v[0:3], v[160:163], v[220:223], v[0:3]
  ds_read_b64_tr_b16 v[192:193], v240 offset:8192
  ds_read_b64_tr_b16 v[194:195], v240 offset:9216
  v_mfma_f32_16x16x32_bf16 v[4:7], v[160:163], v[224:227], v[4:7]
  v_mfma_f32_16x16x32_bf16 v[8:11], v[160:163], v[228:231], v[8:11]
  ds_read_b64_tr_b16 v[196:197], v241 offset:8192
  ds_read_b64_tr_b16 v[198:199], v241 offset:9216
  v_mfma_f32_16x16x32_bf16 v[12:15], v[160:163], v[232:235], v[12:15]
  v_mfma_f32_16x16x32_bf16 v[16:19], v[160:163], v[236:239], v[16:19]
  ds_read_b64_tr_b16 v[160:161], v242 offset:8192
  ds_read_b64_tr_b16 v[162:163], v242 offset:9216
  v_mfma_f32_16x16x32_bf16 v[20:23], v[164:167], v[220:223], v[20:23]
  v_mfma_f32_16x16x32_bf16 v[24:27], v[164:167], v[224:227], v[24:27]
  ds_read_b128 v[200:203], v248 offset:0
  v_mfma_f32_16x16x32_bf16 v[28:31], v[164:167], v[228:231], v[28:31]
  v_mfma_f32_16x16x32_bf16 v[32:35], v[164:167], v[232:235], v[32:35]
  v_mfma_f32_16x16x32_bf16 v[36:39], v[164:167], v[236:239], v[36:39]
  ds_read_b64_tr_b16 v[164:165], v243 offset:8192
  ds_read_b64_tr_b16 v[166:167], v243 offset:9216
  v_mfma_f32_16x16x32_bf16 v[40:43], v[168:171], v[220:223], v[40:43]
  v_mfma_f32_16x16x32_bf16 v[44:47], v[168:171], v[224:227], v[44:47]
  ds_read_b128 v[204:207], v248 offset:2048
  v_mfma_f32_16x16x32_bf16 v[48:51], v[168:171], v[228:231], v[48:51]
  v_mfma_f32_16x16x32_bf16 v[52:55], v[168:171], v[232:235], v[52:55]
  v_mfma_f32_16x16x32_bf16 v[56:59], v[168:171], v[236:239], v[56:59]
  ds_read_b64_tr_b16 v[168:169], v244 offset:8192
  ds_read_b64_tr_b16 v[170:171], v244 offset:9216
  v_mfma_f32_16x16x32_bf16 v[60:63], v[172:175], v[220:223], v[60:63]
  v_mfma_f32_16x16x32_bf16 v[64:67], v[172:175], v[224:227], v[64:67]
  ds_read_b128 v[208:211], v248 offset:4096
  v_mfma_f32_16x16x32_bf16 v[68:71], v[172:175], v[228:231], v[68:71]
  v_mfma_f32_16x16x32_bf16 v[72:75], v[172:175], v[232:235], v[72:75]
  v_mfma_f32_16x16x32_bf16 v[76:79], v[172:175], v[236:239], v[76:79]
  ds_read_b64_tr_b16 v[172:173], v245 offset:8192
  ds_read_b64_tr_b16 v[174:175], v245 offset:9216
  s_waitcnt lgkmcnt(9)
  v_mfma_f32_16x16x32_bf16 v[80:83], v[176:179], v[220:223], v[80:83]
  v_mfma_f32_16x16x32_bf16 v[84:87], v[176:179], v[224:227], v[84:87]
  ds_read_b128 v[212:215], v248 offset:6144
  v_mfma_f32_16x16x32_bf16 v[88:91], v[176:179], v[228:231], v[88:91]
  v_mfma_f32_16x16x32_bf16 v[92:95], v[176:179], v[232:235], v[92:95]
  v_mfma_f32_16x16x32_bf16 v[96:99], v[176:179], v[236:239], v[96:99]
  ds_read_b64_tr_b16 v[176:177], v246 offset:8192
  ds_read_b64_tr_b16 v[178:179], v246 offset:9216
  v_mfma_f32_16x16x32_bf16 v[100:103], v[180:183], v[220:223], v[100:103]
  v_mfma_f32_16x16x32_bf16 v[104:107], v[180:183], v[224:227], v[104:107]
  ds_read_b128 v[216:219], v248 offset:8192
  v_mfma_f32_16x16x32_bf16 v[108:111], v[180:183], v[228:231], v[108:111]
  v_mfma_f32_16x16x32_bf16 v[112:115], v[180:183], v[232:235], v[112:115]
  v_mfma_f32_16x16x32_bf16 v[116:119], v[180:183], v[236:239], v[116:119]
  ds_read_b64_tr_b16 v[180:181], v247 offset:8192
  ds_read_b64_tr_b16 v[182:183], v247 offset:9216
  v_mfma_f32_16x16x32_bf16 v[120:123], v[184:187], v[220:223], v[120:123]
  v_mfma_f32_16x16x32_bf16 v[124:127], v[184:187], v[224:227], v[124:127]
  v_mfma_f32_16x16x32_bf16 v[128:131], v[184:187], v[228:231], v[128:131]
  v_mfma_f32_16x16x32_bf16 v[132:135], v[184:187], v[232:235], v[132:135]
  v_mfma_f32_16x16x32_bf16 v[136:139], v[184:187], v[236:239], v[136:139]
  v_mfma_f32_16x16x32_bf16 v[140:143], v[188:191], v[220:223], v[140:143]
  v_mfma_f32_16x16x32_bf16 v[144:147], v[188:191], v[224:227], v[144:147]
  v_mfma_f32_16x16x32_bf16 v[148:151], v[188:191], v[228:231], v[148:151]
  v_mfma_f32_16x16x32_bf16 v[152:155], v[188:191], v[232:235], v[152:155]
  v_mfma_f32_16x16x32_bf16 v[156:159], v[188:191], v[236:239], v[156:159]
  s_waitcnt lgkmcnt(0)
  s_barrier
  v_mfma_f32_16x16x32_bf16 v[0:3], v[192:195], v[200:203], v[0:3]
  ds_read_b64_tr_b16 v[184:185], v240 offset:24576
  ds_read_b64_tr_b16 v[186:187], v240 offset:25600
  v_mfma_f32_16x16x32_bf16 v[4:7], v[192:195], v[204:207], v[4:7]
  v_mfma_f32_16x16x32_bf16 v[8:11], v[192:195], v[208:211], v[8:11]
  ds_read_b64_tr_b16 v[188:189], v241 offset:24576
  ds_read_b64_tr_b16 v[190:191], v241 offset:25600
  v_mfma_f32_16x16x32_bf16 v[12:15], v[192:195], v[212:215], v[12:15]
  v_mfma_f32_16x16x32_bf16 v[16:19], v[192:195], v[216:219], v[16:19]
  ds_read_b64_tr_b16 v[192:193], v242 offset:24576
  ds_read_b64_tr_b16 v[194:195], v242 offset:25600
  v_mfma_f32_16x16x32_bf16 v[20:23], v[196:199], v[200:203], v[20:23]
  v_mfma_f32_16x16x32_bf16 v[24:27], v[196:199], v[204:207], v[24:27]
  ds_read_b128 v[220:223], v249 offset:0
  v_mfma_f32_16x16x32_bf16 v[28:31], v[196:199], v[208:211], v[28:31]
  v_mfma_f32_16x16x32_bf16 v[32:35], v[196:199], v[212:215], v[32:35]
  v_mfma_f32_16x16x32_bf16 v[36:39], v[196:199], v[216:219], v[36:39]
  ds_read_b64_tr_b16 v[196:197], v243 offset:24576
  ds_read_b64_tr_b16 v[198:199], v243 offset:25600
  v_mfma_f32_16x16x32_bf16 v[40:43], v[160:163], v[200:203], v[40:43]
  v_mfma_f32_16x16x32_bf16 v[44:47], v[160:163], v[204:207], v[44:47]
  ds_read_b128 v[224:227], v249 offset:2048
  v_mfma_f32_16x16x32_bf16 v[48:51], v[160:163], v[208:211], v[48:51]
  v_mfma_f32_16x16x32_bf16 v[52:55], v[160:163], v[212:215], v[52:55]
  v_mfma_f32_16x16x32_bf16 v[56:59], v[160:163], v[216:219], v[56:59]
  ds_read_b64_tr_b16 v[160:161], v244 offset:24576
  ds_read_b64_tr_b16 v[162:163], v244 offset:25600
  v_mfma_f32_16x16x32_bf16 v[60:63], v[164:167], v[200:203], v[60:63]
  v_mfma_f32_16x16x32_bf16 v[64:67], v[164:167], v[204:207], v[64:67]
  ds_read_b128 v[228:231], v249 offset:4096
  v_mfma_f32_16x16x32_bf16 v[68:71], v[164:167], v[208:211], v[68:71]
  v_mfma_f32_16x16x32_bf16 v[72:75], v[164:167], v[212:215], v[72:75]
  v_mfma_f32_16x16x32_bf16 v[76:79], v[164:167], v[216:219], v[76:79]
  ds_read_b64_tr_b16 v[164:165], v245 offset:24576
  ds_read_b64_tr_b16 v[166:167], v245 offset:25600
  s_waitcnt lgkmcnt(9)
  v_mfma_f32_16x16x32_bf16 v[80:83], v[168:171], v[200:203], v[80:83]
  v_mfma_f32_16x16x32_bf16 v[84:87], v[168:171], v[204:207], v[84:87]
  ds_read_b128 v[232:235], v249 offset:6144
  v_mfma_f32_16x16x32_bf16 v[88:91], v[168:171], v[208:211], v[88:91]
  v_mfma_f32_16x16x32_bf16 v[92:95], v[168:171], v[212:215], v[92:95]
  v_mfma_f32_16x16x32_bf16 v[96:99], v[168:171], v[216:219], v[96:99]
  ds_read_b64_tr_b16 v[168:169], v246 offset:24576
  ds_read_b64_tr_b16 v[170:171], v246 offset:25600
  v_mfma_f32_16x16x32_bf16 v[100:103], v[172:175], v[200:203], v[100:103]
  v_mfma_f32_16x16x32_bf16 v[104:107], v[172:175], v[204:207], v[104:107]
  ds_read_b128 v[236:239], v249 offset:8192
  v_mfma_f32_16x16x32_bf16 v[108:111], v[172:175], v[208:211], v[108:111]
  v_mfma_f32_16x16x32_bf16 v[112:115], v[172:175], v[212:215], v[112:115]
  v_mfma_f32_16x16x32_bf16 v[116:119], v[172:175], v[216:219], v[116:119]
  ds_read_b64_tr_b16 v[172:173], v247 offset:24576
  ds_read_b64_tr_b16 v[174:175], v247 offset:25600
  v_mfma_f32_16x16x32_bf16 v[120:123], v[176:179], v[200:203], v[120:123]
  v_mfma_f32_16x16x32_bf16 v[124:127], v[176:179], v[204:207], v[124:127]
  v_mfma_f32_16x16x32_bf16 v[128:131], v[176:179], v[208:211], v[128:131]
  v_mfma_f32_16x16x32_bf16 v[132:135], v[176:179], v[212:215], v[132:135]
  v_mfma_f32_16x16x32_bf16 v[136:139], v[176:179], v[216:219], v[136:139]
  v_mfma_f32_16x16x32_bf16 v[140:143], v[180:183], v[200:203], v[140:143]
  v_mfma_f32_16x16x32_bf16 v[144:147], v[180:183], v[204:207], v[144:147]
  v_mfma_f32_16x16x32_bf16 v[148:151], v[180:183], v[208:211], v[148:151]
  v_mfma_f32_16x16x32_bf16 v[152:155], v[180:183], v[212:215], v[152:155]
  v_mfma_f32_16x16x32_bf16 v[156:159], v[180:183], v[216:219], v[156:159]
  s_waitcnt lgkmcnt(0)
  s_barrier
  v_mfma_f32_16x16x32_bf16 v[0:3], v[184:187], v[220:223], v[0:3]
  ds_read_b64_tr_b16 v[176:177], v240
  ds_read_b64_tr_b16 v[178:179], v240 offset:1024
  v_mfma_f32_16x16x32_bf16 v[4:7], v[184:187], v[224:227], v[4:7]
  v_mfma_f32_16x16x32_bf16 v[8:11], v[184:187], v[228:231], v[8:11]
  ds_read_b64_tr_b16 v[180:181], v241
  ds_read_b64_tr_b16 v[182:183], v241 offset:1024
  v_mfma_f32_16x16x32_bf16 v[12:15], v[184:187], v[232:235], v[12:15]
  v_mfma_f32_16x16x32_bf16 v[16:19], v[184:187], v[236:239], v[16:19]
  ds_read_b64_tr_b16 v[184:185], v242
  ds_read_b64_tr_b16 v[186:187], v242 offset:1024
  v_mfma_f32_16x16x32_bf16 v[20:23], v[188:191], v[220:223], v[20:23]
  v_mfma_f32_16x16x32_bf16 v[24:27], v[188:191], v[224:227], v[24:27]
  ds_read_b128 v[200:203], v248 offset:10240
  v_mfma_f32_16x16x32_bf16 v[28:31], v[188:191], v[228:231], v[28:31]
  v_mfma_f32_16x16x32_bf16 v[32:35], v[188:191], v[232:235], v[32:35]
  v_mfma_f32_16x16x32_bf16 v[36:39], v[188:191], v[236:239], v[36:39]
  ds_read_b64_tr_b16 v[188:189], v243
  ds_read_b64_tr_b16 v[190:191], v243 offset:1024
  v_mfma_f32_16x16x32_bf16 v[40:43], v[192:195], v[220:223], v[40:43]
  v_mfma_f32_16x16x32_bf16 v[44:47], v[192:195], v[224:227], v[44:47]
  ds_read_b128 v[204:207], v248 offset:12288
  v_mfma_f32_16x16x32_bf16 v[48:51], v[192:195], v[228:231], v[48:51]
  v_mfma_f32_16x16x32_bf16 v[52:55], v[192:195], v[232:235], v[52:55]
  v_mfma_f32_16x16x32_bf16 v[56:59], v[192:195], v[236:239], v[56:59]
  ds_read_b64_tr_b16 v[192:193], v244
  ds_read_b64_tr_b16 v[194:195], v244 offset:1024
  v_mfma_f32_16x16x32_bf16 v[60:63], v[196:199], v[220:223], v[60:63]
  v_mfma_f32_16x16x32_bf16 v[64:67], v[196:199], v[224:227], v[64:67]
  ds_read_b128 v[208:211], v248 offset:14336
  v_mfma_f32_16x16x32_bf16 v[68:71], v[196:199], v[228:231], v[68:71]
  v_mfma_f32_16x16x32_bf16 v[72:75], v[196:199], v[232:235], v[72:75]
  v_mfma_f32_16x16x32_bf16 v[76:79], v[196:199], v[236:239], v[76:79]
  ds_read_b64_tr_b16 v[196:197], v245
  ds_read_b64_tr_b16 v[198:199], v245 offset:1024
  s_waitcnt lgkmcnt(9)
  v_mfma_f32_16x16x32_bf16 v[80:83], v[160:163], v[220:223], v[80:83]
  v_mfma_f32_16x16x32_bf16 v[84:87], v[160:163], v[224:227], v[84:87]
  ds_read_b128 v[212:215], v248 offset:16384
  v_mfma_f32_16x16x32_bf16 v[88:91], v[160:163], v[228:231], v[88:91]
  v_mfma_f32_16x16x32_bf16 v[92:95], v[160:163], v[232:235], v[92:95]
  v_mfma_f32_16x16x32_bf16 v[96:99], v[160:163], v[236:239], v[96:99]
  ds_read_b64_tr_b16 v[160:161], v246
  ds_read_b64_tr_b16 v[162:163], v246 offset:1024
  v_mfma_f32_16x16x32_bf16 v[100:103], v[164:167], v[220:223], v[100:103]
  v_mfma_f32_16x16x32_bf16 v[104:107], v[164:167], v[224:227], v[104:107]
  ds_read_b128 v[216:219], v248 offset:18432
  v_mfma_f32_16x16x32_bf16 v[108:111], v[164:167], v[228:231], v[108:111]
  v_mfma_f32_16x16x32_bf16 v[112:115], v[164:167], v[232:235], v[112:115]
  v_mfma_f32_16x16x32_bf16 v[116:119], v[164:167], v[236:239], v[116:119]
  ds_read_b64_tr_b16 v[164:165], v247
  ds_read_b64_tr_b16 v[166:167], v247 offset:1024
  v_mfma_f32_16x16x32_bf16 v[120:123], v[168:171], v[220:223], v[120:123]
  v_mfma_f32_16x16x32_bf16 v[124:127], v[168:171], v[224:227], v[124:127]
  v_mfma_f32_16x16x32_bf16 v[128:131], v[168:171], v[228:231], v[128:131]
  v_mfma_f32_16x16x32_bf16 v[132:135], v[168:171], v[232:235], v[132:135]
  v_mfma_f32_16x16x32_bf16 v[136:139], v[168:171], v[236:239], v[136:139]
  v_mfma_f32_16x16x32_bf16 v[140:143], v[172:175], v[220:223], v[140:143]
  v_mfma_f32_16x16x32_bf16 v[144:147], v[172:175], v[224:227], v[144:147]
  v_mfma_f32_16x16x32_bf16 v[148:151], v[172:175], v[228:231], v[148:151]
  v_mfma_f32_16x16x32_bf16 v[152:155], v[172:175], v[232:235], v[152:155]
  v_mfma_f32_16x16x32_bf16 v[156:159], v[172:175], v[236:239], v[156:159]
  s_waitcnt lgkmcnt(0)
  s_barrier
  v_mfma_f32_16x16x32_bf16 v[0:3], v[176:179], v[200:203], v[0:3]
  ds_read_b64_tr_b16 v[168:169], v240 offset:16384
  ds_read_b64_tr_b16 v[170:171], v240 offset:17408
  v_mfma_f32_16x16x32_bf16 v[4:7], v[176:179], v[204:207], v[4:7]
  v_mfma_f32_16x16x32_bf16 v[8:11], v[176:179], v[208:211], v[8:11]
  ds_read_b64_tr_b16 v[172:173], v241 offset:16384
  ds_read_b64_tr_b16 v[174:175], v241 offset:17408
  v_mfma_f32_16x16x32_bf16 v[12:15], v[176:179], v[212:215], v[12:15]
  v_mfma_f32_16x16x32_bf16 v[16:19], v[176:179], v[216:219], v[16:19]
  ds_read_b64_tr_b16 v[176:177], v242 offset:16384
  ds_read_b64_tr_b16 v[178:179], v242 offset:17408
  v_mfma_f32_16x16x32_bf16 v[20:23], v[180:183], v[200:203], v[20:23]
  v_mfma_f32_16x16x32_bf16 v[24:27], v[180:183], v[204:207], v[24:27]
  ds_read_b128 v[220:223], v249 offset:10240
  v_mfma_f32_16x16x32_bf16 v[28:31], v[180:183], v[208:211], v[28:31]
  v_mfma_f32_16x16x32_bf16 v[32:35], v[180:183], v[212:215], v[32:35]
  v_mfma_f32_16x16x32_bf16 v[36:39], v[180:183], v[216:219], v[36:39]
  ds_read_b64_tr_b16 v[180:181], v243 offset:16384
  ds_read_b64_tr_b16 v[182:183], v243 offset:17408
  v_mfma_f32_16x16x32_bf16 v[40:43], v[184:187], v[200:203], v[40:43]
  v_mfma_f32_16x16x32_bf16 v[44:47], v[184:187], v[204:207], v[44:47]
  ds_read_b128 v[224:227], v249 offset:12288
  v_mfma_f32_16x16x32_bf16 v[48:51], v[184:187], v[208:211], v[48:51]
  v_mfma_f32_16x16x32_bf16 v[52:55], v[184:187], v[212:215], v[52:55]
  v_mfma_f32_16x16x32_bf16 v[56:59], v[184:187], v[216:219], v[56:59]
  ds_read_b64_tr_b16 v[184:185], v244 offset:16384
  ds_read_b64_tr_b16 v[186:187], v244 offset:17408
  v_mfma_f32_16x16x32_bf16 v[60:63], v[188:191], v[200:203], v[60:63]
  v_mfma_f32_16x16x32_bf16 v[64:67], v[188:191], v[204:207], v[64:67]
  ds_read_b128 v[228:231], v249 offset:14336
  v_mfma_f32_16x16x32_bf16 v[68:71], v[188:191], v[208:211], v[68:71]
  v_mfma_f32_16x16x32_bf16 v[72:75], v[188:191], v[212:215], v[72:75]
  v_mfma_f32_16x16x32_bf16 v[76:79], v[188:191], v[216:219], v[76:79]
  ds_read_b64_tr_b16 v[188:189], v245 offset:16384
  ds_read_b64_tr_b16 v[190:191], v245 offset:17408
  s_waitcnt lgkmcnt(9)
  v_mfma_f32_16x16x32_bf16 v[80:83], v[192:195], v[200:203], v[80:83]
  v_mfma_f32_16x16x32_bf16 v[84:87], v[192:195], v[204:207], v[84:87]
  ds_read_b128 v[232:235], v249 offset:16384
  v_mfma_f32_16x16x32_bf16 v[88:91], v[192:195], v[208:211], v[88:91]
  v_mfma_f32_16x16x32_bf16 v[92:95], v[192:195], v[212:215], v[92:95]
  v_mfma_f32_16x16x32_bf16 v[96:99], v[192:195], v[216:219], v[96:99]
  ds_read_b64_tr_b16 v[192:193], v246 offset:16384
  ds_read_b64_tr_b16 v[194:195], v246 offset:17408
  v_mfma_f32_16x16x32_bf16 v[100:103], v[196:199], v[200:203], v[100:103]
  v_mfma_f32_16x16x32_bf16 v[104:107], v[196:199], v[204:207], v[104:107]
  ds_read_b128 v[236:239], v249 offset:18432
  v_mfma_f32_16x16x32_bf16 v[108:111], v[196:199], v[208:211], v[108:111]
  v_mfma_f32_16x16x32_bf16 v[112:115], v[196:199], v[212:215], v[112:115]
  v_mfma_f32_16x16x32_bf16 v[116:119], v[196:199], v[216:219], v[116:119]
  ds_read_b64_tr_b16 v[196:197], v247 offset:16384
  ds_read_b64_tr_b16 v[198:199], v247 offset:17408
  v_mfma_f32_16x16x32_bf16 v[120:123], v[160:163], v[200:203], v[120:123]
  v_mfma_f32_16x16x32_bf16 v[124:127], v[160:163], v[204:207], v[124:127]
  v_mfma_f32_16x16x32_bf16 v[128:131], v[160:163], v[208:211], v[128:131]
  v_mfma_f32_16x16x32_bf16 v[132:135], v[160:163], v[212:215], v[132:135]
  v_mfma_f32_16x16x32_bf16 v[136:139], v[160:163], v[216:219], v[136:139]
  v_mfma_f32_16x16x32_bf16 v[140:143], v[164:167], v[200:203], v[140:143]
  v_mfma_f32_16x16x32_bf16 v[144:147], v[164:167], v[204:207], v[144:147]
  v_mfma_f32_16x16x32_bf16 v[148:151], v[164:167], v[208:211], v[148:151]
  v_mfma_f32_16x16x32_bf16 v[152:155], v[164:167], v[212:215], v[152:155]
  v_mfma_f32_16x16x32_bf16 v[156:159], v[164:167], v[216:219], v[156:159]
  s_waitcnt lgkmcnt(0)
  s_barrier
  v_mfma_f32_16x16x32_bf16 v[0:3], v[168:171], v[220:223], v[0:3]
  ds_read_b64_tr_b16 v[160:161], v240 offset:8192
  ds_read_b64_tr_b16 v[162:163], v240 offset:9216
  v_mfma_f32_16x16x32_bf16 v[4:7], v[168:171], v[224:227], v[4:7]
  v_mfma_f32_16x16x32_bf16 v[8:11], v[168:171], v[228:231], v[8:11]
  ds_read_b64_tr_b16 v[164:165], v241 offset:8192
  ds_read_b64_tr_b16 v[166:167], v241 offset:9216
  v_mfma_f32_16x16x32_bf16 v[12:15], v[168:171], v[232:235], v[12:15]
  v_mfma_f32_16x16x32_bf16 v[16:19], v[168:171], v[236:239], v[16:19]
  ds_read_b64_tr_b16 v[168:169], v242 offset:8192
  ds_read_b64_tr_b16 v[170:171], v242 offset:9216
  v_mfma_f32_16x16x32_bf16 v[20:23], v[172:175], v[220:223], v[20:23]
  v_mfma_f32_16x16x32_bf16 v[24:27], v[172:175], v[224:227], v[24:27]
  ds_read_b128 v[200:203], v248 offset:20480
  v_mfma_f32_16x16x32_bf16 v[28:31], v[172:175], v[228:231], v[28:31]
  v_mfma_f32_16x16x32_bf16 v[32:35], v[172:175], v[232:235], v[32:35]
  v_mfma_f32_16x16x32_bf16 v[36:39], v[172:175], v[236:239], v[36:39]
  ds_read_b64_tr_b16 v[172:173], v243 offset:8192
  ds_read_b64_tr_b16 v[174:175], v243 offset:9216
  v_mfma_f32_16x16x32_bf16 v[40:43], v[176:179], v[220:223], v[40:43]
  v_mfma_f32_16x16x32_bf16 v[44:47], v[176:179], v[224:227], v[44:47]
  ds_read_b128 v[204:207], v248 offset:22528
  v_mfma_f32_16x16x32_bf16 v[48:51], v[176:179], v[228:231], v[48:51]
  v_mfma_f32_16x16x32_bf16 v[52:55], v[176:179], v[232:235], v[52:55]
  v_mfma_f32_16x16x32_bf16 v[56:59], v[176:179], v[236:239], v[56:59]
  ds_read_b64_tr_b16 v[176:177], v244 offset:8192
  ds_read_b64_tr_b16 v[178:179], v244 offset:9216
  v_mfma_f32_16x16x32_bf16 v[60:63], v[180:183], v[220:223], v[60:63]
  v_mfma_f32_16x16x32_bf16 v[64:67], v[180:183], v[224:227], v[64:67]
  ds_read_b128 v[208:211], v248 offset:24576
  v_mfma_f32_16x16x32_bf16 v[68:71], v[180:183], v[228:231], v[68:71]
  v_mfma_f32_16x16x32_bf16 v[72:75], v[180:183], v[232:235], v[72:75]
  v_mfma_f32_16x16x32_bf16 v[76:79], v[180:183], v[236:239], v[76:79]
  ds_read_b64_tr_b16 v[180:181], v245 offset:8192
  ds_read_b64_tr_b16 v[182:183], v245 offset:9216
  s_waitcnt lgkmcnt(9)
  v_mfma_f32_16x16x32_bf16 v[80:83], v[184:187], v[220:223], v[80:83]
  v_mfma_f32_16x16x32_bf16 v[84:87], v[184:187], v[224:227], v[84:87]
  ds_read_b128 v[212:215], v248 offset:26624
  v_mfma_f32_16x16x32_bf16 v[88:91], v[184:187], v[228:231], v[88:91]
  v_mfma_f32_16x16x32_bf16 v[92:95], v[184:187], v[232:235], v[92:95]
  v_mfma_f32_16x16x32_bf16 v[96:99], v[184:187], v[236:239], v[96:99]
  ds_read_b64_tr_b16 v[184:185], v246 offset:8192
  ds_read_b64_tr_b16 v[186:187], v246 offset:9216
  v_mfma_f32_16x16x32_bf16 v[100:103], v[188:191], v[220:223], v[100:103]
  v_mfma_f32_16x16x32_bf16 v[104:107], v[188:191], v[224:227], v[104:107]
  ds_read_b128 v[216:219], v248 offset:28672
  v_mfma_f32_16x16x32_bf16 v[108:111], v[188:191], v[228:231], v[108:111]
  v_mfma_f32_16x16x32_bf16 v[112:115], v[188:191], v[232:235], v[112:115]
  v_mfma_f32_16x16x32_bf16 v[116:119], v[188:191], v[236:239], v[116:119]
  ds_read_b64_tr_b16 v[188:189], v247 offset:8192
  ds_read_b64_tr_b16 v[190:191], v247 offset:9216
  v_mfma_f32_16x16x32_bf16 v[120:123], v[192:195], v[220:223], v[120:123]
  v_mfma_f32_16x16x32_bf16 v[124:127], v[192:195], v[224:227], v[124:127]
  v_mfma_f32_16x16x32_bf16 v[128:131], v[192:195], v[228:231], v[128:131]
  v_mfma_f32_16x16x32_bf16 v[132:135], v[192:195], v[232:235], v[132:135]
  v_mfma_f32_16x16x32_bf16 v[136:139], v[192:195], v[236:239], v[136:139]
  v_mfma_f32_16x16x32_bf16 v[140:143], v[196:199], v[220:223], v[140:143]
  v_mfma_f32_16x16x32_bf16 v[144:147], v[196:199], v[224:227], v[144:147]
  v_mfma_f32_16x16x32_bf16 v[148:151], v[196:199], v[228:231], v[148:151]
  v_mfma_f32_16x16x32_bf16 v[152:155], v[196:199], v[232:235], v[152:155]
  v_mfma_f32_16x16x32_bf16 v[156:159], v[196:199], v[236:239], v[156:159]
  s_waitcnt lgkmcnt(0)
  s_barrier
  v_mfma_f32_16x16x32_bf16 v[0:3], v[160:163], v[200:203], v[0:3]
  ds_read_b64_tr_b16 v[192:193], v240 offset:24576
  ds_read_b64_tr_b16 v[194:195], v240 offset:25600
  v_mfma_f32_16x16x32_bf16 v[4:7], v[160:163], v[204:207], v[4:7]
  v_mfma_f32_16x16x32_bf16 v[8:11], v[160:163], v[208:211], v[8:11]
  ds_read_b64_tr_b16 v[196:197], v241 offset:24576
  ds_read_b64_tr_b16 v[198:199], v241 offset:25600
  v_mfma_f32_16x16x32_bf16 v[12:15], v[160:163], v[212:215], v[12:15]
  v_mfma_f32_16x16x32_bf16 v[16:19], v[160:163], v[216:219], v[16:19]
  ds_read_b64_tr_b16 v[160:161], v242 offset:24576
  ds_read_b64_tr_b16 v[162:163], v242 offset:25600
  v_mfma_f32_16x16x32_bf16 v[20:23], v[164:167], v[200:203], v[20:23]
  v_mfma_f32_16x16x32_bf16 v[24:27], v[164:167], v[204:207], v[24:27]
  ds_read_b128 v[220:223], v249 offset:20480
  v_mfma_f32_16x16x32_bf16 v[28:31], v[164:167], v[208:211], v[28:31]
  v_mfma_f32_16x16x32_bf16 v[32:35], v[164:167], v[212:215], v[32:35]
  v_mfma_f32_16x16x32_bf16 v[36:39], v[164:167], v[216:219], v[36:39]
  ds_read_b64_tr_b16 v[164:165], v243 offset:24576
  ds_read_b64_tr_b16 v[166:167], v243 offset:25600
  v_mfma_f32_16x16x32_bf16 v[40:43], v[168:171], v[200:203], v[40:43]
  v_mfma_f32_16x16x32_bf16 v[44:47], v[168:171], v[204:207], v[44:47]
  ds_read_b128 v[224:227], v249 offset:22528
  v_mfma_f32_16x16x32_bf16 v[48:51], v[168:171], v[208:211], v[48:51]
  v_mfma_f32_16x16x32_bf16 v[52:55], v[168:171], v[212:215], v[52:55]
  v_mfma_f32_16x16x32_bf16 v[56:59], v[168:171], v[216:219], v[56:59]
  ds_read_b64_tr_b16 v[168:169], v244 offset:24576
  ds_read_b64_tr_b16 v[170:171], v244 offset:25600
  v_mfma_f32_16x16x32_bf16 v[60:63], v[172:175], v[200:203], v[60:63]
  v_mfma_f32_16x16x32_bf16 v[64:67], v[172:175], v[204:207], v[64:67]
  ds_read_b128 v[228:231], v249 offset:24576
  v_mfma_f32_16x16x32_bf16 v[68:71], v[172:175], v[208:211], v[68:71]
  v_mfma_f32_16x16x32_bf16 v[72:75], v[172:175], v[212:215], v[72:75]
  v_mfma_f32_16x16x32_bf16 v[76:79], v[172:175], v[216:219], v[76:79]
  ds_read_b64_tr_b16 v[172:173], v245 offset:24576
  ds_read_b64_tr_b16 v[174:175], v245 offset:25600
  s_waitcnt lgkmcnt(9)
  v_mfma_f32_16x16x32_bf16 v[80:83], v[176:179], v[200:203], v[80:83]
  v_mfma_f32_16x16x32_bf16 v[84:87], v[176:179], v[204:207], v[84:87]
  ds_read_b128 v[232:235], v249 offset:26624
  v_mfma_f32_16x16x32_bf16 v[88:91], v[176:179], v[208:211], v[88:91]
  v_mfma_f32_16x16x32_bf16 v[92:95], v[176:179], v[212:215], v[92:95]
  v_mfma_f32_16x16x32_bf16 v[96:99], v[176:179], v[216:219], v[96:99]
  ds_read_b64_tr_b16 v[176:177], v246 offset:24576
  ds_read_b64_tr_b16 v[178:179], v246 offset:25600
  v_mfma_f32_16x16x32_bf16 v[100:103], v[180:183], v[200:203], v[100:103]
  v_mfma_f32_16x16x32_bf16 v[104:107], v[180:183], v[204:207], v[104:107]
  ds_read_b128 v[236:239], v249 offset:28672
  v_mfma_f32_16x16x32_bf16 v[108:111], v[180:183], v[208:211], v[108:111]
  v_mfma_f32_16x16x32_bf16 v[112:115], v[180:183], v[212:215], v[112:115]
  v_mfma_f32_16x16x32_bf16 v[116:119], v[180:183], v[216:219], v[116:119]
  ds_read_b64_tr_b16 v[180:181], v247 offset:24576
  ds_read_b64_tr_b16 v[182:183], v247 offset:25600
  v_mfma_f32_16x16x32_bf16 v[120:123], v[184:187], v[200:203], v[120:123]
  v_mfma_f32_16x16x32_bf16 v[124:127], v[184:187], v[204:207], v[124:127]
  v_mfma_f32_16x16x32_bf16 v[128:131], v[184:187], v[208:211], v[128:131]
  v_mfma_f32_16x16x32_bf16 v[132:135], v[184:187], v[212:215], v[132:135]
  v_mfma_f32_16x16x32_bf16 v[136:139], v[184:187], v[216:219], v[136:139]
  v_mfma_f32_16x16x32_bf16 v[140:143], v[188:191], v[200:203], v[140:143]
  v_mfma_f32_16x16x32_bf16 v[144:147], v[188:191], v[204:207], v[144:147]
  v_mfma_f32_16x16x32_bf16 v[148:151], v[188:191], v[208:211], v[148:151]
  v_mfma_f32_16x16x32_bf16 v[152:155], v[188:191], v[212:215], v[152:155]
  v_mfma_f32_16x16x32_bf16 v[156:159], v[188:191], v[216:219], v[156:159]
  s_waitcnt lgkmcnt(0)
  s_barrier
  v_mfma_f32_16x16x32_bf16 v[0:3], v[192:195], v[220:223], v[0:3]
  ds_read_b64_tr_b16 v[184:185], v240
  ds_read_b64_tr_b16 v[186:187], v240 offset:1024
  v_mfma_f32_16x16x32_bf16 v[4:7], v[192:195], v[224:227], v[4:7]
  v_mfma_f32_16x16x32_bf16 v[8:11], v[192:195], v[228:231], v[8:11]
  ds_read_b64_tr_b16 v[188:189], v241
  ds_read_b64_tr_b16 v[190:191], v241 offset:1024
  v_mfma_f32_16x16x32_bf16 v[12:15], v[192:195], v[232:235], v[12:15]
  v_mfma_f32_16x16x32_bf16 v[16:19], v[192:195], v[236:239], v[16:19]
  ds_read_b64_tr_b16 v[192:193], v242
  ds_read_b64_tr_b16 v[194:195], v242 offset:1024
  v_mfma_f32_16x16x32_bf16 v[20:23], v[196:199], v[220:223], v[20:23]
  v_mfma_f32_16x16x32_bf16 v[24:27], v[196:199], v[224:227], v[24:27]
  ds_read_b128 v[200:203], v248 offset:0
  v_mfma_f32_16x16x32_bf16 v[28:31], v[196:199], v[228:231], v[28:31]
  v_mfma_f32_16x16x32_bf16 v[32:35], v[196:199], v[232:235], v[32:35]
  v_mfma_f32_16x16x32_bf16 v[36:39], v[196:199], v[236:239], v[36:39]
  ds_read_b64_tr_b16 v[196:197], v243
  ds_read_b64_tr_b16 v[198:199], v243 offset:1024
  v_mfma_f32_16x16x32_bf16 v[40:43], v[160:163], v[220:223], v[40:43]
  v_mfma_f32_16x16x32_bf16 v[44:47], v[160:163], v[224:227], v[44:47]
  ds_read_b128 v[204:207], v248 offset:2048
  v_mfma_f32_16x16x32_bf16 v[48:51], v[160:163], v[228:231], v[48:51]
  v_mfma_f32_16x16x32_bf16 v[52:55], v[160:163], v[232:235], v[52:55]
  v_mfma_f32_16x16x32_bf16 v[56:59], v[160:163], v[236:239], v[56:59]
  ds_read_b64_tr_b16 v[160:161], v244
  ds_read_b64_tr_b16 v[162:163], v244 offset:1024
  v_mfma_f32_16x16x32_bf16 v[60:63], v[164:167], v[220:223], v[60:63]
  v_mfma_f32_16x16x32_bf16 v[64:67], v[164:167], v[224:227], v[64:67]
  ds_read_b128 v[208:211], v248 offset:4096
  v_mfma_f32_16x16x32_bf16 v[68:71], v[164:167], v[228:231], v[68:71]
  v_mfma_f32_16x16x32_bf16 v[72:75], v[164:167], v[232:235], v[72:75]
  v_mfma_f32_16x16x32_bf16 v[76:79], v[164:167], v[236:239], v[76:79]
  ds_read_b64_tr_b16 v[164:165], v245
  ds_read_b64_tr_b16 v[166:167], v245 offset:1024
  s_waitcnt lgkmcnt(9)
  v_mfma_f32_16x16x32_bf16 v[80:83], v[168:171], v[220:223], v[80:83]
  v_mfma_f32_16x16x32_bf16 v[84:87], v[168:171], v[224:227], v[84:87]
  ds_read_b128 v[212:215], v248 offset:6144
  v_mfma_f32_16x16x32_bf16 v[88:91], v[168:171], v[228:231], v[88:91]
  v_mfma_f32_16x16x32_bf16 v[92:95], v[168:171], v[232:235], v[92:95]
  v_mfma_f32_16x16x32_bf16 v[96:99], v[168:171], v[236:239], v[96:99]
  ds_read_b64_tr_b16 v[168:169], v246
  ds_read_b64_tr_b16 v[170:171], v246 offset:1024
  v_mfma_f32_16x16x32_bf16 v[100:103], v[172:175], v[220:223], v[100:103]
  v_mfma_f32_16x16x32_bf16 v[104:107], v[172:175], v[224:227], v[104:107]
  ds_read_b128 v[216:219], v248 offset:8192
  v_mfma_f32_16x16x32_bf16 v[108:111], v[172:175], v[228:231], v[108:111]
  v_mfma_f32_16x16x32_bf16 v[112:115], v[172:175], v[232:235], v[112:115]
  v_mfma_f32_16x16x32_bf16 v[116:119], v[172:175], v[236:239], v[116:119]
  ds_read_b64_tr_b16 v[172:173], v247
  ds_read_b64_tr_b16 v[174:175], v247 offset:1024
  v_mfma_f32_16x16x32_bf16 v[120:123], v[176:179], v[220:223], v[120:123]
  v_mfma_f32_16x16x32_bf16 v[124:127], v[176:179], v[224:227], v[124:127]
  v_mfma_f32_16x16x32_bf16 v[128:131], v[176:179], v[228:231], v[128:131]
  v_mfma_f32_16x16x32_bf16 v[132:135], v[176:179], v[232:235], v[132:135]
  v_mfma_f32_16x16x32_bf16 v[136:139], v[176:179], v[236:239], v[136:139]
  v_mfma_f32_16x16x32_bf16 v[140:143], v[180:183], v[220:223], v[140:143]
  v_mfma_f32_16x16x32_bf16 v[144:147], v[180:183], v[224:227], v[144:147]
  v_mfma_f32_16x16x32_bf16 v[148:151], v[180:183], v[228:231], v[148:151]
  v_mfma_f32_16x16x32_bf16 v[152:155], v[180:183], v[232:235], v[152:155]
  v_mfma_f32_16x16x32_bf16 v[156:159], v[180:183], v[236:239], v[156:159]
  s_waitcnt lgkmcnt(0)
  s_barrier
  v_mfma_f32_16x16x32_bf16 v[0:3], v[184:187], v[200:203], v[0:3]
  ds_read_b64_tr_b16 v[176:177], v240 offset:16384
  ds_read_b64_tr_b16 v[178:179], v240 offset:17408
  v_mfma_f32_16x16x32_bf16 v[4:7], v[184:187], v[204:207], v[4:7]
  v_mfma_f32_16x16x32_bf16 v[8:11], v[184:187], v[208:211], v[8:11]
  ds_read_b64_tr_b16 v[180:181], v241 offset:16384
  ds_read_b64_tr_b16 v[182:183], v241 offset:17408
  v_mfma_f32_16x16x32_bf16 v[12:15], v[184:187], v[212:215], v[12:15]
  v_mfma_f32_16x16x32_bf16 v[16:19], v[184:187], v[216:219], v[16:19]
  ds_read_b64_tr_b16 v[184:185], v242 offset:16384
  ds_read_b64_tr_b16 v[186:187], v242 offset:17408
  v_mfma_f32_16x16x32_bf16 v[20:23], v[188:191], v[200:203], v[20:23]
  v_mfma_f32_16x16x32_bf16 v[24:27], v[188:191], v[204:207], v[24:27]
  ds_read_b128 v[220:223], v249 offset:0
  v_mfma_f32_16x16x32_bf16 v[28:31], v[188:191], v[208:211], v[28:31]
  v_mfma_f32_16x16x32_bf16 v[32:35], v[188:191], v[212:215], v[32:35]
  v_mfma_f32_16x16x32_bf16 v[36:39], v[188:191], v[216:219], v[36:39]
  ds_read_b64_tr_b16 v[188:189], v243 offset:16384
  ds_read_b64_tr_b16 v[190:191], v243 offset:17408
  v_mfma_f32_16x16x32_bf16 v[40:43], v[192:195], v[200:203], v[40:43]
  v_mfma_f32_16x16x32_bf16 v[44:47], v[192:195], v[204:207], v[44:47]
  ds_read_b128 v[224:227], v249 offset:2048
  v_mfma_f32_16x16x32_bf16 v[48:51], v[192:195], v[208:211], v[48:51]
  v_mfma_f32_16x16x32_bf16 v[52:55], v[192:195], v[212:215], v[52:55]
  v_mfma_f32_16x16x32_bf16 v[56:59], v[192:195], v[216:219], v[56:59]
  ds_read_b64_tr_b16 v[192:193], v244 offset:16384
  ds_read_b64_tr_b16 v[194:195], v244 offset:17408
  v_mfma_f32_16x16x32_bf16 v[60:63], v[196:199], v[200:203], v[60:63]
  v_mfma_f32_16x16x32_bf16 v[64:67], v[196:199], v[204:207], v[64:67]
  ds_read_b128 v[228:231], v249 offset:4096
  v_mfma_f32_16x16x32_bf16 v[68:71], v[196:199], v[208:211], v[68:71]
  v_mfma_f32_16x16x32_bf16 v[72:75], v[196:199], v[212:215], v[72:75]
  v_mfma_f32_16x16x32_bf16 v[76:79], v[196:199], v[216:219], v[76:79]
  ds_read_b64_tr_b16 v[196:197], v245 offset:16384
  ds_read_b64_tr_b16 v[198:199], v245 offset:17408
  s_waitcnt lgkmcnt(9)
  v_mfma_f32_16x16x32_bf16 v[80:83], v[160:163], v[200:203], v[80:83]
  v_mfma_f32_16x16x32_bf16 v[84:87], v[160:163], v[204:207], v[84:87]
  ds_read_b128 v[232:235], v249 offset:6144
  v_mfma_f32_16x16x32_bf16 v[88:91], v[160:163], v[208:211], v[88:91]
  v_mfma_f32_16x16x32_bf16 v[92:95], v[160:163], v[212:215], v[92:95]
  v_mfma_f32_16x16x32_bf16 v[96:99], v[160:163], v[216:219], v[96:99]
  ds_read_b64_tr_b16 v[160:161], v246 offset:16384
  ds_read_b64_tr_b16 v[162:163], v246 offset:17408
  v_mfma_f32_16x16x32_bf16 v[100:103], v[164:167], v[200:203], v[100:103]
  v_mfma_f32_16x16x32_bf16 v[104:107], v[164:167], v[204:207], v[104:107]
  ds_read_b128 v[236:239], v249 offset:8192
  v_mfma_f32_16x16x32_bf16 v[108:111], v[164:167], v[208:211], v[108:111]
  v_mfma_f32_16x16x32_bf16 v[112:115], v[164:167], v[212:215], v[112:115]
  v_mfma_f32_16x16x32_bf16 v[116:119], v[164:167], v[216:219], v[116:119]
  ds_read_b64_tr_b16 v[164:165], v247 offset:16384
  ds_read_b64_tr_b16 v[166:167], v247 offset:17408
  v_mfma_f32_16x16x32_bf16 v[120:123], v[168:171], v[200:203], v[120:123]
  v_mfma_f32_16x16x32_bf16 v[124:127], v[168:171], v[204:207], v[124:127]
  v_mfma_f32_16x16x32_bf16 v[128:131], v[168:171], v[208:211], v[128:131]
  v_mfma_f32_16x16x32_bf16 v[132:135], v[168:171], v[212:215], v[132:135]
  v_mfma_f32_16x16x32_bf16 v[136:139], v[168:171], v[216:219], v[136:139]
  v_mfma_f32_16x16x32_bf16 v[140:143], v[172:175], v[200:203], v[140:143]
  v_mfma_f32_16x16x32_bf16 v[144:147], v[172:175], v[204:207], v[144:147]
  v_mfma_f32_16x16x32_bf16 v[148:151], v[172:175], v[208:211], v[148:151]
  v_mfma_f32_16x16x32_bf16 v[152:155], v[172:175], v[212:215], v[152:155]
  v_mfma_f32_16x16x32_bf16 v[156:159], v[172:175], v[216:219], v[156:159]
  s_waitcnt lgkmcnt(0)
  s_barrier
  v_mfma_f32_16x16x32_bf16 v[0:3], v[176:179], v[220:223], v[0:3]
  v_mfma_f32_16x16x32_bf16 v[4:7], v[176:179], v[224:227], v[4:7]
  v_mfma_f32_16x16x32_bf16 v[8:11], v[176:179], v[228:231], v[8:11]
  v_mfma_f32_16x16x32_bf16 v[12:15], v[176:179], v[232:235], v[12:15]
  v_mfma_f32_16x16x32_bf16 v[16:19], v[176:179], v[236:239], v[16:19]
  v_mfma_f32_16x16x32_bf16 v[20:23], v[180:183], v[220:223], v[20:23]
  v_mfma_f32_16x16x32_bf16 v[24:27], v[180:183], v[224:227], v[24:27]
  v_mfma_f32_16x16x32_bf16 v[28:31], v[180:183], v[228:231], v[28:31]
  v_mfma_f32_16x16x32_bf16 v[32:35], v[180:183], v[232:235], v[32:35]
  v_mfma_f32_16x16x32_bf16 v[36:39], v[180:183], v[236:239], v[36:39]
  v_mfma_f32_16x16x32_bf16 v[40:43], v[184:187], v[220:223], v[40:43]
  v_mfma_f32_16x16x32_bf16 v[44:47], v[184:187], v[224:227], v[44:47]
  v_mfma_f32_16x16x32_bf16 v[48:51], v[184:187], v[228:231], v[48:51]
  v_mfma_f32_16x16x32_bf16 v[52:55], v[184:187], v[232:235], v[52:55]
  v_mfma_f32_16x16x32_bf16 v[56:59], v[184:187], v[236:239], v[56:59]
  v_mfma_f32_16x16x32_bf16 v[60:63], v[188:191], v[220:223], v[60:63]
  v_mfma_f32_16x16x32_bf16 v[64:67], v[188:191], v[224:227], v[64:67]
  v_mfma_f32_16x16x32_bf16 v[68:71], v[188:191], v[228:231], v[68:71]
  v_mfma_f32_16x16x32_bf16 v[72:75], v[188:191], v[232:235], v[72:75]
  v_mfma_f32_16x16x32_bf16 v[76:79], v[188:191], v[236:239], v[76:79]
  v_mfma_f32_16x16x32_bf16 v[80:83], v[192:195], v[220:223], v[80:83]
  v_mfma_f32_16x16x32_bf16 v[84:87], v[192:195], v[224:227], v[84:87]
  v_mfma_f32_16x16x32_bf16 v[88:91], v[192:195], v[228:231], v[88:91]
  v_mfma_f32_16x16x32_bf16 v[92:95], v[192:195], v[232:235], v[92:95]
  v_mfma_f32_16x16x32_bf16 v[96:99], v[192:195], v[236:239], v[96:99]
  v_mfma_f32_16x16x32_bf16 v[100:103], v[196:199], v[220:223], v[100:103]
  v_mfma_f32_16x16x32_bf16 v[104:107], v[196:199], v[224:227], v[104:107]
  v_mfma_f32_16x16x32_bf16 v[108:111], v[196:199], v[228:231], v[108:111]
  v_mfma_f32_16x16x32_bf16 v[112:115], v[196:199], v[232:235], v[112:115]
  v_mfma_f32_16x16x32_bf16 v[116:119], v[196:199], v[236:239], v[116:119]
  v_mfma_f32_16x16x32_bf16 v[120:123], v[160:163], v[220:223], v[120:123]
  v_mfma_f32_16x16x32_bf16 v[124:127], v[160:163], v[224:227], v[124:127]
  v_mfma_f32_16x16x32_bf16 v[128:131], v[160:163], v[228:231], v[128:131]
  v_mfma_f32_16x16x32_bf16 v[132:135], v[160:163], v[232:235], v[132:135]
  v_mfma_f32_16x16x32_bf16 v[136:139], v[160:163], v[236:239], v[136:139]
  v_mfma_f32_16x16x32_bf16 v[140:143], v[164:167], v[220:223], v[140:143]
  v_mfma_f32_16x16x32_bf16 v[144:147], v[164:167], v[224:227], v[144:147]
  v_mfma_f32_16x16x32_bf16 v[148:151], v[164:167], v[228:231], v[148:151]
  v_mfma_f32_16x16x32_bf16 v[152:155], v[164:167], v[232:235], v[152:155]
  v_mfma_f32_16x16x32_bf16 v[156:159], v[164:167], v[236:239], v[156:159]
  s_waitcnt lgkmcnt(0)
  s_waitcnt vmcnt(0)
  s_barrier
  s_mul_i32 s46, s17, 40960
  s_lshl_b32 s47, s18, 12
  s_add_u32 s46, s46, s47
  s_add_u32 s46, s46, 65536
  v_lshlrev_b32 v250, 4, v255
  v_add_u32 v250, s46, v250
  s_nop 3
  v_cvt_pk_bf16_f32 v160, v0, v1
  v_cvt_pk_bf16_f32 v161, v2, v3
  v_cvt_pk_bf16_f32 v162, v20, v21
  v_cvt_pk_bf16_f32 v163, v22, v23
  v_cvt_pk_bf16_f32 v164, v4, v5
  v_cvt_pk_bf16_f32 v165, v6, v7
  v_cvt_pk_bf16_f32 v166, v24, v25
  v_cvt_pk_bf16_f32 v167, v26, v27
  v_cvt_pk_bf16_f32 v168, v8, v9
  v_cvt_pk_bf16_f32 v169, v10, v11
  v_cvt_pk_bf16_f32 v170, v28, v29
  v_cvt_pk_bf16_f32 v171, v30, v31
  v_cvt_pk_bf16_f32 v172, v12, v13
  v_cvt_pk_bf16_f32 v173, v14, v15
  v_cvt_pk_bf16_f32 v174, v32, v33
  v_cvt_pk_bf16_f32 v175, v34, v35
  v_cvt_pk_bf16_f32 v176, v16, v17
  v_cvt_pk_bf16_f32 v177, v18, v19
  v_cvt_pk_bf16_f32 v178, v36, v37
  v_cvt_pk_bf16_f32 v179, v38, v39
  v_cvt_pk_bf16_f32 v180, v40, v41
  v_cvt_pk_bf16_f32 v181, v42, v43
  v_cvt_pk_bf16_f32 v182, v60, v61
  v_cvt_pk_bf16_f32 v183, v62, v63
  v_cvt_pk_bf16_f32 v184, v44, v45
  v_cvt_pk_bf16_f32 v185, v46, v47
  v_cvt_pk_bf16_f32 v186, v64, v65
  v_cvt_pk_bf16_f32 v187, v66, v67
  v_cvt_pk_bf16_f32 v188, v48, v49
  v_cvt_pk_bf16_f32 v189, v50, v51
  v_cvt_pk_bf16_f32 v190, v68, v69
  v_cvt_pk_bf16_f32 v191, v70, v71
  v_cvt_pk_bf16_f32 v192, v52, v53
  v_cvt_pk_bf16_f32 v193, v54, v55
  v_cvt_pk_bf16_f32 v194, v72, v73
  v_cvt_pk_bf16_f32 v195, v74, v75
  v_cvt_pk_bf16_f32 v196, v56, v57
  v_cvt_pk_bf16_f32 v197, v58, v59
  v_cvt_pk_bf16_f32 v198, v76, v77
  v_cvt_pk_bf16_f32 v199, v78, v79
  s_nop 1
  v_permlane32_swap_b32 v160, v162
  v_permlane32_swap_b32 v161, v163
  v_permlane32_swap_b32 v164, v166
  v_permlane32_swap_b32 v165, v167
  v_permlane32_swap_b32 v168, v170
  v_permlane32_swap_b32 v169, v171
  v_permlane32_swap_b32 v172, v174
  v_permlane32_swap_b32 v173, v175
  v_permlane32_swap_b32 v176, v178
  v_permlane32_swap_b32 v177, v179
  v_permlane32_swap_b32 v180, v182
  v_permlane32_swap_b32 v181, v183
  v_permlane32_swap_b32 v184, v186
  v_permlane32_swap_b32 v185, v187
  v_permlane32_swap_b32 v188, v190
  v_permlane32_swap_b32 v189, v191
  v_permlane32_swap_b32 v192, v194
  v_permlane32_swap_b32 v193, v195
  v_permlane32_swap_b32 v196, v198
  v_permlane32_swap_b32 v197, v199
  v_permlane16_swap_b32 v160, v162
  v_permlane16_swap_b32 v161, v163
  v_permlane16_swap_b32 v164, v166
  v_permlane16_swap_b32 v165, v167
  v_permlane16_swap_b32 v168, v170
  v_permlane16_swap_b32 v169, v171
  v_permlane16_swap_b32 v172, v174
  v_permlane16_swap_b32 v173, v175
  v_permlane16_swap_b32 v176, v178
  v_permlane16_swap_b32 v177, v179
  v_permlane16_swap_b32 v180, v182
  v_permlane16_swap_b32 v181, v183
  v_permlane16_swap_b32 v184, v186
  v_permlane16_swap_b32 v185, v187
  v_permlane16_swap_b32 v188, v190
  v_permlane16_swap_b32 v189, v191
  v_permlane16_swap_b32 v192, v194
  v_permlane16_swap_b32 v193, v195
  v_permlane16_swap_b32 v196, v198
  v_permlane16_swap_b32 v197, v199
  s_nop 0
  ds_write_b128 v250, v[160:163] offset:0
  ds_write_b128 v250, v[164:167] offset:8192
  ds_write_b128 v250, v[168:171] offset:16384
  ds_write_b128 v250, v[172:175] offset:24576
  ds_write_b128 v250, v[176:179] offset:32768
  ds_write_b128 v250, v[180:183] offset:1024
  ds_write_b128 v250, v[184:187] offset:9216
  ds_write_b128 v250, v[188:191] offset:17408
  ds_write_b128 v250, v[192:195] offset:25600
  ds_write_b128 v250, v[196:199] offset:33792
  v_cvt_pk_bf16_f32 v200, v80, v81
  v_cvt_pk_bf16_f32 v201, v82, v83
  v_cvt_pk_bf16_f32 v202, v100, v101
  v_cvt_pk_bf16_f32 v203, v102, v103
  v_cvt_pk_bf16_f32 v204, v84, v85
  v_cvt_pk_bf16_f32 v205, v86, v87
  v_cvt_pk_bf16_f32 v206, v104, v105
  v_cvt_pk_bf16_f32 v207, v106, v107
  v_cvt_pk_bf16_f32 v208, v88, v89
  v_cvt_pk_bf16_f32 v209, v90, v91
  v_cvt_pk_bf16_f32 v210, v108, v109
  v_cvt_pk_bf16_f32 v211, v110, v111
  v_cvt_pk_bf16_f32 v212, v92, v93
  v_cvt_pk_bf16_f32 v213, v94, v95
  v_cvt_pk_bf16_f32 v214, v112, v113
  v_cvt_pk_bf16_f32 v215, v114, v115
  v_cvt_pk_bf16_f32 v216, v96, v97
  v_cvt_pk_bf16_f32 v217, v98, v99
  v_cvt_pk_bf16_f32 v218, v116, v117
  v_cvt_pk_bf16_f32 v219, v118, v119
  v_cvt_pk_bf16_f32 v220, v120, v121
  v_cvt_pk_bf16_f32 v221, v122, v123
  v_cvt_pk_bf16_f32 v222, v140, v141
  v_cvt_pk_bf16_f32 v223, v142, v143
  v_cvt_pk_bf16_f32 v224, v124, v125
  v_cvt_pk_bf16_f32 v225, v126, v127
  v_cvt_pk_bf16_f32 v226, v144, v145
  v_cvt_pk_bf16_f32 v227, v146, v147
  v_cvt_pk_bf16_f32 v228, v128, v129
  v_cvt_pk_bf16_f32 v229, v130, v131
  v_cvt_pk_bf16_f32 v230, v148, v149
  v_cvt_pk_bf16_f32 v231, v150, v151
  v_cvt_pk_bf16_f32 v232, v132, v133
  v_cvt_pk_bf16_f32 v233, v134, v135
  v_cvt_pk_bf16_f32 v234, v152, v153
  v_cvt_pk_bf16_f32 v235, v154, v155
  v_cvt_pk_bf16_f32 v236, v136, v137
  v_cvt_pk_bf16_f32 v237, v138, v139
  v_cvt_pk_bf16_f32 v238, v156, v157
  v_cvt_pk_bf16_f32 v239, v158, v159
  s_nop 1
  v_permlane32_swap_b32 v200, v202
  v_permlane32_swap_b32 v201, v203
  v_permlane32_swap_b32 v204, v206
  v_permlane32_swap_b32 v205, v207
  v_permlane32_swap_b32 v208, v210
  v_permlane32_swap_b32 v209, v211
  v_permlane32_swap_b32 v212, v214
  v_permlane32_swap_b32 v213, v215
  v_permlane32_swap_b32 v216, v218
  v_permlane32_swap_b32 v217, v219
  v_permlane32_swap_b32 v220, v222
  v_permlane32_swap_b32 v221, v223
  v_permlane32_swap_b32 v224, v226
  v_permlane32_swap_b32 v225, v227
  v_permlane32_swap_b32 v228, v230
  v_permlane32_swap_b32 v229, v231
  v_permlane32_swap_b32 v232, v234
  v_permlane32_swap_b32 v233, v235
  v_permlane32_swap_b32 v236, v238
  v_permlane32_swap_b32 v237, v239
  v_permlane16_swap_b32 v200, v202
  v_permlane16_swap_b32 v201, v203
  v_permlane16_swap_b32 v204, v206
  v_permlane16_swap_b32 v205, v207
  v_permlane16_swap_b32 v208, v210
  v_permlane16_swap_b32 v209, v211
  v_permlane16_swap_b32 v212, v214
  v_permlane16_swap_b32 v213, v215
  v_permlane16_swap_b32 v216, v218
  v_permlane16_swap_b32 v217, v219
  v_permlane16_swap_b32 v220, v222
  v_permlane16_swap_b32 v221, v223
  v_permlane16_swap_b32 v224, v226
  v_permlane16_swap_b32 v225, v227
  v_permlane16_swap_b32 v228, v230
  v_permlane16_swap_b32 v229, v231
  v_permlane16_swap_b32 v232, v234
  v_permlane16_swap_b32 v233, v235
  v_permlane16_swap_b32 v236, v238
  v_permlane16_swap_b32 v237, v239
  s_nop 0
  ds_write_b128 v250, v[200:203] offset:2048
  ds_write_b128 v250, v[204:207] offset:10240
  ds_write_b128 v250, v[208:211] offset:18432
  ds_write_b128 v250, v[212:215] offset:26624
  ds_write_b128 v250, v[216:219] offset:34816
  ds_write_b128 v250, v[220:223] offset:3072
  ds_write_b128 v250, v[224:227] offset:11264
  ds_write_b128 v250, v[228:231] offset:19456
  ds_write_b128 v250, v[232:235] offset:27648
  ds_write_b128 v250, v[236:239] offset:35840
  s_waitcnt lgkmcnt(0)
  s_barrier
  s_cmp_eq_u32 s19, 1
  s_cselect_b64 s[8:9], s[38:39], s[36:37]
  s_mov_b32 s10, 3670016
  s_mov_b32 s11, 0x20000
  v_and_b32 v248, 15, v255
  v_lshrrev_b32 v249, 4, v255
  v_add_u32 v250, 0, v249
  v_lshlrev_b32 v250, 1, v250
  v_xor_b32 v250, v250, v248
  v_lshlrev_b32 v250, 4, v250
  v_lshl_add_u32 v250, v249, 9, v250
  s_lshl_b32 s73, s18, 8
  v_add_u32 v244, s73, v250
  v_add_u32 v250, 4, v249
  v_lshlrev_b32 v250, 1, v250
  v_xor_b32 v250, v250, v248
  v_lshlrev_b32 v250, 4, v250
  v_lshl_add_u32 v250, v249, 9, v250
  s_lshl_b32 s73, s18, 8
  v_add_u32 v245, s73, v250
  v_lshrrev_b32 v250, 2, v248
  v_lshl_add_u32 v250, v249, 2, v250
  v_and_b32 v251, 3, v248
  v_lshlrev_b32 v251, 3, v251
  v_lshl_add_u32 v251, v250, 8, v251
  v_add_u32 v251, s76, v251
  v_and_b32 v250, 7, v250
  v_xor_b32 v236, 0, v250
  v_lshl_add_u32 v236, v236, 5, v251
  v_xor_b32 v237, 1, v250
  v_lshl_add_u32 v237, v237, 5, v251
  v_xor_b32 v238, 2, v250
  v_lshl_add_u32 v238, v238, 5, v251
  v_xor_b32 v239, 3, v250
  v_lshl_add_u32 v239, v239, 5, v251
  v_xor_b32 v240, 4, v250
  v_lshl_add_u32 v240, v240, 5, v251
  v_xor_b32 v241, 5, v250
  v_lshl_add_u32 v241, v241, 5, v251
  v_xor_b32 v242, 6, v250
  v_lshl_add_u32 v242, v242, 5, v251
  v_xor_b32 v243, 7, v250
  v_lshl_add_u32 v243, v243, 5, v251
  s_mul_i32 s73, s17, 5120
  s_add_u32 s73, s73, 131072
  v_lshlrev_b32 v250, 4, v255
  v_add_u32 v246, s73, v250
  v_mov_b32 v232, 0x3f803f80
  v_mov_b32 v233, 0x3f803f80
  v_mov_b32 v234, 0x3f803f80
  v_mov_b32 v235, 0x3f803f80
  s_barrier
  s_cmp_eq_u32 s19, 0
  s_cbranch_scc1 L_attn_kernel_pvA
  s_and_b32 s21, s20, 31
  s_lshl_b32 s21, s21, 14
  s_add_u32 m0, s22, 0
  s_add_u32 s20, s20, 1
  buffer_load_dwordx4 v244, s[4:7], s21 offen nt lds
  s_add_u32 s21, s21, 1024
  buffer_load_dwordx4 v245, s[4:7], s21 offen offset:1024 nt lds
  s_add_u32 s21, s21, 1024
  buffer_load_dwordx4 v244, s[4:7], s21 offen offset:2048 nt lds
  s_add_u32 s21, s21, 1024
  buffer_load_dwordx4 v245, s[4:7], s21 offen offset:3072 nt lds
  s_add_u32 m0, s22, 4096
  s_add_u32 s21, s21, 5120
  buffer_load_dwordx4 v244, s[4:7], s21 offen nt lds
  s_add_u32 s21, s21, 1024
  buffer_load_dwordx4 v245, s[4:7], s21 offen offset:1024 nt lds
  s_add_u32 s21, s21, 1024
  buffer_load_dwordx4 v244, s[4:7], s21 offen offset:2048 nt lds
  s_add_u32 s21, s21, 1024
  buffer_load_dwordx4 v245, s[4:7], s21 offen offset:3072 nt lds
  s_and_b32 s21, s20, 31
  s_lshl_b32 s21, s21, 14
  s_add_u32 m0, s22, 8192
  s_add_u32 s20, s20, 1
  buffer_load_dwordx4 v244, s[4:7], s21 offen nt lds
  s_add_u32 s21, s21, 1024
  buffer_load_dwordx4 v245, s[4:7], s21 offen offset:1024 nt lds
  s_add_u32 s21, s21, 1024
  buffer_load_dwordx4 v244, s[4:7], s21 offen offset:2048 nt lds
  s_add_u32 s21, s21, 1024
  buffer_load_dwordx4 v245, s[4:7], s21 offen offset:3072 nt lds
  s_add_u32 m0, s22, 12288
  s_add_u32 s21, s21, 5120
  buffer_load_dwordx4 v244, s[4:7], s21 offen nt lds
  s_add_u32 s21, s21, 1024
  buffer_load_dwordx4 v245, s[4:7], s21 offen offset:1024 nt lds
  s_add_u32 s21, s21, 1024
  buffer_load_dwordx4 v244, s[4:7], s21 offen offset:2048 nt lds
  s_add_u32 s21, s21, 1024
  buffer_load_dwordx4 v245, s[4:7], s21 offen offset:3072 nt lds
  s_waitcnt vmcnt(8)
  s_barrier
  v_mov_b32 v252, 151552
  ds_read_b128 v[248:251], v252 offset:0
  ds_read_b64_tr_b16 v[180:181], v236
  ds_read_b64_tr_b16 v[182:183], v236 offset:4096
  ds_read_b64_tr_b16 v[184:185], v237
  ds_read_b64_tr_b16 v[186:187], v237 offset:4096
  ds_read_b128 v[212:215], v246 offset:0
  ds_read_b128 v[216:219], v246 offset:1024
  ds_read_b128 v[220:223], v246 offset:2048
  ds_read_b128 v[224:227], v246 offset:3072
  ds_read_b128 v[228:231], v246 offset:4096
  s_waitcnt lgkmcnt(9)
  v_or3_b32 v248, v248, v249, v250
  v_or_b32 v248, v248, v251
  v_cmp_ne_u32 vcc, 0, v248
  s_mov_b32 s25, 0
  s_mov_b32 s24, 0
  s_cbranch_vccnz L_slow_pv_B
L_back_16:
  ds_read_b64_tr_b16 v[188:189], v238
  ds_read_b64_tr_b16 v[190:191], v238 offset:4096
  ds_read_b64_tr_b16 v[192:193], v239
  ds_read_b64_tr_b16 v[194:195], v239 offset:4096
  s_waitcnt lgkmcnt(4)
  ds_read_b64_tr_b16 v[196:197], v240
  ds_read_b64_tr_b16 v[198:199], v240 offset:4096
  v_mfma_f32_16x16x32_bf16 v[0:3], v[180:183], v[212:215], 0
  v_mfma_f32_16x16x32_bf16 v[4:7], v[180:183], v[216:219], 0
  v_mfma_f32_16x16x32_bf16 v[8:11], v[180:183], v[220:223], 0
  v_mfma_f32_16x16x32_bf16 v[12:15], v[180:183], v[224:227], 0
  v_mfma_f32_16x16x32_bf16 v[16:19], v[180:183], v[228:231], 0
  s_waitcnt lgkmcnt(6)
  ds_read_b64_tr_b16 v[200:201], v241
  ds_read_b64_tr_b16 v[202:203], v241 offset:4096
  v_mfma_f32_16x16x32_bf16 v[20:23], v[184:187], v[212:215], 0
  v_mfma_f32_16x16x32_bf16 v[24:27], v[184:187], v[216:219], 0
  v_mfma_f32_16x16x32_bf16 v[28:31], v[184:187], v[220:223], 0
  v_mfma_f32_16x16x32_bf16 v[32:35], v[184:187], v[224:227], 0
  v_mfma_f32_16x16x32_bf16 v[36:39], v[184:187], v[228:231], 0
  s_waitcnt lgkmcnt(6)
  ds_read_b64_tr_b16 v[204:205], v242
  ds_read_b64_tr_b16 v[206:207], v242 offset:4096
  v_mfma_f32_16x16x32_bf16 v[40:43], v[188:191], v[212:215], 0
  v_mfma_f32_16x16x32_bf16 v[44:47], v[188:191], v[216:219], 0
  v_mfma_f32_16x16x32_bf16 v[48:51], v[188:191], v[220:223], 0
  v_mfma_f32_16x16x32_bf16 v[52:55], v[188:191], v[224:227], 0
  v_mfma_f32_16x16x32_bf16 v[56:59], v[188:191], v[228:231], 0
  s_waitcnt lgkmcnt(6)
  ds_read_b64_tr_b16 v[208:209], v243
  ds_read_b64_tr_b16 v[210:211], v243 offset:4096
  v_mfma_f32_16x16x32_bf16 v[60:63], v[192:195], v[212:215], 0
  v_mfma_f32_16x16x32_bf16 v[64:67], v[192:195], v[216:219], 0
  v_mfma_f32_16x16x32_bf16 v[68:71], v[192:195], v[220:223], 0
  v_mfma_f32_16x16x32_bf16 v[72:75], v[192:195], v[224:227], 0
  v_mfma_f32_16x16x32_bf16 v[76:79], v[192:195], v[228:231], 0
  s_waitcnt lgkmcnt(0)
  v_mfma_f32_16x16x32_bf16 v[80:83], v[196:199], v[212:215], 0
  v_mfma_f32_16x16x32_bf16 v[84:87], v[196:199], v[216:219], 0
  s_and_b32 s21, s20, 31
  s_lshl_b32 s21, s21, 14
  s_add_u32 m0, s22, 0
  s_add_u32 s20, s20, 1
  buffer_load_dwordx4 v244, s[4:7], s21 offen nt lds
  v_mfma_f32_16x16x32_bf16 v[88:91], v[196:199], v[220:223], 0
  v_mfma_f32_16x16x32_bf16 v[92:95], v[196:199], v[224:227], 0
  v_mfma_f32_16x16x32_bf16 v[96:99], v[196:199], v[228:231], 0
  s_add_u32 s21, s21, 1024
  buffer_load_dwordx4 v245, s[4:7], s21 offen offset:1024 nt lds
  v_mfma_f32_16x16x32_bf16 v[100:103], v[200:203], v[212:215], 0
  v_mfma_f32_16x16x32_bf16 v[104:107], v[200:203], v[216:219], 0
  s_add_u32 s21, s21, 1024
  buffer_load_dwordx4 v244, s[4:7], s21 offen offset:2048 nt lds
  v_mfma_f32_16x16x32_bf16 v[108:111], v[200:203], v[220:223], 0
  v_mfma_f32_16x16x32_bf16 v[112:115], v[200:203], v[224:227], 0
  v_mfma_f32_16x16x32_bf16 v[116:119], v[200:203], v[228:231], 0
  s_add_u32 s21, s21, 1024
  buffer_load_dwordx4 v245, s[4:7], s21 offen offset:3072 nt lds
  v_mfma_f32_16x16x32_bf16 v[120:123], v[204:207], v[212:215], 0
  v_mfma_f32_16x16x32_bf16 v[124:127], v[204:207], v[216:219], 0
  s_add_u32 m0, s22, 4096
  s_add_u32 s21, s21, 5120
  buffer_load_dwordx4 v244, s[4:7], s21 offen nt lds
  v_mfma_f32_16x16x32_bf16 v[128:131], v[204:207], v[220:223], 0
  v_mfma_f32_16x16x32_bf16 v[132:135], v[204:207], v[224:227], 0
  v_mfma_f32_16x16x32_bf16 v[136:139], v[204:207], v[228:231], 0
  s_add_u32 s21, s21, 1024
  buffer_load_dwordx4 v245, s[4:7], s21 offen offset:1024 nt lds
  v_mfma_f32_16x16x32_bf16 v[140:143], v[208:211], v[212:215], 0
  v_mfma_f32_16x16x32_bf16 v[144:147], v[208:211], v[216:219], 0
  s_add_u32 s21, s21, 1024
  buffer_load_dwordx4 v244, s[4:7], s21 offen offset:2048 nt lds
  v_mfma_f32_16x16x32_bf16 v[148:151], v[208:211], v[220:223], 0
  v_mfma_f32_16x16x32_bf16 v[152:155], v[208:211], v[224:227], 0
  v_mfma_f32_16x16x32_bf16 v[156:159], v[208:211], v[228:231], 0
  s_add_u32 s21, s21, 1024
  buffer_load_dwordx4 v245, s[4:7], s21 offen offset:3072 nt lds
  v_mfma_f32_16x16x32_bf16 v[160:163], v[232:235], v[212:215], 0
  v_mfma_f32_16x16x32_bf16 v[164:167], v[232:235], v[216:219], 0
  v_mfma_f32_16x16x32_bf16 v[168:171], v[232:235], v[220:223], 0
  v_mfma_f32_16x16x32_bf16 v[172:175], v[232:235], v[224:227], 0
  v_mfma_f32_16x16x32_bf16 v[176:179], v[232:235], v[228:231], 0
  s_waitcnt vmcnt(8)
  s_barrier
  s_mov_b32 s23, 14
L_pv_B_17:
  v_mov_b32 v252, 151552
  ds_read_b128 v[248:251], v252 offset:16
  ds_read_b64_tr_b16 v[180:181], v236 offset:8192
  ds_read_b64_tr_b16 v[182:183], v236 offset:12288
  ds_read_b64_tr_b16 v[184:185], v237 offset:8192
  ds_read_b64_tr_b16 v[186:187], v237 offset:12288
  ds_read_b128 v[212:215], v246 offset:10240
  ds_read_b128 v[216:219], v246 offset:11264
  ds_read_b128 v[220:223], v246 offset:12288
  ds_read_b128 v[224:227], v246 offset:13312
  ds_read_b128 v[228:231], v246 offset:14336
  s_waitcnt lgkmcnt(9)
  v_or3_b32 v248, v248, v249, v250
  v_or_b32 v248, v248, v251
  v_cmp_ne_u32 vcc, 0, v248
  s_mov_b32 s25, 1
  s_mov_b32 s24, 10240
  s_cbranch_vccnz L_slow_pv_B
L_back_18:
  ds_read_b64_tr_b16 v[188:189], v238 offset:8192
  ds_read_b64_tr_b16 v[190:191], v238 offset:12288
  ds_read_b64_tr_b16 v[192:193], v239 offset:8192
  ds_read_b64_tr_b16 v[194:195], v239 offset:12288
  s_waitcnt lgkmcnt(4)
  ds_read_b64_tr_b16 v[196:197], v240 offset:8192
  ds_read_b64_tr_b16 v[198:199], v240 offset:12288
  v_mfma_f32_16x16x32_bf16 v[0:3], v[180:183], v[212:215], v[0:3]
  v_mfma_f32_16x16x32_bf16 v[4:7], v[180:183], v[216:219], v[4:7]
  v_mfma_f32_16x16x32_bf16 v[8:11], v[180:183], v[220:223], v[8:11]
  v_mfma_f32_16x16x32_bf16 v[12:15], v[180:183], v[224:227], v[12:15]
  v_mfma_f32_16x16x32_bf16 v[16:19], v[180:183], v[228:231], v[16:19]
  s_waitcnt lgkmcnt(6)
  ds_read_b64_tr_b16 v[200:201], v241 offset:8192
  ds_read_b64_tr_b16 v[202:203], v241 offset:12288
  v_mfma_f32_16x16x32_bf16 v[20:23], v[184:187], v[212:215], v[20:23]
  v_mfma_f32_16x16x32_bf16 v[24:27], v[184:187], v[216:219], v[24:27]
  v_mfma_f32_16x16x32_bf16 v[28:31], v[184:187], v[220:223], v[28:31]
  v_mfma_f32_16x16x32_bf16 v[32:35], v[184:187], v[224:227], v[32:35]
  v_mfma_f32_16x16x32_bf16 v[36:39], v[184:187], v[228:231], v[36:39]
  s_waitcnt lgkmcnt(6)
  ds_read_b64_tr_b16 v[204:205], v242 offset:8192
  ds_read_b64_tr_b16 v[206:207], v242 offset:12288
  v_mfma_f32_16x16x32_bf16 v[40:43], v[188:191], v[212:215], v[40:43]
  v_mfma_f32_16x16x32_bf16 v[44:47], v[188:191], v[216:219], v[44:47]
  v_mfma_f32_16x16x32_bf16 v[48:51], v[188:191], v[220:223], v[48:51]
  v_mfma_f32_16x16x32_bf16 v[52:55], v[188:191], v[224:227], v[52:55]
  v_mfma_f32_16x16x32_bf16 v[56:59], v[188:191], v[228:231], v[56:59]
  s_waitcnt lgkmcnt(6)
  ds_read_b64_tr_b16 v[208:209], v243 offset:8192
  ds_read_b64_tr_b16 v[210:211], v243 offset:12288
  v_mfma_f32_16x16x32_bf16 v[60:63], v[192:195], v[212:215], v[60:63]
  v_mfma_f32_16x16x32_bf16 v[64:67], v[192:195], v[216:219], v[64:67]
  v_mfma_f32_16x16x32_bf16 v[68:71], v[192:195], v[220:223], v[68:71]
  v_mfma_f32_16x16x32_bf16 v[72:75], v[192:195], v[224:227], v[72:75]
  v_mfma_f32_16x16x32_bf16 v[76:79], v[192:195], v[228:231], v[76:79]
  s_waitcnt lgkmcnt(0)
  v_mfma_f32_16x16x32_bf16 v[80:83], v[196:199], v[212:215], v[80:83]
  v_mfma_f32_16x16x32_bf16 v[84:87], v[196:199], v[216:219], v[84:87]
  s_and_b32 s21, s20, 31
  s_lshl_b32 s21, s21, 14
  s_add_u32 m0, s22, 8192
  s_add_u32 s20, s20, 1
  buffer_load_dwordx4 v244, s[4:7], s21 offen nt lds
  v_mfma_f32_16x16x32_bf16 v[88:91], v[196:199], v[220:223], v[88:91]
  v_mfma_f32_16x16x32_bf16 v[92:95], v[196:199], v[224:227], v[92:95]
  v_mfma_f32_16x16x32_bf16 v[96:99], v[196:199], v[228:231], v[96:99]
  s_add_u32 s21, s21, 1024
  buffer_load_dwordx4 v245, s[4:7], s21 offen offset:1024 nt lds
  v_mfma_f32_16x16x32_bf16 v[100:103], v[200:203], v[212:215], v[100:103]
  v_mfma_f32_16x16x32_bf16 v[104:107], v[200:203], v[216:219], v[104:107]
  s_add_u32 s21, s21, 1024
  buffer_load_dwordx4 v244, s[4:7], s21 offen offset:2048 nt lds
  v_mfma_f32_16x16x32_bf16 v[108:111], v[200:203], v[220:223], v[108:111]
  v_mfma_f32_16x16x32_bf16 v[112:115], v[200:203], v[224:227], v[112:115]
  v_mfma_f32_16x16x32_bf16 v[116:119], v[200:203], v[228:231], v[116:119]
  s_add_u32 s21, s21, 1024
  buffer_load_dwordx4 v245, s[4:7], s21 offen offset:3072 nt lds
  v_mfma_f32_16x16x32_bf16 v[120:123], v[204:207], v[212:215], v[120:123]
  v_mfma_f32_16x16x32_bf16 v[124:127], v[204:207], v[216:219], v[124:127]
  s_add_u32 m0, s22, 12288
  s_add_u32 s21, s21, 5120
  buffer_load_dwordx4 v244, s[4:7], s21 offen nt lds
  v_mfma_f32_16x16x32_bf16 v[128:131], v[204:207], v[220:223], v[128:131]
  v_mfma_f32_16x16x32_bf16 v[132:135], v[204:207], v[224:227], v[132:135]
  v_mfma_f32_16x16x32_bf16 v[136:139], v[204:207], v[228:231], v[136:139]
  s_add_u32 s21, s21, 1024
  buffer_load_dwordx4 v245, s[4:7], s21 offen offset:1024 nt lds
  v_mfma_f32_16x16x32_bf16 v[140:143], v[208:211], v[212:215], v[140:143]
  v_mfma_f32_16x16x32_bf16 v[144:147], v[208:211], v[216:219], v[144:147]
  s_add_u32 s21, s21, 1024
  buffer_load_dwordx4 v244, s[4:7], s21 offen offset:2048 nt lds
  v_mfma_f32_16x16x32_bf16 v[148:151], v[208:211], v[220:223], v[148:151]
  v_mfma_f32_16x16x32_bf16 v[152:155], v[208:211], v[224:227], v[152:155]
  v_mfma_f32_16x16x32_bf16 v[156:159], v[208:211], v[228:231], v[156:159]
  s_add_u32 s21, s21, 1024
  buffer_load_dwordx4 v245, s[4:7], s21 offen offset:3072 nt lds
  v_mfma_f32_16x16x32_bf16 v[160:163], v[232:235], v[212:215], v[160:163]
  v_mfma_f32_16x16x32_bf16 v[164:167], v[232:235], v[216:219], v[164:167]
  v_mfma_f32_16x16x32_bf16 v[168:171], v[232:235], v[220:223], v[168:171]
  v_mfma_f32_16x16x32_bf16 v[172:175], v[232:235], v[224:227], v[172:175]
  v_mfma_f32_16x16x32_bf16 v[176:179], v[232:235], v[228:231], v[176:179]
  s_waitcnt vmcnt(8)
  s_barrier
  v_mov_b32 v252, 151552
  ds_read_b128 v[248:251], v252 offset:0
  ds_read_b64_tr_b16 v[180:181], v236
  ds_read_b64_tr_b16 v[182:183], v236 offset:4096
  ds_read_b64_tr_b16 v[184:185], v237
  ds_read_b64_tr_b16 v[186:187], v237 offset:4096
  ds_read_b128 v[212:215], v246 offset:0
  ds_read_b128 v[216:219], v246 offset:1024
  ds_read_b128 v[220:223], v246 offset:2048
  ds_read_b128 v[224:227], v246 offset:3072
  ds_read_b128 v[228:231], v246 offset:4096
  s_waitcnt lgkmcnt(9)
  v_or3_b32 v248, v248, v249, v250
  v_or_b32 v248, v248, v251
  v_cmp_ne_u32 vcc, 0, v248
  s_mov_b32 s25, 2
  s_mov_b32 s24, 0
  s_cbranch_vccnz L_slow_pv_B
L_back_19:
  ds_read_b64_tr_b16 v[188:189], v238
  ds_read_b64_tr_b16 v[190:191], v238 offset:4096
  ds_read_b64_tr_b16 v[192:193], v239
  ds_read_b64_tr_b16 v[194:195], v239 offset:4096
  s_waitcnt lgkmcnt(4)
  ds_read_b64_tr_b16 v[196:197], v240
  ds_read_b64_tr_b16 v[198:199], v240 offset:4096
  v_mfma_f32_16x16x32_bf16 v[0:3], v[180:183], v[212:215], v[0:3]
  v_mfma_f32_16x16x32_bf16 v[4:7], v[180:183], v[216:219], v[4:7]
  v_mfma_f32_16x16x32_bf16 v[8:11], v[180:183], v[220:223], v[8:11]
  v_mfma_f32_16x16x32_bf16 v[12:15], v[180:183], v[224:227], v[12:15]
  v_mfma_f32_16x16x32_bf16 v[16:19], v[180:183], v[228:231], v[16:19]
  s_waitcnt lgkmcnt(6)
  ds_read_b64_tr_b16 v[200:201], v241
  ds_read_b64_tr_b16 v[202:203], v241 offset:4096
  v_mfma_f32_16x16x32_bf16 v[20:23], v[184:187], v[212:215], v[20:23]
  v_mfma_f32_16x16x32_bf16 v[24:27], v[184:187], v[216:219], v[24:27]
  v_mfma_f32_16x16x32_bf16 v[28:31], v[184:187], v[220:223], v[28:31]
  v_mfma_f32_16x16x32_bf16 v[32:35], v[184:187], v[224:227], v[32:35]
  v_mfma_f32_16x16x32_bf16 v[36:39], v[184:187], v[228:231], v[36:39]
  s_waitcnt lgkmcnt(6)
  ds_read_b64_tr_b16 v[204:205], v242
  ds_read_b64_tr_b16 v[206:207], v242 offset:4096
  v_mfma_f32_16x16x32_bf16 v[40:43], v[188:191], v[212:215], v[40:43]
  v_mfma_f32_16x16x32_bf16 v[44:47], v[188:191], v[216:219], v[44:47]
  v_mfma_f32_16x16x32_bf16 v[48:51], v[188:191], v[220:223], v[48:51]
  v_mfma_f32_16x16x32_bf16 v[52:55], v[188:191], v[224:227], v[52:55]
  v_mfma_f32_16x16x32_bf16 v[56:59], v[188:191], v[228:231], v[56:59]
  s_waitcnt lgkmcnt(6)
  ds_read_b64_tr_b16 v[208:209], v243
  ds_read_b64_tr_b16 v[210:211], v243 offset:4096
  v_mfma_f32_16x16x32_bf16 v[60:63], v[192:195], v[212:215], v[60:63]
  v_mfma_f32_16x16x32_bf16 v[64:67], v[192:195], v[216:219], v[64:67]
  v_mfma_f32_16x16x32_bf16 v[68:71], v[192:195], v[220:223], v[68:71]
  v_mfma_f32_16x16x32_bf16 v[72:75], v[192:195], v[224:227], v[72:75]
  v_mfma_f32_16x16x32_bf16 v[76:79], v[192:195], v[228:231], v[76:79]
  s_waitcnt lgkmcnt(0)
  v_mfma_f32_16x16x32_bf16 v[80:83], v[196:199], v[212:215], v[80:83]
  v_mfma_f32_16x16x32_bf16 v[84:87], v[196:199], v[216:219], v[84:87]
  s_and_b32 s21, s20, 31
  s_lshl_b32 s21, s21, 14
  s_add_u32 m0, s22, 0
  s_add_u32 s20, s20, 1
  buffer_load_dwordx4 v244, s[4:7], s21 offen nt lds
  v_mfma_f32_16x16x32_bf16 v[88:91], v[196:199], v[220:223], v[88:91]
  v_mfma_f32_16x16x32_bf16 v[92:95], v[196:199], v[224:227], v[92:95]
  v_mfma_f32_16x16x32_bf16 v[96:99], v[196:199], v[228:231], v[96:99]
  s_add_u32 s21, s21, 1024
  buffer_load_dwordx4 v245, s[4:7], s21 offen offset:1024 nt lds
  v_mfma_f32_16x16x32_bf16 v[100:103], v[200:203], v[212:215], v[100:103]
  v_mfma_f32_16x16x32_bf16 v[104:107], v[200:203], v[216:219], v[104:107]
  s_add_u32 s21, s21, 1024
  buffer_load_dwordx4 v244, s[4:7], s21 offen offset:2048 nt lds
  v_mfma_f32_16x16x32_bf16 v[108:111], v[200:203], v[220:223], v[108:111]
  v_mfma_f32_16x16x32_bf16 v[112:115], v[200:203], v[224:227], v[112:115]
  v_mfma_f32_16x16x32_bf16 v[116:119], v[200:203], v[228:231], v[116:119]
  s_add_u32 s21, s21, 1024
  buffer_load_dwordx4 v245, s[4:7], s21 offen offset:3072 nt lds
  v_mfma_f32_16x16x32_bf16 v[120:123], v[204:207], v[212:215], v[120:123]
  v_mfma_f32_16x16x32_bf16 v[124:127], v[204:207], v[216:219], v[124:127]
  s_add_u32 m0, s22, 4096
  s_add_u32 s21, s21, 5120
  buffer_load_dwordx4 v244, s[4:7], s21 offen nt lds
  v_mfma_f32_16x16x32_bf16 v[128:131], v[204:207], v[220:223], v[128:131]
  v_mfma_f32_16x16x32_bf16 v[132:135], v[204:207], v[224:227], v[132:135]
  v_mfma_f32_16x16x32_bf16 v[136:139], v[204:207], v[228:231], v[136:139]
  s_add_u32 s21, s21, 1024
  buffer_load_dwordx4 v245, s[4:7], s21 offen offset:1024 nt lds
  v_mfma_f32_16x16x32_bf16 v[140:143], v[208:211], v[212:215], v[140:143]
  v_mfma_f32_16x16x32_bf16 v[144:147], v[208:211], v[216:219], v[144:147]
  s_add_u32 s21, s21, 1024
  buffer_load_dwordx4 v244, s[4:7], s21 offen offset:2048 nt lds
  v_mfma_f32_16x16x32_bf16 v[148:151], v[208:211], v[220:223], v[148:151]
  v_mfma_f32_16x16x32_bf16 v[152:155], v[208:211], v[224:227], v[152:155]
  v_mfma_f32_16x16x32_bf16 v[156:159], v[208:211], v[228:231], v[156:159]
  s_add_u32 s21, s21, 1024
  buffer_load_dwordx4 v245, s[4:7], s21 offen offset:3072 nt lds
  v_mfma_f32_16x16x32_bf16 v[160:163], v[232:235], v[212:215], v[160:163]
  v_mfma_f32_16x16x32_bf16 v[164:167], v[232:235], v[216:219], v[164:167]
  v_mfma_f32_16x16x32_bf16 v[168:171], v[232:235], v[220:223], v[168:171]
  v_mfma_f32_16x16x32_bf16 v[172:175], v[232:235], v[224:227], v[172:175]
  v_mfma_f32_16x16x32_bf16 v[176:179], v[232:235], v[228:231], v[176:179]
  s_waitcnt vmcnt(8)
  s_barrier
  s_sub_u32 s23, s23, 1
  s_cmp_lg_u32 s23, 0
  s_cbranch_scc1 L_pv_B_17
  v_mov_b32 v252, 151552
  ds_read_b128 v[248:251], v252 offset:16
  ds_read_b64_tr_b16 v[180:181], v236 offset:8192
  ds_read_b64_tr_b16 v[182:183], v236 offset:12288
  ds_read_b64_tr_b16 v[184:185], v237 offset:8192
  ds_read_b64_tr_b16 v[186:187], v237 offset:12288
  ds_read_b128 v[212:215], v246 offset:10240
  ds_read_b128 v[216:219], v246 offset:11264
  ds_read_b128 v[220:223], v246 offset:12288
  ds_read_b128 v[224:227], v246 offset:13312
  ds_read_b128 v[228:231], v246 offset:14336
  s_waitcnt lgkmcnt(9)
  v_or3_b32 v248, v248, v249, v250
  v_or_b32 v248, v248, v251
  v_cmp_ne_u32 vcc, 0, v248
  s_mov_b32 s25, 3
  s_mov_b32 s24, 10240
  s_cbranch_vccnz L_slow_pv_B
L_back_20:
  ds_read_b64_tr_b16 v[188:189], v238 offset:8192
  ds_read_b64_tr_b16 v[190:191], v238 offset:12288
  ds_read_b64_tr_b16 v[192:193], v239 offset:8192
  ds_read_b64_tr_b16 v[194:195], v239 offset:12288
  s_waitcnt lgkmcnt(4)
  ds_read_b64_tr_b16 v[196:197], v240 offset:8192
  ds_read_b64_tr_b16 v[198:199], v240 offset:12288
  v_mfma_f32_16x16x32_bf16 v[0:3], v[180:183], v[212:215], v[0:3]
  v_mfma_f32_16x16x32_bf16 v[4:7], v[180:183], v[216:219], v[4:7]
  v_mfma_f32_16x16x32_bf16 v[8:11], v[180:183], v[220:223], v[8:11]
  v_mfma_f32_16x16x32_bf16 v[12:15], v[180:183], v[224:227], v[12:15]
  v_mfma_f32_16x16x32_bf16 v[16:19], v[180:183], v[228:231], v[16:19]
  s_waitcnt lgkmcnt(6)
  ds_read_b64_tr_b16 v[200:201], v241 offset:8192
  ds_read_b64_tr_b16 v[202:203], v241 offset:12288
  v_mfma_f32_16x16x32_bf16 v[20:23], v[184:187], v[212:215], v[20:23]
  v_mfma_f32_16x16x32_bf16 v[24:27], v[184:187], v[216:219], v[24:27]
  v_mfma_f32_16x16x32_bf16 v[28:31], v[184:187], v[220:223], v[28:31]
  v_mfma_f32_16x16x32_bf16 v[32:35], v[184:187], v[224:227], v[32:35]
  v_mfma_f32_16x16x32_bf16 v[36:39], v[184:187], v[228:231], v[36:39]
  s_waitcnt lgkmcnt(6)
  ds_read_b64_tr_b16 v[204:205], v242 offset:8192
  ds_read_b64_tr_b16 v[206:207], v242 offset:12288
  v_mfma_f32_16x16x32_bf16 v[40:43], v[188:191], v[212:215], v[40:43]
  v_mfma_f32_16x16x32_bf16 v[44:47], v[188:191], v[216:219], v[44:47]
  v_mfma_f32_16x16x32_bf16 v[48:51], v[188:191], v[220:223], v[48:51]
  v_mfma_f32_16x16x32_bf16 v[52:55], v[188:191], v[224:227], v[52:55]
  v_mfma_f32_16x16x32_bf16 v[56:59], v[188:191], v[228:231], v[56:59]
  s_waitcnt lgkmcnt(6)
  ds_read_b64_tr_b16 v[208:209], v243 offset:8192
  ds_read_b64_tr_b16 v[210:211], v243 offset:12288
  v_mfma_f32_16x16x32_bf16 v[60:63], v[192:195], v[212:215], v[60:63]
  v_mfma_f32_16x16x32_bf16 v[64:67], v[192:195], v[216:219], v[64:67]
  v_mfma_f32_16x16x32_bf16 v[68:71], v[192:195], v[220:223], v[68:71]
  v_mfma_f32_16x16x32_bf16 v[72:75], v[192:195], v[224:227], v[72:75]
  v_mfma_f32_16x16x32_bf16 v[76:79], v[192:195], v[228:231], v[76:79]
  s_waitcnt lgkmcnt(0)
  v_mfma_f32_16x16x32_bf16 v[80:83], v[196:199], v[212:215], v[80:83]
  v_mfma_f32_16x16x32_bf16 v[84:87], v[196:199], v[216:219], v[84:87]
  s_and_b32 s21, s20, 31
  s_lshl_b32 s21, s21, 14
  s_add_u32 m0, s22, 8192
  s_add_u32 s20, s20, 1
  buffer_load_dwordx4 v244, s[4:7], s21 offen nt lds
  v_mfma_f32_16x16x32_bf16 v[88:91], v[196:199], v[220:223], v[88:91]
  v_mfma_f32_16x16x32_bf16 v[92:95], v[196:199], v[224:227], v[92:95]
  v_mfma_f32_16x16x32_bf16 v[96:99], v[196:199], v[228:231], v[96:99]
  s_add_u32 s21, s21, 1024
  buffer_load_dwordx4 v245, s[4:7], s21 offen offset:1024 nt lds
  v_mfma_f32_16x16x32_bf16 v[100:103], v[200:203], v[212:215], v[100:103]
  v_mfma_f32_16x16x32_bf16 v[104:107], v[200:203], v[216:219], v[104:107]
  s_add_u32 s21, s21, 1024
  buffer_load_dwordx4 v244, s[4:7], s21 offen offset:2048 nt lds
  v_mfma_f32_16x16x32_bf16 v[108:111], v[200:203], v[220:223], v[108:111]
  v_mfma_f32_16x16x32_bf16 v[112:115], v[200:203], v[224:227], v[112:115]
  v_mfma_f32_16x16x32_bf16 v[116:119], v[200:203], v[228:231], v[116:119]
  s_add_u32 s21, s21, 1024
  buffer_load_dwordx4 v245, s[4:7], s21 offen offset:3072 nt lds
  v_mfma_f32_16x16x32_bf16 v[120:123], v[204:207], v[212:215], v[120:123]
  v_mfma_f32_16x16x32_bf16 v[124:127], v[204:207], v[216:219], v[124:127]
  s_add_u32 m0, s22, 12288
  s_add_u32 s21, s21, 5120
  buffer_load_dwordx4 v244, s[4:7], s21 offen nt lds
  v_mfma_f32_16x16x32_bf16 v[128:131], v[204:207], v[220:223], v[128:131]
  v_mfma_f32_16x16x32_bf16 v[132:135], v[204:207], v[224:227], v[132:135]
  v_mfma_f32_16x16x32_bf16 v[136:139], v[204:207], v[228:231], v[136:139]
  s_add_u32 s21, s21, 1024
  buffer_load_dwordx4 v245, s[4:7], s21 offen offset:1024 nt lds
  v_mfma_f32_16x16x32_bf16 v[140:143], v[208:211], v[212:215], v[140:143]
  v_mfma_f32_16x16x32_bf16 v[144:147], v[208:211], v[216:219], v[144:147]
  s_add_u32 s21, s21, 1024
  buffer_load_dwordx4 v244, s[4:7], s21 offen offset:2048 nt lds
  v_mfma_f32_16x16x32_bf16 v[148:151], v[208:211], v[220:223], v[148:151]
  v_mfma_f32_16x16x32_bf16 v[152:155], v[208:211], v[224:227], v[152:155]
  v_mfma_f32_16x16x32_bf16 v[156:159], v[208:211], v[228:231], v[156:159]
  s_add_u32 s21, s21, 1024
  buffer_load_dwordx4 v245, s[4:7], s21 offen offset:3072 nt lds
  v_mfma_f32_16x16x32_bf16 v[160:163], v[232:235], v[212:215], v[160:163]
  v_mfma_f32_16x16x32_bf16 v[164:167], v[232:235], v[216:219], v[164:167]
  v_mfma_f32_16x16x32_bf16 v[168:171], v[232:235], v[220:223], v[168:171]
  v_mfma_f32_16x16x32_bf16 v[172:175], v[232:235], v[224:227], v[172:175]
  v_mfma_f32_16x16x32_bf16 v[176:179], v[232:235], v[228:231], v[176:179]
  s_waitcnt vmcnt(8)
  s_barrier
  v_mov_b32 v252, 151552
  ds_read_b128 v[248:251], v252 offset:0
  ds_read_b64_tr_b16 v[180:181], v236
  ds_read_b64_tr_b16 v[182:183], v236 offset:4096
  ds_read_b64_tr_b16 v[184:185], v237
  ds_read_b64_tr_b16 v[186:187], v237 offset:4096
  ds_read_b128 v[212:215], v246 offset:0
  ds_read_b128 v[216:219], v246 offset:1024
  ds_read_b128 v[220:223], v246 offset:2048
  ds_read_b128 v[224:227], v246 offset:3072
  ds_read_b128 v[228:231], v246 offset:4096
  s_waitcnt lgkmcnt(9)
  v_or3_b32 v248, v248, v249, v250
  v_or_b32 v248, v248, v251
  v_cmp_ne_u32 vcc, 0, v248
  s_mov_b32 s25, 4
  s_mov_b32 s24, 0
  s_cbranch_vccnz L_slow_pv_B
L_back_21:
  ds_read_b64_tr_b16 v[188:189], v238
  ds_read_b64_tr_b16 v[190:191], v238 offset:4096
  ds_read_b64_tr_b16 v[192:193], v239
  ds_read_b64_tr_b16 v[194:195], v239 offset:4096
  s_waitcnt lgkmcnt(4)
  ds_read_b64_tr_b16 v[196:197], v240
  ds_read_b64_tr_b16 v[198:199], v240 offset:4096
  v_mfma_f32_16x16x32_bf16 v[0:3], v[180:183], v[212:215], v[0:3]
  v_mfma_f32_16x16x32_bf16 v[4:7], v[180:183], v[216:219], v[4:7]
  v_mfma_f32_16x16x32_bf16 v[8:11], v[180:183], v[220:223], v[8:11]
  v_mfma_f32_16x16x32_bf16 v[12:15], v[180:183], v[224:227], v[12:15]
  v_mfma_f32_16x16x32_bf16 v[16:19], v[180:183], v[228:231], v[16:19]
  s_waitcnt lgkmcnt(6)
  ds_read_b64_tr_b16 v[200:201], v241
  ds_read_b64_tr_b16 v[202:203], v241 offset:4096
  v_mfma_f32_16x16x32_bf16 v[20:23], v[184:187], v[212:215], v[20:23]
  v_mfma_f32_16x16x32_bf16 v[24:27], v[184:187], v[216:219], v[24:27]
  v_mfma_f32_16x16x32_bf16 v[28:31], v[184:187], v[220:223], v[28:31]
  v_mfma_f32_16x16x32_bf16 v[32:35], v[184:187], v[224:227], v[32:35]
  v_mfma_f32_16x16x32_bf16 v[36:39], v[184:187], v[228:231], v[36:39]
  s_waitcnt lgkmcnt(6)
  ds_read_b64_tr_b16 v[204:205], v242
  ds_read_b64_tr_b16 v[206:207], v242 offset:4096
  v_mfma_f32_16x16x32_bf16 v[40:43], v[188:191], v[212:215], v[40:43]
  v_mfma_f32_16x16x32_bf16 v[44:47], v[188:191], v[216:219], v[44:47]
  v_mfma_f32_16x16x32_bf16 v[48:51], v[188:191], v[220:223], v[48:51]
  v_mfma_f32_16x16x32_bf16 v[52:55], v[188:191], v[224:227], v[52:55]
  v_mfma_f32_16x16x32_bf16 v[56:59], v[188:191], v[228:231], v[56:59]
  s_waitcnt lgkmcnt(6)
  ds_read_b64_tr_b16 v[208:209], v243
  ds_read_b64_tr_b16 v[210:211], v243 offset:4096
  v_mfma_f32_16x16x32_bf16 v[60:63], v[192:195], v[212:215], v[60:63]
  v_mfma_f32_16x16x32_bf16 v[64:67], v[192:195], v[216:219], v[64:67]
  v_mfma_f32_16x16x32_bf16 v[68:71], v[192:195], v[220:223], v[68:71]
  v_mfma_f32_16x16x32_bf16 v[72:75], v[192:195], v[224:227], v[72:75]
  v_mfma_f32_16x16x32_bf16 v[76:79], v[192:195], v[228:231], v[76:79]
  s_waitcnt lgkmcnt(6)
  v_mfma_f32_16x16x32_bf16 v[80:83], v[196:199], v[212:215], v[80:83]
  v_mfma_f32_16x16x32_bf16 v[84:87], v[196:199], v[216:219], v[84:87]
  v_mfma_f32_16x16x32_bf16 v[88:91], v[196:199], v[220:223], v[88:91]
  v_mfma_f32_16x16x32_bf16 v[92:95], v[196:199], v[224:227], v[92:95]
  v_mfma_f32_16x16x32_bf16 v[96:99], v[196:199], v[228:231], v[96:99]
  s_waitcnt lgkmcnt(4)
  v_mfma_f32_16x16x32_bf16 v[100:103], v[200:203], v[212:215], v[100:103]
  v_mfma_f32_16x16x32_bf16 v[104:107], v[200:203], v[216:219], v[104:107]
  v_mfma_f32_16x16x32_bf16 v[108:111], v[200:203], v[220:223], v[108:111]
  v_mfma_f32_16x16x32_bf16 v[112:115], v[200:203], v[224:227], v[112:115]
  v_mfma_f32_16x16x32_bf16 v[116:119], v[200:203], v[228:231], v[116:119]
  s_waitcnt lgkmcnt(2)
  v_mfma_f32_16x16x32_bf16 v[120:123], v[204:207], v[212:215], v[120:123]
  v_mfma_f32_16x16x32_bf16 v[124:127], v[204:207], v[216:219], v[124:127]
  v_mfma_f32_16x16x32_bf16 v[128:131], v[204:207], v[220:223], v[128:131]
  v_mfma_f32_16x16x32_bf16 v[132:135], v[204:207], v[224:227], v[132:135]
  v_mfma_f32_16x16x32_bf16 v[136:139], v[204:207], v[228:231], v[136:139]
  s_waitcnt lgkmcnt(0)
  v_mfma_f32_16x16x32_bf16 v[140:143], v[208:211], v[212:215], v[140:143]
  v_mfma_f32_16x16x32_bf16 v[144:147], v[208:211], v[216:219], v[144:147]
  v_mfma_f32_16x16x32_bf16 v[148:151], v[208:211], v[220:223], v[148:151]
  v_mfma_f32_16x16x32_bf16 v[152:155], v[208:211], v[224:227], v[152:155]
  v_mfma_f32_16x16x32_bf16 v[156:159], v[208:211], v[228:231], v[156:159]
  v_mfma_f32_16x16x32_bf16 v[160:163], v[232:235], v[212:215], v[160:163]
  v_mfma_f32_16x16x32_bf16 v[164:167], v[232:235], v[216:219], v[164:167]
  v_mfma_f32_16x16x32_bf16 v[168:171], v[232:235], v[220:223], v[168:171]
  v_mfma_f32_16x16x32_bf16 v[172:175], v[232:235], v[224:227], v[172:175]
  v_mfma_f32_16x16x32_bf16 v[176:179], v[232:235], v[228:231], v[176:179]
  s_waitcnt vmcnt(0)
  s_barrier
  v_mov_b32 v252, 151552
  ds_read_b128 v[248:251], v252 offset:16
  ds_read_b64_tr_b16 v[180:181], v236 offset:8192
  ds_read_b64_tr_b16 v[182:183], v236 offset:12288
  ds_read_b64_tr_b16 v[184:185], v237 offset:8192
  ds_read_b64_tr_b16 v[186:187], v237 offset:12288
  ds_read_b128 v[212:215], v246 offset:10240
  ds_read_b128 v[216:219], v246 offset:11264
  ds_read_b128 v[220:223], v246 offset:12288
  ds_read_b128 v[224:227], v246 offset:13312
  ds_read_b128 v[228:231], v246 offset:14336
  s_waitcnt lgkmcnt(9)
  v_or3_b32 v248, v248, v249, v250
  v_or_b32 v248, v248, v251
  v_cmp_ne_u32 vcc, 0, v248
  s_mov_b32 s25, 5
  s_mov_b32 s24, 10240
  s_cbranch_vccnz L_slow_pv_B
L_back_22:
  ds_read_b64_tr_b16 v[188:189], v238 offset:8192
  ds_read_b64_tr_b16 v[190:191], v238 offset:12288
  ds_read_b64_tr_b16 v[192:193], v239 offset:8192
  ds_read_b64_tr_b16 v[194:195], v239 offset:12288
  s_waitcnt lgkmcnt(4)
  ds_read_b64_tr_b16 v[196:197], v240 offset:8192
  ds_read_b64_tr_b16 v[198:199], v240 offset:12288
  v_mfma_f32_16x16x32_bf16 v[0:3], v[180:183], v[212:215], v[0:3]
  v_mfma_f32_16x16x32_bf16 v[4:7], v[180:183], v[216:219], v[4:7]
  v_mfma_f32_16x16x32_bf16 v[8:11], v[180:183], v[220:223], v[8:11]
  v_mfma_f32_16x16x32_bf16 v[12:15], v[180:183], v[224:227], v[12:15]
  v_mfma_f32_16x16x32_bf16 v[16:19], v[180:183], v[228:231], v[16:19]
  s_waitcnt lgkmcnt(6)
  ds_read_b64_tr_b16 v[200:201], v241 offset:8192
  ds_read_b64_tr_b16 v[202:203], v241 offset:12288
  v_mfma_f32_16x16x32_bf16 v[20:23], v[184:187], v[212:215], v[20:23]
  v_mfma_f32_16x16x32_bf16 v[24:27], v[184:187], v[216:219], v[24:27]
  v_mfma_f32_16x16x32_bf16 v[28:31], v[184:187], v[220:223], v[28:31]
  v_mfma_f32_16x16x32_bf16 v[32:35], v[184:187], v[224:227], v[32:35]
  v_mfma_f32_16x16x32_bf16 v[36:39], v[184:187], v[228:231], v[36:39]
  s_waitcnt lgkmcnt(6)
  ds_read_b64_tr_b16 v[204:205], v242 offset:8192
  ds_read_b64_tr_b16 v[206:207], v242 offset:12288
  v_mfma_f32_16x16x32_bf16 v[40:43], v[188:191], v[212:215], v[40:43]
  v_mfma_f32_16x16x32_bf16 v[44:47], v[188:191], v[216:219], v[44:47]
  v_mfma_f32_16x16x32_bf16 v[48:51], v[188:191], v[220:223], v[48:51]
  v_mfma_f32_16x16x32_bf16 v[52:55], v[188:191], v[224:227], v[52:55]
  v_mfma_f32_16x16x32_bf16 v[56:59], v[188:191], v[228:231], v[56:59]
  s_waitcnt lgkmcnt(6)
  ds_read_b64_tr_b16 v[208:209], v243 offset:8192
  ds_read_b64_tr_b16 v[210:211], v243 offset:12288
  v_mfma_f32_16x16x32_bf16 v[60:63], v[192:195], v[212:215], v[60:63]
  v_mfma_f32_16x16x32_bf16 v[64:67], v[192:195], v[216:219], v[64:67]
  v_mfma_f32_16x16x32_bf16 v[68:71], v[192:195], v[220:223], v[68:71]
  v_mfma_f32_16x16x32_bf16 v[72:75], v[192:195], v[224:227], v[72:75]
  v_mfma_f32_16x16x32_bf16 v[76:79], v[192:195], v[228:231], v[76:79]
  s_waitcnt lgkmcnt(6)
  v_mfma_f32_16x16x32_bf16 v[80:83], v[196:199], v[212:215], v[80:83]
  v_mfma_f32_16x16x32_bf16 v[84:87], v[196:199], v[216:219], v[84:87]
  v_mfma_f32_16x16x32_bf16 v[88:91], v[196:199], v[220:223], v[88:91]
  v_mfma_f32_16x16x32_bf16 v[92:95], v[196:199], v[224:227], v[92:95]
  v_mfma_f32_16x16x32_bf16 v[96:99], v[196:199], v[228:231], v[96:99]
  s_waitcnt lgkmcnt(4)
  v_mfma_f32_16x16x32_bf16 v[100:103], v[200:203], v[212:215], v[100:103]
  v_mfma_f32_16x16x32_bf16 v[104:107], v[200:203], v[216:219], v[104:107]
  v_mfma_f32_16x16x32_bf16 v[108:111], v[200:203], v[220:223], v[108:111]
  v_mfma_f32_16x16x32_bf16 v[112:115], v[200:203], v[224:227], v[112:115]
  v_mfma_f32_16x16x32_bf16 v[116:119], v[200:203], v[228:231], v[116:119]
  s_waitcnt lgkmcnt(2)
  v_mfma_f32_16x16x32_bf16 v[120:123], v[204:207], v[212:215], v[120:123]
  v_mfma_f32_16x16x32_bf16 v[124:127], v[204:207], v[216:219], v[124:127]
  v_mfma_f32_16x16x32_bf16 v[128:131], v[204:207], v[220:223], v[128:131]
  v_mfma_f32_16x16x32_bf16 v[132:135], v[204:207], v[224:227], v[132:135]
  v_mfma_f32_16x16x32_bf16 v[136:139], v[204:207], v[228:231], v[136:139]
  s_waitcnt lgkmcnt(0)
  v_mfma_f32_16x16x32_bf16 v[140:143], v[208:211], v[212:215], v[140:143]
  v_mfma_f32_16x16x32_bf16 v[144:147], v[208:211], v[216:219], v[144:147]
  v_mfma_f32_16x16x32_bf16 v[148:151], v[208:211], v[220:223], v[148:151]
  v_mfma_f32_16x16x32_bf16 v[152:155], v[208:211], v[224:227], v[152:155]
  v_mfma_f32_16x16x32_bf16 v[156:159], v[208:211], v[228:231], v[156:159]
  v_mfma_f32_16x16x32_bf16 v[160:163], v[232:235], v[212:215], v[160:163]
  v_mfma_f32_16x16x32_bf16 v[164:167], v[232:235], v[216:219], v[164:167]
  v_mfma_f32_16x16x32_bf16 v[168:171], v[232:235], v[220:223], v[168:171]
  v_mfma_f32_16x16x32_bf16 v[172:175], v[232:235], v[224:227], v[172:175]
  v_mfma_f32_16x16x32_bf16 v[176:179], v[232:235], v[228:231], v[176:179]
  s_barrier
  s_branch L_attn_kernel_pvepi
L_attn_kernel_pvA:
  s_and_b32 s21, s20, 31
  s_lshl_b32 s21, s21, 14
  s_lshl_b32 s31, s17, 13
  s_add_u32 s21, s21, s31
  s_add_u32 m0, s22, 0
  s_add_u32 s20, s20, 1
  buffer_load_dwordx4 v244, s[4:7], s21 offen nt lds
  s_add_u32 s21, s21, 1024
  buffer_load_dwordx4 v245, s[4:7], s21 offen offset:1024 nt lds
  s_add_u32 s21, s21, 1024
  buffer_load_dwordx4 v244, s[4:7], s21 offen offset:2048 nt lds
  s_add_u32 s21, s21, 1024
  buffer_load_dwordx4 v245, s[4:7], s21 offen offset:3072 nt lds
  s_waitcnt vmcnt(0)
  s_barrier
  v_mov_b32 v252, 151552
  ds_read_b128 v[248:251], v252 offset:0
  ds_read_b64_tr_b16 v[180:181], v236
  ds_read_b64_tr_b16 v[182:183], v236 offset:4096
  ds_read_b64_tr_b16 v[184:185], v237
  ds_read_b64_tr_b16 v[186:187], v237 offset:4096
  ds_read_b128 v[212:215], v246 offset:0
  ds_read_b128 v[216:219], v246 offset:1024
  ds_read_b128 v[220:223], v246 offset:2048
  ds_read_b128 v[224:227], v246 offset:3072
  ds_read_b128 v[228:231], v246 offset:4096
  s_waitcnt lgkmcnt(9)
  v_or3_b32 v248, v248, v249, v250
  v_or_b32 v248, v248, v251
  v_cmp_ne_u32 vcc, 0, v248
  s_mov_b32 s25, 0
  s_mov_b32 s24, 0
  s_cbranch_vccnz L_slow_pv_A
L_back_23:
  ds_read_b64_tr_b16 v[188:189], v238
  ds_read_b64_tr_b16 v[190:191], v238 offset:4096
  ds_read_b64_tr_b16 v[192:193], v239
  ds_read_b64_tr_b16 v[194:195], v239 offset:4096
  s_waitcnt lgkmcnt(4)
  ds_read_b64_tr_b16 v[196:197], v240
  ds_read_b64_tr_b16 v[198:199], v240 offset:4096
  v_mfma_f32_16x16x32_bf16 v[0:3], v[180:183], v[212:215], 0
  v_mfma_f32_16x16x32_bf16 v[4:7], v[180:183], v[216:219], 0
  v_mfma_f32_16x16x32_bf16 v[8:11], v[180:183], v[220:223], 0
  v_mfma_f32_16x16x32_bf16 v[12:15], v[180:183], v[224:227], 0
  v_mfma_f32_16x16x32_bf16 v[16:19], v[180:183], v[228:231], 0
  s_waitcnt lgkmcnt(6)
  ds_read_b64_tr_b16 v[200:201], v241
  ds_read_b64_tr_b16 v[202:203], v241 offset:4096
  v_mfma_f32_16x16x32_bf16 v[20:23], v[184:187], v[212:215], 0
  v_mfma_f32_16x16x32_bf16 v[24:27], v[184:187], v[216:219], 0
  v_mfma_f32_16x16x32_bf16 v[28:31], v[184:187], v[220:223], 0
  v_mfma_f32_16x16x32_bf16 v[32:35], v[184:187], v[224:227], 0
  v_mfma_f32_16x16x32_bf16 v[36:39], v[184:187], v[228:231], 0
  s_and_b32 s21, s20, 31
  s_lshl_b32 s21, s21, 14
  s_lshl_b32 s31, s17, 13
  s_add_u32 s21, s21, s31
  s_add_u32 m0, s22, 8192
  s_add_u32 s20, s20, 1
  buffer_load_dwordx4 v244, s[4:7], s21 offen nt lds
  s_waitcnt lgkmcnt(6)
  ds_read_b64_tr_b16 v[204:205], v242
  ds_read_b64_tr_b16 v[206:207], v242 offset:4096
  v_mfma_f32_16x16x32_bf16 v[40:43], v[188:191], v[212:215], 0
  v_mfma_f32_16x16x32_bf16 v[44:47], v[188:191], v[216:219], 0
  v_mfma_f32_16x16x32_bf16 v[48:51], v[188:191], v[220:223], 0
  v_mfma_f32_16x16x32_bf16 v[52:55], v[188:191], v[224:227], 0
  v_mfma_f32_16x16x32_bf16 v[56:59], v[188:191], v[228:231], 0
  s_add_u32 s21, s21, 1024
  buffer_load_dwordx4 v245, s[4:7], s21 offen offset:1024 nt lds
  s_waitcnt lgkmcnt(6)
  ds_read_b64_tr_b16 v[208:209], v243
  ds_read_b64_tr_b16 v[210:211], v243 offset:4096
  v_mfma_f32_16x16x32_bf16 v[60:63], v[192:195], v[212:215], 0
  v_mfma_f32_16x16x32_bf16 v[64:67], v[192:195], v[216:219], 0
  v_mfma_f32_16x16x32_bf16 v[68:71], v[192:195], v[220:223], 0
  v_mfma_f32_16x16x32_bf16 v[72:75], v[192:195], v[224:227], 0
  v_mfma_f32_16x16x32_bf16 v[76:79], v[192:195], v[228:231], 0
  s_add_u32 s21, s21, 1024
  buffer_load_dwordx4 v244, s[4:7], s21 offen offset:2048 nt lds
  s_waitcnt lgkmcnt(6)
  v_mfma_f32_16x16x32_bf16 v[80:83], v[196:199], v[212:215], 0
  v_mfma_f32_16x16x32_bf16 v[84:87], v[196:199], v[216:219], 0
  v_mfma_f32_16x16x32_bf16 v[88:91], v[196:199], v[220:223], 0
  v_mfma_f32_16x16x32_bf16 v[92:95], v[196:199], v[224:227], 0
  v_mfma_f32_16x16x32_bf16 v[96:99], v[196:199], v[228:231], 0
  s_add_u32 s21, s21, 1024
  buffer_load_dwordx4 v245, s[4:7], s21 offen offset:3072 nt lds
  s_waitcnt lgkmcnt(4)
  v_mfma_f32_16x16x32_bf16 v[100:103], v[200:203], v[212:215], 0
  v_mfma_f32_16x16x32_bf16 v[104:107], v[200:203], v[216:219], 0
  v_mfma_f32_16x16x32_bf16 v[108:111], v[200:203], v[220:223], 0
  v_mfma_f32_16x16x32_bf16 v[112:115], v[200:203], v[224:227], 0
  v_mfma_f32_16x16x32_bf16 v[116:119], v[200:203], v[228:231], 0
  s_waitcnt lgkmcnt(2)
  v_mfma_f32_16x16x32_bf16 v[120:123], v[204:207], v[212:215], 0
  v_mfma_f32_16x16x32_bf16 v[124:127], v[204:207], v[216:219], 0
  v_mfma_f32_16x16x32_bf16 v[128:131], v[204:207], v[220:223], 0
  v_mfma_f32_16x16x32_bf16 v[132:135], v[204:207], v[224:227], 0
  v_mfma_f32_16x16x32_bf16 v[136:139], v[204:207], v[228:231], 0
  s_waitcnt lgkmcnt(0)
  v_mfma_f32_16x16x32_bf16 v[140:143], v[208:211], v[212:215], 0
  v_mfma_f32_16x16x32_bf16 v[144:147], v[208:211], v[216:219], 0
  v_mfma_f32_16x16x32_bf16 v[148:151], v[208:211], v[220:223], 0
  v_mfma_f32_16x16x32_bf16 v[152:155], v[208:211], v[224:227], 0
  v_mfma_f32_16x16x32_bf16 v[156:159], v[208:211], v[228:231], 0
  v_mfma_f32_16x16x32_bf16 v[160:163], v[232:235], v[212:215], 0
  v_mfma_f32_16x16x32_bf16 v[164:167], v[232:235], v[216:219], 0
  v_mfma_f32_16x16x32_bf16 v[168:171], v[232:235], v[220:223], 0
  v_mfma_f32_16x16x32_bf16 v[172:175], v[232:235], v[224:227], 0
  v_mfma_f32_16x16x32_bf16 v[176:179], v[232:235], v[228:231], 0
  s_waitcnt vmcnt(0)
  s_barrier
  s_mov_b32 s23, 15
L_pv_A_24:
  v_mov_b32 v252, 151552
  ds_read_b128 v[248:251], v252 offset:16
  ds_read_b64_tr_b16 v[180:181], v236 offset:8192
  ds_read_b64_tr_b16 v[182:183], v236 offset:12288
  ds_read_b64_tr_b16 v[184:185], v237 offset:8192
  ds_read_b64_tr_b16 v[186:187], v237 offset:12288
  ds_read_b128 v[212:215], v246 offset:10240
  ds_read_b128 v[216:219], v246 offset:11264
  ds_read_b128 v[220:223], v246 offset:12288
  ds_read_b128 v[224:227], v246 offset:13312
  ds_read_b128 v[228:231], v246 offset:14336
  s_waitcnt lgkmcnt(9)
  v_or3_b32 v248, v248, v249, v250
  v_or_b32 v248, v248, v251
  v_cmp_ne_u32 vcc, 0, v248
  s_mov_b32 s25, 1
  s_mov_b32 s24, 10240
  s_cbranch_vccnz L_slow_pv_A
L_back_25:
  ds_read_b64_tr_b16 v[188:189], v238 offset:8192
  ds_read_b64_tr_b16 v[190:191], v238 offset:12288
  ds_read_b64_tr_b16 v[192:193], v239 offset:8192
  ds_read_b64_tr_b16 v[194:195], v239 offset:12288
  s_waitcnt lgkmcnt(4)
  ds_read_b64_tr_b16 v[196:197], v240 offset:8192
  ds_read_b64_tr_b16 v[198:199], v240 offset:12288
  v_mfma_f32_16x16x32_bf16 v[0:3], v[180:183], v[212:215], v[0:3]
  v_mfma_f32_16x16x32_bf16 v[4:7], v[180:183], v[216:219], v[4:7]
  v_mfma_f32_16x16x32_bf16 v[8:11], v[180:183], v[220:223], v[8:11]
  v_mfma_f32_16x16x32_bf16 v[12:15], v[180:183], v[224:227], v[12:15]
  v_mfma_f32_16x16x32_bf16 v[16:19], v[180:183], v[228:231], v[16:19]
  s_waitcnt lgkmcnt(6)
  ds_read_b64_tr_b16 v[200:201], v241 offset:8192
  ds_read_b64_tr_b16 v[202:203], v241 offset:12288
  v_mfma_f32_16x16x32_bf16 v[20:23], v[184:187], v[212:215], v[20:23]
  v_mfma_f32_16x16x32_bf16 v[24:27], v[184:187], v[216:219], v[24:27]
  v_mfma_f32_16x16x32_bf16 v[28:31], v[184:187], v[220:223], v[28:31]
  v_mfma_f32_16x16x32_bf16 v[32:35], v[184:187], v[224:227], v[32:35]
  v_mfma_f32_16x16x32_bf16 v[36:39], v[184:187], v[228:231], v[36:39]
  s_and_b32 s21, s20, 31
  s_lshl_b32 s21, s21, 14
  s_lshl_b32 s31, s17, 13
  s_add_u32 s21, s21, s31
  s_add_u32 m0, s22, 0
  s_add_u32 s20, s20, 1
  buffer_load_dwordx4 v244, s[4:7], s21 offen nt lds
  s_waitcnt lgkmcnt(6)
  ds_read_b64_tr_b16 v[204:205], v242 offset:8192
  ds_read_b64_tr_b16 v[206:207], v242 offset:12288
  v_mfma_f32_16x16x32_bf16 v[40:43], v[188:191], v[212:215], v[40:43]
  v_mfma_f32_16x16x32_bf16 v[44:47], v[188:191], v[216:219], v[44:47]
  v_mfma_f32_16x16x32_bf16 v[48:51], v[188:191], v[220:223], v[48:51]
  v_mfma_f32_16x16x32_bf16 v[52:55], v[188:191], v[224:227], v[52:55]
  v_mfma_f32_16x16x32_bf16 v[56:59], v[188:191], v[228:231], v[56:59]
  s_add_u32 s21, s21, 1024
  buffer_load_dwordx4 v245, s[4:7], s21 offen offset:1024 nt lds
  s_waitcnt lgkmcnt(6)
  ds_read_b64_tr_b16 v[208:209], v243 offset:8192
  ds_read_b64_tr_b16 v[210:211], v243 offset:12288
  v_mfma_f32_16x16x32_bf16 v[60:63], v[192:195], v[212:215], v[60:63]
  v_mfma_f32_16x16x32_bf16 v[64:67], v[192:195], v[216:219], v[64:67]
  v_mfma_f32_16x16x32_bf16 v[68:71], v[192:195], v[220:223], v[68:71]
  v_mfma_f32_16x16x32_bf16 v[72:75], v[192:195], v[224:227], v[72:75]
  v_mfma_f32_16x16x32_bf16 v[76:79], v[192:195], v[228:231], v[76:79]
  s_add_u32 s21, s21, 1024
  buffer_load_dwordx4 v244, s[4:7], s21 offen offset:2048 nt lds
  s_waitcnt lgkmcnt(6)
  v_mfma_f32_16x16x32_bf16 v[80:83], v[196:199], v[212:215], v[80:83]
  v_mfma_f32_16x16x32_bf16 v[84:87], v[196:199], v[216:219], v[84:87]
  v_mfma_f32_16x16x32_bf16 v[88:91], v[196:199], v[220:223], v[88:91]
  v_mfma_f32_16x16x32_bf16 v[92:95], v[196:199], v[224:227], v[92:95]
  v_mfma_f32_16x16x32_bf16 v[96:99], v[196:199], v[228:231], v[96:99]
  s_add_u32 s21, s21, 1024
  buffer_load_dwordx4 v245, s[4:7], s21 offen offset:3072 nt lds
  s_waitcnt lgkmcnt(4)
  v_mfma_f32_16x16x32_bf16 v[100:103], v[200:203], v[212:215], v[100:103]
  v_mfma_f32_16x16x32_bf16 v[104:107], v[200:203], v[216:219], v[104:107]
  v_mfma_f32_16x16x32_bf16 v[108:111], v[200:203], v[220:223], v[108:111]
  v_mfma_f32_16x16x32_bf16 v[112:115], v[200:203], v[224:227], v[112:115]
  v_mfma_f32_16x16x32_bf16 v[116:119], v[200:203], v[228:231], v[116:119]
  s_waitcnt lgkmcnt(2)
  v_mfma_f32_16x16x32_bf16 v[120:123], v[204:207], v[212:215], v[120:123]
  v_mfma_f32_16x16x32_bf16 v[124:127], v[204:207], v[216:219], v[124:127]
  v_mfma_f32_16x16x32_bf16 v[128:131], v[204:207], v[220:223], v[128:131]
  v_mfma_f32_16x16x32_bf16 v[132:135], v[204:207], v[224:227], v[132:135]
  v_mfma_f32_16x16x32_bf16 v[136:139], v[204:207], v[228:231], v[136:139]
  s_waitcnt lgkmcnt(0)
  v_mfma_f32_16x16x32_bf16 v[140:143], v[208:211], v[212:215], v[140:143]
  v_mfma_f32_16x16x32_bf16 v[144:147], v[208:211], v[216:219], v[144:147]
  v_mfma_f32_16x16x32_bf16 v[148:151], v[208:211], v[220:223], v[148:151]
  v_mfma_f32_16x16x32_bf16 v[152:155], v[208:211], v[224:227], v[152:155]
  v_mfma_f32_16x16x32_bf16 v[156:159], v[208:211], v[228:231], v[156:159]
  v_mfma_f32_16x16x32_bf16 v[160:163], v[232:235], v[212:215], v[160:163]
  v_mfma_f32_16x16x32_bf16 v[164:167], v[232:235], v[216:219], v[164:167]
  v_mfma_f32_16x16x32_bf16 v[168:171], v[232:235], v[220:223], v[168:171]
  v_mfma_f32_16x16x32_bf16 v[172:175], v[232:235], v[224:227], v[172:175]
  v_mfma_f32_16x16x32_bf16 v[176:179], v[232:235], v[228:231], v[176:179]
  s_waitcnt vmcnt(0)
  s_barrier
  v_mov_b32 v252, 151552
  ds_read_b128 v[248:251], v252 offset:0
  ds_read_b64_tr_b16 v[180:181], v236
  ds_read_b64_tr_b16 v[182:183], v236 offset:4096
  ds_read_b64_tr_b16 v[184:185], v237
  ds_read_b64_tr_b16 v[186:187], v237 offset:4096
  ds_read_b128 v[212:215], v246 offset:0
  ds_read_b128 v[216:219], v246 offset:1024
  ds_read_b128 v[220:223], v246 offset:2048
  ds_read_b128 v[224:227], v246 offset:3072
  ds_read_b128 v[228:231], v246 offset:4096
  s_waitcnt lgkmcnt(9)
  v_or3_b32 v248, v248, v249, v250
  v_or_b32 v248, v248, v251
  v_cmp_ne_u32 vcc, 0, v248
  s_mov_b32 s25, 2
  s_mov_b32 s24, 0
  s_cbranch_vccnz L_slow_pv_A
L_back_26:
  ds_read_b64_tr_b16 v[188:189], v238
  ds_read_b64_tr_b16 v[190:191], v238 offset:4096
  ds_read_b64_tr_b16 v[192:193], v239
  ds_read_b64_tr_b16 v[194:195], v239 offset:4096
  s_waitcnt lgkmcnt(4)
  ds_read_b64_tr_b16 v[196:197], v240
  ds_read_b64_tr_b16 v[198:199], v240 offset:4096
  v_mfma_f32_16x16x32_bf16 v[0:3], v[180:183], v[212:215], v[0:3]
  v_mfma_f32_16x16x32_bf16 v[4:7], v[180:183], v[216:219], v[4:7]
  v_mfma_f32_16x16x32_bf16 v[8:11], v[180:183], v[220:223], v[8:11]
  v_mfma_f32_16x16x32_bf16 v[12:15], v[180:183], v[224:227], v[12:15]
  v_mfma_f32_16x16x32_bf16 v[16:19], v[180:183], v[228:231], v[16:19]
  s_waitcnt lgkmcnt(6)
  ds_read_b64_tr_b16 v[200:201], v241
  ds_read_b64_tr_b16 v[202:203], v241 offset:4096
  v_mfma_f32_16x16x32_bf16 v[20:23], v[184:187], v[212:215], v[20:23]
  v_mfma_f32_16x16x32_bf16 v[24:27], v[184:187], v[216:219], v[24:27]
  v_mfma_f32_16x16x32_bf16 v[28:31], v[184:187], v[220:223], v[28:31]
  v_mfma_f32_16x16x32_bf16 v[32:35], v[184:187], v[224:227], v[32:35]
  v_mfma_f32_16x16x32_bf16 v[36:39], v[184:187], v[228:231], v[36:39]
  s_and_b32 s21, s20, 31
  s_lshl_b32 s21, s21, 14
  s_lshl_b32 s31, s17, 13
  s_add_u32 s21, s21, s31
  s_add_u32 m0, s22, 8192
  s_add_u32 s20, s20, 1
  buffer_load_dwordx4 v244, s[4:7], s21 offen nt lds
  s_waitcnt lgkmcnt(6)
  ds_read_b64_tr_b16 v[204:205], v242
  ds_read_b64_tr_b16 v[206:207], v242 offset:4096
  v_mfma_f32_16x16x32_bf16 v[40:43], v[188:191], v[212:215], v[40:43]
  v_mfma_f32_16x16x32_bf16 v[44:47], v[188:191], v[216:219], v[44:47]
  v_mfma_f32_16x16x32_bf16 v[48:51], v[188:191], v[220:223], v[48:51]
  v_mfma_f32_16x16x32_bf16 v[52:55], v[188:191], v[224:227], v[52:55]
  v_mfma_f32_16x16x32_bf16 v[56:59], v[188:191], v[228:231], v[56:59]
  s_add_u32 s21, s21, 1024
  buffer_load_dwordx4 v245, s[4:7], s21 offen offset:1024 nt lds
  s_waitcnt lgkmcnt(6)
  ds_read_b64_tr_b16 v[208:209], v243
  ds_read_b64_tr_b16 v[210:211], v243 offset:4096
  v_mfma_f32_16x16x32_bf16 v[60:63], v[192:195], v[212:215], v[60:63]
  v_mfma_f32_16x16x32_bf16 v[64:67], v[192:195], v[216:219], v[64:67]
  v_mfma_f32_16x16x32_bf16 v[68:71], v[192:195], v[220:223], v[68:71]
  v_mfma_f32_16x16x32_bf16 v[72:75], v[192:195], v[224:227], v[72:75]
  v_mfma_f32_16x16x32_bf16 v[76:79], v[192:195], v[228:231], v[76:79]
  s_add_u32 s21, s21, 1024
  buffer_load_dwordx4 v244, s[4:7], s21 offen offset:2048 nt lds
  s_waitcnt lgkmcnt(6)
  v_mfma_f32_16x16x32_bf16 v[80:83], v[196:199], v[212:215], v[80:83]
  v_mfma_f32_16x16x32_bf16 v[84:87], v[196:199], v[216:219], v[84:87]
  v_mfma_f32_16x16x32_bf16 v[88:91], v[196:199], v[220:223], v[88:91]
  v_mfma_f32_16x16x32_bf16 v[92:95], v[196:199], v[224:227], v[92:95]
  v_mfma_f32_16x16x32_bf16 v[96:99], v[196:199], v[228:231], v[96:99]
  s_add_u32 s21, s21, 1024
  buffer_load_dwordx4 v245, s[4:7], s21 offen offset:3072 nt lds
  s_waitcnt lgkmcnt(4)
  v_mfma_f32_16x16x32_bf16 v[100:103], v[200:203], v[212:215], v[100:103]
  v_mfma_f32_16x16x32_bf16 v[104:107], v[200:203], v[216:219], v[104:107]
  v_mfma_f32_16x16x32_bf16 v[108:111], v[200:203], v[220:223], v[108:111]
  v_mfma_f32_16x16x32_bf16 v[112:115], v[200:203], v[224:227], v[112:115]
  v_mfma_f32_16x16x32_bf16 v[116:119], v[200:203], v[228:231], v[116:119]
  s_waitcnt lgkmcnt(2)
  v_mfma_f32_16x16x32_bf16 v[120:123], v[204:207], v[212:215], v[120:123]
  v_mfma_f32_16x16x32_bf16 v[124:127], v[204:207], v[216:219], v[124:127]
  v_mfma_f32_16x16x32_bf16 v[128:131], v[204:207], v[220:223], v[128:131]
  v_mfma_f32_16x16x32_bf16 v[132:135], v[204:207], v[224:227], v[132:135]
  v_mfma_f32_16x16x32_bf16 v[136:139], v[204:207], v[228:231], v[136:139]
  s_waitcnt lgkmcnt(0)
  v_mfma_f32_16x16x32_bf16 v[140:143], v[208:211], v[212:215], v[140:143]
  v_mfma_f32_16x16x32_bf16 v[144:147], v[208:211], v[216:219], v[144:147]
  v_mfma_f32_16x16x32_bf16 v[148:151], v[208:211], v[220:223], v[148:151]
  v_mfma_f32_16x16x32_bf16 v[152:155], v[208:211], v[224:227], v[152:155]
  v_mfma_f32_16x16x32_bf16 v[156:159], v[208:211], v[228:231], v[156:159]
  v_mfma_f32_16x16x32_bf16 v[160:163], v[232:235], v[212:215], v[160:163]
  v_mfma_f32_16x16x32_bf16 v[164:167], v[232:235], v[216:219], v[164:167]
  v_mfma_f32_16x16x32_bf16 v[168:171], v[232:235], v[220:223], v[168:171]
  v_mfma_f32_16x16x32_bf16 v[172:175], v[232:235], v[224:227], v[172:175]
  v_mfma_f32_16x16x32_bf16 v[176:179], v[232:235], v[228:231], v[176:179]
  s_waitcnt vmcnt(0)
  s_barrier
  s_sub_u32 s23, s23, 1
  s_cmp_lg_u32 s23, 0
  s_cbranch_scc1 L_pv_A_24
  v_mov_b32 v252, 151552
  ds_read_b128 v[248:251], v252 offset:16
  ds_read_b64_tr_b16 v[180:181], v236 offset:8192
  ds_read_b64_tr_b16 v[182:183], v236 offset:12288
  ds_read_b64_tr_b16 v[184:185], v237 offset:8192
  ds_read_b64_tr_b16 v[186:187], v237 offset:12288
  ds_read_b128 v[212:215], v246 offset:10240
  ds_read_b128 v[216:219], v246 offset:11264
  ds_read_b128 v[220:223], v246 offset:12288
  ds_read_b128 v[224:227], v246 offset:13312
  ds_read_b128 v[228:231], v246 offset:14336
  s_waitcnt lgkmcnt(9)
  v_or3_b32 v248, v248, v249, v250
  v_or_b32 v248, v248, v251
  v_cmp_ne_u32 vcc, 0, v248
  s_mov_b32 s25, 3
  s_mov_b32 s24, 10240
  s_cbranch_vccnz L_slow_pv_A
L_back_27:
  ds_read_b64_tr_b16 v[188:189], v238 offset:8192
  ds_read_b64_tr_b16 v[190:191], v238 offset:12288
  ds_read_b64_tr_b16 v[192:193], v239 offset:8192
  ds_read_b64_tr_b16 v[194:195], v239 offset:12288
  s_waitcnt lgkmcnt(4)
  ds_read_b64_tr_b16 v[196:197], v240 offset:8192
  ds_read_b64_tr_b16 v[198:199], v240 offset:12288
  v_mfma_f32_16x16x32_bf16 v[0:3], v[180:183], v[212:215], v[0:3]
  v_mfma_f32_16x16x32_bf16 v[4:7], v[180:183], v[216:219], v[4:7]
  v_mfma_f32_16x16x32_bf16 v[8:11], v[180:183], v[220:223], v[8:11]
  v_mfma_f32_16x16x32_bf16 v[12:15], v[180:183], v[224:227], v[12:15]
  v_mfma_f32_16x16x32_bf16 v[16:19], v[180:183], v[228:231], v[16:19]
  s_waitcnt lgkmcnt(6)
  ds_read_b64_tr_b16 v[200:201], v241 offset:8192
  ds_read_b64_tr_b16 v[202:203], v241 offset:12288
  v_mfma_f32_16x16x32_bf16 v[20:23], v[184:187], v[212:215], v[20:23]
  v_mfma_f32_16x16x32_bf16 v[24:27], v[184:187], v[216:219], v[24:27]
  v_mfma_f32_16x16x32_bf16 v[28:31], v[184:187], v[220:223], v[28:31]
  v_mfma_f32_16x16x32_bf16 v[32:35], v[184:187], v[224:227], v[32:35]
  v_mfma_f32_16x16x32_bf16 v[36:39], v[184:187], v[228:231], v[36:39]
  s_waitcnt lgkmcnt(6)
  ds_read_b64_tr_b16 v[204:205], v242 offset:8192
  ds_read_b64_tr_b16 v[206:207], v242 offset:12288
  v_mfma_f32_16x16x32_bf16 v[40:43], v[188:191], v[212:215], v[40:43]
  v_mfma_f32_16x16x32_bf16 v[44:47], v[188:191], v[216:219], v[44:47]
  v_mfma_f32_16x16x32_bf16 v[48:51], v[188:191], v[220:223], v[48:51]
  v_mfma_f32_16x16x32_bf16 v[52:55], v[188:191], v[224:227], v[52:55]
  v_mfma_f32_16x16x32_bf16 v[56:59], v[188:191], v[228:231], v[56:59]
  s_waitcnt lgkmcnt(6)
  ds_read_b64_tr_b16 v[208:209], v243 offset:8192
  ds_read_b64_tr_b16 v[210:211], v243 offset:12288
  v_mfma_f32_16x16x32_bf16 v[60:63], v[192:195], v[212:215], v[60:63]
  v_mfma_f32_16x16x32_bf16 v[64:67], v[192:195], v[216:219], v[64:67]
  v_mfma_f32_16x16x32_bf16 v[68:71], v[192:195], v[220:223], v[68:71]
  v_mfma_f32_16x16x32_bf16 v[72:75], v[192:195], v[224:227], v[72:75]
  v_mfma_f32_16x16x32_bf16 v[76:79], v[192:195], v[228:231], v[76:79]
  s_waitcnt lgkmcnt(6)
  v_mfma_f32_16x16x32_bf16 v[80:83], v[196:199], v[212:215], v[80:83]
  v_mfma_f32_16x16x32_bf16 v[84:87], v[196:199], v[216:219], v[84:87]
  v_mfma_f32_16x16x32_bf16 v[88:91], v[196:199], v[220:223], v[88:91]
  v_mfma_f32_16x16x32_bf16 v[92:95], v[196:199], v[224:227], v[92:95]
  v_mfma_f32_16x16x32_bf16 v[96:99], v[196:199], v[228:231], v[96:99]
  s_waitcnt lgkmcnt(4)
  v_mfma_f32_16x16x32_bf16 v[100:103], v[200:203], v[212:215], v[100:103]
  v_mfma_f32_16x16x32_bf16 v[104:107], v[200:203], v[216:219], v[104:107]
  v_mfma_f32_16x16x32_bf16 v[108:111], v[200:203], v[220:223], v[108:111]
  v_mfma_f32_16x16x32_bf16 v[112:115], v[200:203], v[224:227], v[112:115]
  v_mfma_f32_16x16x32_bf16 v[116:119], v[200:203], v[228:231], v[116:119]
  s_waitcnt lgkmcnt(2)
  v_mfma_f32_16x16x32_bf16 v[120:123], v[204:207], v[212:215], v[120:123]
  v_mfma_f32_16x16x32_bf16 v[124:127], v[204:207], v[216:219], v[124:127]
  v_mfma_f32_16x16x32_bf16 v[128:131], v[204:207], v[220:223], v[128:131]
  v_mfma_f32_16x16x32_bf16 v[132:135], v[204:207], v[224:227], v[132:135]
  v_mfma_f32_16x16x32_bf16 v[136:139], v[204:207], v[228:231], v[136:139]
  s_waitcnt lgkmcnt(0)
  v_mfma_f32_16x16x32_bf16 v[140:143], v[208:211], v[212:215], v[140:143]
  v_mfma_f32_16x16x32_bf16 v[144:147], v[208:211], v[216:219], v[144:147]
  v_mfma_f32_16x16x32_bf16 v[148:151], v[208:211], v[220:223], v[148:151]
  v_mfma_f32_16x16x32_bf16 v[152:155], v[208:211], v[224:227], v[152:155]
  v_mfma_f32_16x16x32_bf16 v[156:159], v[208:211], v[228:231], v[156:159]
  v_mfma_f32_16x16x32_bf16 v[160:163], v[232:235], v[212:215], v[160:163]
  v_mfma_f32_16x16x32_bf16 v[164:167], v[232:235], v[216:219], v[164:167]
  v_mfma_f32_16x16x32_bf16 v[168:171], v[232:235], v[220:223], v[168:171]
  v_mfma_f32_16x16x32_bf16 v[172:175], v[232:235], v[224:227], v[172:175]
  v_mfma_f32_16x16x32_bf16 v[176:179], v[232:235], v[228:231], v[176:179]
  s_barrier
  s_branch L_attn_kernel_pvepi
L_attn_kernel_pvepi:
  s_setprio 3
  s_and_b32 s79, s16, 3
  s_mul_i32 s46, s79, 20480
  s_cmp_eq_u32 s79, 3
  s_cselect_b32 s46, 0, s46
  s_add_u32 s46, s46, 86016
  v_lshlrev_b32 v252, 4, v255
  v_add_u32 v252, s46, v252
  s_nop 3
  v_rcp_f32 v240, v160
  v_rcp_f32 v242, v164
  v_rcp_f32 v244, v168
  v_rcp_f32 v246, v172
  v_rcp_f32 v248, v176
  s_nop 0
  v_pk_mul_f32 v[0:1], v[0:1], v[240:241] op_sel_hi:[1,0]
  v_pk_mul_f32 v[2:3], v[2:3], v[240:241] op_sel_hi:[1,0]
  v_pk_mul_f32 v[20:21], v[20:21], v[240:241] op_sel_hi:[1,0]
  v_pk_mul_f32 v[22:23], v[22:23], v[240:241] op_sel_hi:[1,0]
  v_pk_mul_f32 v[4:5], v[4:5], v[242:243] op_sel_hi:[1,0]
  v_pk_mul_f32 v[6:7], v[6:7], v[242:243] op_sel_hi:[1,0]
  v_pk_mul_f32 v[24:25], v[24:25], v[242:243] op_sel_hi:[1,0]
  v_pk_mul_f32 v[26:27], v[26:27], v[242:243] op_sel_hi:[1,0]
  v_pk_mul_f32 v[8:9], v[8:9], v[244:245] op_sel_hi:[1,0]
  v_pk_mul_f32 v[10:11], v[10:11], v[244:245] op_sel_hi:[1,0]
  v_pk_mul_f32 v[28:29], v[28:29], v[244:245] op_sel_hi:[1,0]
  v_pk_mul_f32 v[30:31], v[30:31], v[244:245] op_sel_hi:[1,0]
  v_pk_mul_f32 v[12:13], v[12:13], v[246:247] op_sel_hi:[1,0]
  v_pk_mul_f32 v[14:15], v[14:15], v[246:247] op_sel_hi:[1,0]
  v_pk_mul_f32 v[32:33], v[32:33], v[246:247] op_sel_hi:[1,0]
  v_pk_mul_f32 v[34:35], v[34:35], v[246:247] op_sel_hi:[1,0]
  v_pk_mul_f32 v[16:17], v[16:17], v[248:249] op_sel_hi:[1,0]
  v_pk_mul_f32 v[18:19], v[18:19], v[248:249] op_sel_hi:[1,0]
  v_pk_mul_f32 v[36:37], v[36:37], v[248:249] op_sel_hi:[1,0]
  v_pk_mul_f32 v[38:39], v[38:39], v[248:249] op_sel_hi:[1,0]
  v_cvt_pk_bf16_f32 v160, v0, v1
  v_cvt_pk_bf16_f32 v161, v2, v3
  v_cvt_pk_bf16_f32 v162, v20, v21
  v_cvt_pk_bf16_f32 v163, v22, v23
  v_cvt_pk_bf16_f32 v164, v4, v5
  v_cvt_pk_bf16_f32 v165, v6, v7
  v_cvt_pk_bf16_f32 v166, v24, v25
  v_cvt_pk_bf16_f32 v167, v26, v27
  v_cvt_pk_bf16_f32 v168, v8, v9
  v_cvt_pk_bf16_f32 v169, v10, v11
  v_cvt_pk_bf16_f32 v170, v28, v29
  v_cvt_pk_bf16_f32 v171, v30, v31
  v_cvt_pk_bf16_f32 v172, v12, v13
  v_cvt_pk_bf16_f32 v173, v14, v15
  v_cvt_pk_bf16_f32 v174, v32, v33
  v_cvt_pk_bf16_f32 v175, v34, v35
  v_cvt_pk_bf16_f32 v176, v16, v17
  v_cvt_pk_bf16_f32 v177, v18, v19
  v_cvt_pk_bf16_f32 v178, v36, v37
  v_cvt_pk_bf16_f32 v179, v38, v39
  s_cmp_eq_u32 s16, 7
  s_cbranch_scc1 L_o_hold_28
  ds_write_b128 v252, v[160:163] offset:0
  ds_write_b128 v252, v[164:167] offset:4096
  ds_write_b128 v252, v[168:171] offset:8192
  ds_write_b128 v252, v[172:175] offset:12288
  ds_write_b128 v252, v[176:179] offset:16384
L_o_hold_28:
  s_waitcnt lgkmcnt(0)
  s_barrier
  v_pk_mul_f32 v[40:41], v[40:41], v[240:241] op_sel_hi:[1,0]
  v_pk_mul_f32 v[42:43], v[42:43], v[240:241] op_sel_hi:[1,0]
  v_pk_mul_f32 v[60:61], v[60:61], v[240:241] op_sel_hi:[1,0]
  v_pk_mul_f32 v[62:63], v[62:63], v[240:241] op_sel_hi:[1,0]
  v_pk_mul_f32 v[44:45], v[44:45], v[242:243] op_sel_hi:[1,0]
  v_pk_mul_f32 v[46:47], v[46:47], v[242:243] op_sel_hi:[1,0]
  v_pk_mul_f32 v[64:65], v[64:65], v[242:243] op_sel_hi:[1,0]
  v_pk_mul_f32 v[66:67], v[66:67], v[242:243] op_sel_hi:[1,0]
  v_pk_mul_f32 v[48:49], v[48:49], v[244:245] op_sel_hi:[1,0]
  v_pk_mul_f32 v[50:51], v[50:51], v[244:245] op_sel_hi:[1,0]
  v_pk_mul_f32 v[68:69], v[68:69], v[244:245] op_sel_hi:[1,0]
  v_pk_mul_f32 v[70:71], v[70:71], v[244:245] op_sel_hi:[1,0]
  v_pk_mul_f32 v[52:53], v[52:53], v[246:247] op_sel_hi:[1,0]
  v_pk_mul_f32 v[54:55], v[54:55], v[246:247] op_sel_hi:[1,0]
  v_pk_mul_f32 v[72:73], v[72:73], v[246:247] op_sel_hi:[1,0]
  v_pk_mul_f32 v[74:75], v[74:75], v[246:247] op_sel_hi:[1,0]
  v_pk_mul_f32 v[56:57], v[56:57], v[248:249] op_sel_hi:[1,0]
  v_pk_mul_f32 v[58:59], v[58:59], v[248:249] op_sel_hi:[1,0]
  v_pk_mul_f32 v[76:77], v[76:77], v[248:249] op_sel_hi:[1,0]
  v_pk_mul_f32 v[78:79], v[78:79], v[248:249] op_sel_hi:[1,0]
  v_cvt_pk_bf16_f32 v180, v40, v41
  v_cvt_pk_bf16_f32 v181, v42, v43
  v_cvt_pk_bf16_f32 v182, v60, v61
  v_cvt_pk_bf16_f32 v183, v62, v63
  v_cvt_pk_bf16_f32 v184, v44, v45
  v_cvt_pk_bf16_f32 v185, v46, v47
  v_cvt_pk_bf16_f32 v186, v64, v65
  v_cvt_pk_bf16_f32 v187, v66, v67
  v_cvt_pk_bf16_f32 v188, v48, v49
  v_cvt_pk_bf16_f32 v189, v50, v51
  v_cvt_pk_bf16_f32 v190, v68, v69
  v_cvt_pk_bf16_f32 v191, v70, v71
  v_cvt_pk_bf16_f32 v192, v52, v53
  v_cvt_pk_bf16_f32 v193, v54, v55
  v_cvt_pk_bf16_f32 v194, v72, v73
  v_cvt_pk_bf16_f32 v195, v74, v75
  v_cvt_pk_bf16_f32 v196, v56, v57
  v_cvt_pk_bf16_f32 v197, v58, v59
  v_cvt_pk_bf16_f32 v198, v76, v77
  v_cvt_pk_bf16_f32 v199, v78, v79
  s_cmp_eq_u32 s16, 7
  s_cbranch_scc1 L_o_hold_29
  ds_write_b128 v252, v[180:183] offset:1024
  ds_write_b128 v252, v[184:187] offset:5120
  ds_write_b128 v252, v[188:191] offset:9216
  ds_write_b128 v252, v[192:195] offset:13312
  ds_write_b128 v252, v[196:199] offset:17408
L_o_hold_29:
  v_lshrrev_b32 v253, 3, v255
  v_and_b32 v254, 6, v253
  v_mul_u32_u24 v253, 896, v253
  v_and_b32 v250, 7, v255
  v_xor_b32 v250, v250, v254
  v_lshl_add_u32 v250, v250, 4, v253
  s_mul_i32 s44, s49, 458752
  s_mul_i32 s46, s79, 7168
  s_add_u32 s44, s44, s46
  s_lshl_b32 s45, s79, 10
  s_waitcnt lgkmcnt(0)
  s_barrier
  s_add_u32 m0, s45, 0
  s_add_u32 s46, s44, 86016
  buffer_load_dwordx4 v250, s[8:11], s46 offen lds
  s_add_u32 m0, s45, 4096
  s_add_u32 s46, s44, 86144
  buffer_load_dwordx4 v250, s[8:11], s46 offen lds
  s_add_u32 m0, s45, 8192
  s_add_u32 s46, s44, 86272
  buffer_load_dwordx4 v250, s[8:11], s46 offen lds
  s_add_u32 m0, s45, 12288
  s_add_u32 s46, s44, 86400
  buffer_load_dwordx4 v250, s[8:11], s46 offen lds
  s_add_u32 m0, s45, 16384
  s_add_u32 s46, s44, 86528
  buffer_load_dwordx4 v250, s[8:11], s46 offen lds
  s_add_u32 m0, s45, 20480
  s_add_u32 s46, s44, 86656
  buffer_load_dwordx4 v250, s[8:11], s46 offen lds
  s_add_u32 m0, s45, 24576
  s_add_u32 s46, s44, 86784
  buffer_load_dwordx4 v250, s[8:11], s46 offen lds
  v_pk_mul_f32 v[80:81], v[80:81], v[240:241] op_sel_hi:[1,0]
  v_pk_mul_f32 v[82:83], v[82:83], v[240:241] op_sel_hi:[1,0]
  v_pk_mul_f32 v[100:101], v[100:101], v[240:241] op_sel_hi:[1,0]
  v_pk_mul_f32 v[102:103], v[102:103], v[240:241] op_sel_hi:[1,0]
  v_pk_mul_f32 v[84:85], v[84:85], v[242:243] op_sel_hi:[1,0]
  v_pk_mul_f32 v[86:87], v[86:87], v[242:243] op_sel_hi:[1,0]
  v_pk_mul_f32 v[104:105], v[104:105], v[242:243] op_sel_hi:[1,0]
  v_pk_mul_f32 v[106:107], v[106:107], v[242:243] op_sel_hi:[1,0]
  v_pk_mul_f32 v[88:89], v[88:89], v[244:245] op_sel_hi:[1,0]
  v_pk_mul_f32 v[90:91], v[90:91], v[244:245] op_sel_hi:[1,0]
  v_pk_mul_f32 v[108:109], v[108:109], v[244:245] op_sel_hi:[1,0]
  v_pk_mul_f32 v[110:111], v[110:111], v[244:245] op_sel_hi:[1,0]
  v_pk_mul_f32 v[92:93], v[92:93], v[246:247] op_sel_hi:[1,0]
  v_pk_mul_f32 v[94:95], v[94:95], v[246:247] op_sel_hi:[1,0]
  v_pk_mul_f32 v[112:113], v[112:113], v[246:247] op_sel_hi:[1,0]
  v_pk_mul_f32 v[114:115], v[114:115], v[246:247] op_sel_hi:[1,0]
  v_pk_mul_f32 v[96:97], v[96:97], v[248:249] op_sel_hi:[1,0]
  v_pk_mul_f32 v[98:99], v[98:99], v[248:249] op_sel_hi:[1,0]
  v_pk_mul_f32 v[116:117], v[116:117], v[248:249] op_sel_hi:[1,0]
  v_pk_mul_f32 v[118:119], v[118:119], v[248:249] op_sel_hi:[1,0]
  v_cvt_pk_bf16_f32 v200, v80, v81
  v_cvt_pk_bf16_f32 v201, v82, v83
  v_cvt_pk_bf16_f32 v202, v100, v101
  v_cvt_pk_bf16_f32 v203, v102, v103
  v_cvt_pk_bf16_f32 v204, v84, v85
  v_cvt_pk_bf16_f32 v205, v86, v87
  v_cvt_pk_bf16_f32 v206, v104, v105
  v_cvt_pk_bf16_f32 v207, v106, v107
  v_cvt_pk_bf16_f32 v208, v88, v89
  v_cvt_pk_bf16_f32 v209, v90, v91
  v_cvt_pk_bf16_f32 v210, v108, v109
  v_cvt_pk_bf16_f32 v211, v110, v111
  v_cvt_pk_bf16_f32 v212, v92, v93
  v_cvt_pk_bf16_f32 v213, v94, v95
  v_cvt_pk_bf16_f32 v214, v112, v113
  v_cvt_pk_bf16_f32 v215, v114, v115
  v_cvt_pk_bf16_f32 v216, v96, v97
  v_cvt_pk_bf16_f32 v217, v98, v99
  v_cvt_pk_bf16_f32 v218, v116, v117
  v_cvt_pk_bf16_f32 v219, v118, v119
  s_cmp_eq_u32 s16, 7
  s_cbranch_scc1 L_o_hold_30
  ds_write_b128 v252, v[200:203] offset:2048
  ds_write_b128 v252, v[204:207] offset:6144
  ds_write_b128 v252, v[208:211] offset:10240
  ds_write_b128 v252, v[212:215] offset:14336
  ds_write_b128 v252, v[216:219] offset:18432
L_o_hold_30:
  s_waitcnt lgkmcnt(0)
  s_barrier
  s_add_u32 m0, s45, 28672
  s_add_u32 s46, s44, 114688
  buffer_load_dwordx4 v250, s[8:11], s46 offen lds
  s_add_u32 m0, s45, 32768
  s_add_u32 s46, s44, 114816
  buffer_load_dwordx4 v250, s[8:11], s46 offen lds
  s_add_u32 m0, s45, 36864
  s_add_u32 s46, s44, 114944
  buffer_load_dwordx4 v250, s[8:11], s46 offen lds
  s_add_u32 m0, s45, 40960
  s_add_u32 s46, s44, 115072
  buffer_load_dwordx4 v250, s[8:11], s46 offen lds
  s_add_u32 m0, s45, 45056
  s_add_u32 s46, s44, 115200
  buffer_load_dwordx4 v250, s[8:11], s46 offen lds
  s_add_u32 m0, s45, 49152
  s_add_u32 s46, s44, 115328
  buffer_load_dwordx4 v250, s[8:11], s46 offen lds
  s_add_u32 m0, s45, 53248
  s_add_u32 s46, s44, 115456
  buffer_load_dwordx4 v250, s[8:11], s46 offen lds
  v_pk_mul_f32 v[120:121], v[120:121], v[240:241] op_sel_hi:[1,0]
  v_pk_mul_f32 v[122:123], v[122:123], v[240:241] op_sel_hi:[1,0]
  v_pk_mul_f32 v[140:141], v[140:141], v[240:241] op_sel_hi:[1,0]
  v_pk_mul_f32 v[142:143], v[142:143], v[240:241] op_sel_hi:[1,0]
  v_pk_mul_f32 v[124:125], v[124:125], v[242:243] op_sel_hi:[1,0]
  v_pk_mul_f32 v[126:127], v[126:127], v[242:243] op_sel_hi:[1,0]
  v_pk_mul_f32 v[144:145], v[144:145], v[242:243] op_sel_hi:[1,0]
  v_pk_mul_f32 v[146:147], v[146:147], v[242:243] op_sel_hi:[1,0]
  v_pk_mul_f32 v[128:129], v[128:129], v[244:245] op_sel_hi:[1,0]
  v_pk_mul_f32 v[130:131], v[130:131], v[244:245] op_sel_hi:[1,0]
  v_pk_mul_f32 v[148:149], v[148:149], v[244:245] op_sel_hi:[1,0]
  v_pk_mul_f32 v[150:151], v[150:151], v[244:245] op_sel_hi:[1,0]
  v_pk_mul_f32 v[132:133], v[132:133], v[246:247] op_sel_hi:[1,0]
  v_pk_mul_f32 v[134:135], v[134:135], v[246:247] op_sel_hi:[1,0]
  v_pk_mul_f32 v[152:153], v[152:153], v[246:247] op_sel_hi:[1,0]
  v_pk_mul_f32 v[154:155], v[154:155], v[246:247] op_sel_hi:[1,0]
  v_pk_mul_f32 v[136:137], v[136:137], v[248:249] op_sel_hi:[1,0]
  v_pk_mul_f32 v[138:139], v[138:139], v[248:249] op_sel_hi:[1,0]
  v_pk_mul_f32 v[156:157], v[156:157], v[248:249] op_sel_hi:[1,0]
  v_pk_mul_f32 v[158:159], v[158:159], v[248:249] op_sel_hi:[1,0]
  v_cvt_pk_bf16_f32 v220, v120, v121
  v_cvt_pk_bf16_f32 v221, v122, v123
  v_cvt_pk_bf16_f32 v222, v140, v141
  v_cvt_pk_bf16_f32 v223, v142, v143
  v_cvt_pk_bf16_f32 v224, v124, v125
  v_cvt_pk_bf16_f32 v225, v126, v127
  v_cvt_pk_bf16_f32 v226, v144, v145
  v_cvt_pk_bf16_f32 v227, v146, v147
  v_cvt_pk_bf16_f32 v228, v128, v129
  v_cvt_pk_bf16_f32 v229, v130, v131
  v_cvt_pk_bf16_f32 v230, v148, v149
  v_cvt_pk_bf16_f32 v231, v150, v151
  v_cvt_pk_bf16_f32 v232, v132, v133
  v_cvt_pk_bf16_f32 v233, v134, v135
  v_cvt_pk_bf16_f32 v234, v152, v153
  v_cvt_pk_bf16_f32 v235, v154, v155
  v_cvt_pk_bf16_f32 v236, v136, v137
  v_cvt_pk_bf16_f32 v237, v138, v139
  v_cvt_pk_bf16_f32 v238, v156, v157
  v_cvt_pk_bf16_f32 v239, v158, v159
  s_cmp_eq_u32 s16, 7
  s_cbranch_scc1 L_o_hold_31
  ds_write_b128 v252, v[220:223] offset:3072
  ds_write_b128 v252, v[224:227] offset:7168
  ds_write_b128 v252, v[228:231] offset:11264
  ds_write_b128 v252, v[232:235] offset:15360
  ds_write_b128 v252, v[236:239] offset:19456
L_o_hold_31:
  s_waitcnt lgkmcnt(0)
  s_waitcnt vmcnt(7)
  s_barrier
  s_add_u32 m0, s45, 57344
  s_add_u32 s46, s44, 143360
  buffer_load_dwordx4 v250, s[8:11], s46 offen lds
  s_add_u32 m0, s45, 61440
  s_add_u32 s46, s44, 143488
  buffer_load_dwordx4 v250, s[8:11], s46 offen lds
  s_add_u32 m0, s45, 65536
  s_add_u32 s46, s44, 143616
  buffer_load_dwordx4 v250, s[8:11], s46 offen lds
  s_add_u32 m0, s45, 69632
  s_add_u32 s46, s44, 143744
  buffer_load_dwordx4 v250, s[8:11], s46 offen lds
  s_add_u32 m0, s45, 73728
  s_add_u32 s46, s44, 143872
  buffer_load_dwordx4 v250, s[8:11], s46 offen lds
  s_add_u32 m0, s45, 77824
  s_add_u32 s46, s44, 144000
  buffer_load_dwordx4 v250, s[8:11], s46 offen lds
  s_add_u32 m0, s45, 81920
  s_add_u32 s46, s44, 144128
  buffer_load_dwordx4 v250, s[8:11], s46 offen lds
  s_waitcnt vmcnt(7)
  s_barrier
  s_add_u32 m0, s45, 0
  s_add_u32 s46, s44, 172032
  buffer_load_dwordx4 v250, s[8:11], s46 offen lds
  s_add_u32 m0, s45, 4096
  s_add_u32 s46, s44, 172160
  buffer_load_dwordx4 v250, s[8:11], s46 offen lds
  s_add_u32 m0, s45, 8192
  s_add_u32 s46, s44, 172288
  buffer_load_dwordx4 v250, s[8:11], s46 offen lds
  s_add_u32 m0, s45, 12288
  s_add_u32 s46, s44, 172416
  buffer_load_dwordx4 v250, s[8:11], s46 offen lds
  s_add_u32 m0, s45, 16384
  s_add_u32 s46, s44, 172544
  buffer_load_dwordx4 v250, s[8:11], s46 offen lds
  s_add_u32 m0, s45, 20480
  s_add_u32 s46, s44, 172672
  buffer_load_dwordx4 v250, s[8:11], s46 offen lds
  s_add_u32 m0, s45, 24576
  s_add_u32 s46, s44, 172800
  buffer_load_dwordx4 v250, s[8:11], s46 offen lds
  s_cmp_lg_u32 s16, 7
  s_cbranch_scc1 L_o_w7_32
  ds_write_b128 v252, v[160:163] offset:0
  ds_write_b128 v252, v[164:167] offset:4096
  ds_write_b128 v252, v[168:171] offset:8192
  ds_write_b128 v252, v[172:175] offset:12288
  ds_write_b128 v252, v[176:179] offset:16384
  ds_write_b128 v252, v[180:183] offset:1024
  ds_write_b128 v252, v[184:187] offset:5120
  ds_write_b128 v252, v[188:191] offset:9216
  ds_write_b128 v252, v[192:195] offset:13312
  ds_write_b128 v252, v[196:199] offset:17408
  s_waitcnt lgkmcnt(4)
  ds_write_b128 v252, v[200:203] offset:2048
  ds_write_b128 v252, v[204:207] offset:6144
  ds_write_b128 v252, v[208:211] offset:10240
  ds_write_b128 v252, v[212:215] offset:14336
  ds_write_b128 v252, v[216:219] offset:18432
  ds_write_b128 v252, v[220:223] offset:3072
  ds_write_b128 v252, v[224:227] offset:7168
  ds_write_b128 v252, v[228:231] offset:11264
  ds_write_b128 v252, v[232:235] offset:15360
  ds_write_b128 v252, v[236:239] offset:19456
L_o_w7_32:
  s_waitcnt vmcnt(7)
  s_barrier
  s_add_u32 m0, s45, 28672
  s_add_u32 s46, s44, 200704
  buffer_load_dwordx4 v250, s[8:11], s46 offen lds
  s_add_u32 m0, s45, 32768
  s_add_u32 s46, s44, 200832
  buffer_load_dwordx4 v250, s[8:11], s46 offen lds
  s_add_u32 m0, s45, 36864
  s_add_u32 s46, s44, 200960
  buffer_load_dwordx4 v250, s[8:11], s46 offen lds
  s_add_u32 m0, s45, 40960
  s_add_u32 s46, s44, 201088
  buffer_load_dwordx4 v250, s[8:11], s46 offen lds
  s_add_u32 m0, s45, 45056
  s_add_u32 s46, s44, 201216
  buffer_load_dwordx4 v250, s[8:11], s46 offen lds
  s_add_u32 m0, s45, 49152
  s_add_u32 s46, s44, 201344
  buffer_load_dwordx4 v250, s[8:11], s46 offen lds
  s_add_u32 m0, s45, 53248
  s_add_u32 s46, s44, 201472
  buffer_load_dwordx4 v250, s[8:11], s46 offen lds
  s_waitcnt vmcnt(7)
  s_barrier
  s_add_u32 m0, s45, 57344
  s_add_u32 s46, s44, 229376
  buffer_load_dwordx4 v250, s[8:11], s46 offen lds
  s_add_u32 m0, s45, 61440
  s_add_u32 s46, s44, 229504
  buffer_load_dwordx4 v250, s[8:11], s46 offen lds
  s_add_u32 m0, s45, 65536
  s_add_u32 s46, s44, 229632
  buffer_load_dwordx4 v250, s[8:11], s46 offen lds
  s_add_u32 m0, s45, 69632
  s_add_u32 s46, s44, 229760
  buffer_load_dwordx4 v250, s[8:11], s46 offen lds
  s_add_u32 m0, s45, 73728
  s_add_u32 s46, s44, 229888
  buffer_load_dwordx4 v250, s[8:11], s46 offen lds
  s_add_u32 m0, s45, 77824
  s_add_u32 s46, s44, 230016
  buffer_load_dwordx4 v250, s[8:11], s46 offen lds
  s_add_u32 m0, s45, 81920
  s_add_u32 s46, s44, 230144
  buffer_load_dwordx4 v250, s[8:11], s46 offen lds
  s_waitcnt vmcnt(7)
  s_barrier
  s_add_u32 m0, s45, 0
  s_add_u32 s46, s44, 258048
  buffer_load_dwordx4 v250, s[8:11], s46 offen lds
  s_add_u32 m0, s45, 4096
  s_add_u32 s46, s44, 258176
  buffer_load_dwordx4 v250, s[8:11], s46 offen lds
  s_add_u32 m0, s45, 8192
  s_add_u32 s46, s44, 258304
  buffer_load_dwordx4 v250, s[8:11], s46 offen lds
  s_add_u32 m0, s45, 12288
  s_add_u32 s46, s44, 258432
  buffer_load_dwordx4 v250, s[8:11], s46 offen lds
  s_add_u32 m0, s45, 16384
  s_add_u32 s46, s44, 258560
  buffer_load_dwordx4 v250, s[8:11], s46 offen lds
  s_add_u32 m0, s45, 20480
  s_add_u32 s46, s44, 258688
  buffer_load_dwordx4 v250, s[8:11], s46 offen lds
  s_add_u32 m0, s45, 24576
  s_add_u32 s46, s44, 258816
  buffer_load_dwordx4 v250, s[8:11], s46 offen lds
  s_waitcnt vmcnt(7)
  s_barrier
  s_add_u32 m0, s45, 28672
  s_add_u32 s46, s44, 286720
  buffer_load_dwordx4 v250, s[8:11], s46 offen lds
  s_add_u32 m0, s45, 32768
  s_add_u32 s46, s44, 286848
  buffer_load_dwordx4 v250, s[8:11], s46 offen lds
  s_add_u32 m0, s45, 36864
  s_add_u32 s46, s44, 286976
  buffer_load_dwordx4 v250, s[8:11], s46 offen lds
  s_add_u32 m0, s45, 40960
  s_add_u32 s46, s44, 287104
  buffer_load_dwordx4 v250, s[8:11], s46 offen lds
  s_add_u32 m0, s45, 45056
  s_add_u32 s46, s44, 287232
  buffer_load_dwordx4 v250, s[8:11], s46 offen lds
  s_add_u32 m0, s45, 49152
  s_add_u32 s46, s44, 287360
  buffer_load_dwordx4 v250, s[8:11], s46 offen lds
  s_add_u32 m0, s45, 53248
  s_add_u32 s46, s44, 287488
  buffer_load_dwordx4 v250, s[8:11], s46 offen lds
  s_waitcnt vmcnt(7)
  s_barrier
  s_add_u32 m0, s45, 57344
  s_add_u32 s46, s44, 315392
  buffer_load_dwordx4 v250, s[8:11], s46 offen lds
  s_add_u32 m0, s45, 61440
  s_add_u32 s46, s44, 315520
  buffer_load_dwordx4 v250, s[8:11], s46 offen lds
  s_add_u32 m0, s45, 65536
  s_add_u32 s46, s44, 315648
  buffer_load_dwordx4 v250, s[8:11], s46 offen lds
  s_add_u32 m0, s45, 69632
  s_add_u32 s46, s44, 315776
  buffer_load_dwordx4 v250, s[8:11], s46 offen lds
  s_add_u32 m0, s45, 73728
  s_add_u32 s46, s44, 315904
  buffer_load_dwordx4 v250, s[8:11], s46 offen lds
  s_add_u32 m0, s45, 77824
  s_add_u32 s46, s44, 316032
  buffer_load_dwordx4 v250, s[8:11], s46 offen lds
  s_add_u32 m0, s45, 81920
  s_add_u32 s46, s44, 316160
  buffer_load_dwordx4 v250, s[8:11], s46 offen lds
  s_waitcnt lgkmcnt(0)
  s_waitcnt vmcnt(7)
  s_barrier
  s_add_u32 m0, s45, 0
  s_add_u32 s46, s44, 344064
  buffer_load_dwordx4 v250, s[8:11], s46 offen lds
  s_add_u32 m0, s45, 4096
  s_add_u32 s46, s44, 344192
  buffer_load_dwordx4 v250, s[8:11], s46 offen lds
  s_add_u32 m0, s45, 8192
  s_add_u32 s46, s44, 344320
  buffer_load_dwordx4 v250, s[8:11], s46 offen lds
  s_add_u32 m0, s45, 12288
  s_add_u32 s46, s44, 344448
  buffer_load_dwordx4 v250, s[8:11], s46 offen lds
  s_add_u32 m0, s45, 16384
  s_add_u32 s46, s44, 344576
  buffer_load_dwordx4 v250, s[8:11], s46 offen lds
  s_add_u32 m0, s45, 20480
  s_add_u32 s46, s44, 344704
  buffer_load_dwordx4 v250, s[8:11], s46 offen lds
  s_add_u32 m0, s45, 24576
  s_add_u32 s46, s44, 344832
  buffer_load_dwordx4 v250, s[8:11], s46 offen lds
  s_waitcnt vmcnt(7)
  s_barrier
  s_add_u32 m0, s45, 28672
  s_add_u32 s46, s44, 372736
  buffer_load_dwordx4 v250, s[8:11], s46 offen lds
  s_add_u32 m0, s45, 32768
  s_add_u32 s46, s44, 372864
  buffer_load_dwordx4 v250, s[8:11], s46 offen lds
  s_add_u32 m0, s45, 36864
  s_add_u32 s46, s44, 372992
  buffer_load_dwordx4 v250, s[8:11], s46 offen lds
  s_add_u32 m0, s45, 40960
  s_add_u32 s46, s44, 373120
  buffer_load_dwordx4 v250, s[8:11], s46 offen lds
  s_add_u32 m0, s45, 45056
  s_add_u32 s46, s44, 373248
  buffer_load_dwordx4 v250, s[8:11], s46 offen lds
  s_add_u32 m0, s45, 49152
  s_add_u32 s46, s44, 373376
  buffer_load_dwordx4 v250, s[8:11], s46 offen lds
  s_add_u32 m0, s45, 53248
  s_add_u32 s46, s44, 373504
  buffer_load_dwordx4 v250, s[8:11], s46 offen lds
  s_waitcnt vmcnt(7)
  s_barrier
  s_add_u32 m0, s45, 57344
  s_add_u32 s46, s44, 401408
  buffer_load_dwordx4 v250, s[8:11], s46 offen lds
  s_add_u32 m0, s45, 61440
  s_add_u32 s46, s44, 401536
  buffer_load_dwordx4 v250, s[8:11], s46 offen lds
  s_add_u32 m0, s45, 65536
  s_add_u32 s46, s44, 401664
  buffer_load_dwordx4 v250, s[8:11], s46 offen lds
  s_add_u32 m0, s45, 69632
  s_add_u32 s46, s44, 401792
  buffer_load_dwordx4 v250, s[8:11], s46 offen lds
  s_add_u32 m0, s45, 73728
  s_add_u32 s46, s44, 401920
  buffer_load_dwordx4 v250, s[8:11], s46 offen lds
  s_add_u32 m0, s45, 77824
  s_add_u32 s46, s44, 402048
  buffer_load_dwordx4 v250, s[8:11], s46 offen lds
  s_add_u32 m0, s45, 81920
  s_add_u32 s46, s44, 402176
  buffer_load_dwordx4 v250, s[8:11], s46 offen lds
  s_waitcnt vmcnt(7)
  s_barrier
  s_add_u32 m0, s45, 0
  s_add_u32 s46, s44, 430080
  buffer_load_dwordx4 v250, s[8:11], s46 offen lds
  s_add_u32 m0, s45, 4096
  s_add_u32 s46, s44, 430208
  buffer_load_dwordx4 v250, s[8:11], s46 offen lds
  s_add_u32 m0, s45, 8192
  s_add_u32 s46, s44, 430336
  buffer_load_dwordx4 v250, s[8:11], s46 offen lds
  s_add_u32 m0, s45, 12288
  s_add_u32 s46, s44, 430464
  buffer_load_dwordx4 v250, s[8:11], s46 offen lds
  s_add_u32 m0, s45, 16384
  s_add_u32 s46, s44, 430592
  buffer_load_dwordx4 v250, s[8:11], s46 offen lds
  s_add_u32 m0, s45, 20480
  s_add_u32 s46, s44, 430720
  buffer_load_dwordx4 v250, s[8:11], s46 offen lds
  s_add_u32 m0, s45, 24576
  s_add_u32 s46, s44, 430848
  buffer_load_dwordx4 v250, s[8:11], s46 offen lds
  s_waitcnt vmcnt(7)
  s_barrier
  s_waitcnt vmcnt(0)
  s_barrier
  s_barrier
L_attn_kernel_done:
  s_endpgm
L_slow_qk_B:
  s_waitcnt lgkmcnt(0)
  v_max3_f32 v228, v160, v161, v162
  v_max_f32 v228, v228, v163
  v_max3_f32 v229, v164, v165, v166
  v_max_f32 v229, v229, v167
  v_max3_f32 v230, v168, v169, v170
  v_max_f32 v230, v230, v171
  v_max3_f32 v231, v172, v173, v174
  v_max_f32 v231, v231, v175
  v_max3_f32 v232, v176, v177, v178
  v_max_f32 v232, v232, v179
  v_mov_b32 v234, v228
  v_mov_b32 v235, v229
  v_mov_b32 v236, v230
  v_mov_b32 v237, v231
  v_mov_b32 v238, v232
  s_nop 1
  v_permlane32_swap_b32 v228, v234
  v_permlane32_swap_b32 v229, v235
  v_permlane32_swap_b32 v230, v236
  v_permlane32_swap_b32 v231, v237
  v_permlane32_swap_b32 v232, v238
  s_nop 0
  v_max_f32 v228, v228, v234
  v_max_f32 v229, v229, v235
  v_max_f32 v230, v230, v236
  v_max_f32 v231, v231, v237
  v_max_f32 v232, v232, v238
  v_mov_b32 v234, v228
  v_mov_b32 v235, v229
  v_mov_b32 v236, v230
  v_mov_b32 v237, v231
  v_mov_b32 v238, v232
  s_nop 1
  v_permlane16_swap_b32 v228, v234
  v_permlane16_swap_b32 v229, v235
  v_permlane16_swap_b32 v230, v236
  v_permlane16_swap_b32 v231, v237
  v_permlane16_swap_b32 v232, v238
  s_nop 0
  v_max_f32 v228, v228, v234
  v_max_f32 v229, v229, v235
  v_max_f32 v230, v230, v236
  v_max_f32 v231, v231, v237
  v_max_f32 v232, v232, v238
  v_mbcnt_lo_u32_b32 v226, -1, 0
  v_mbcnt_hi_u32_b32 v226, -1, v226
  v_and_b32 v226, 15, v226
  v_lshlrev_b32 v226, 2, v226
  s_lshl_b32 s31, s17, 1
  s_add_u32 s21, s31, s18
  s_mul_i32 s21, s21, 320
  s_add_u32 s21, s21, 151616
  v_add_u32 v227, s21, v226
  ds_write_b32 v227, v228 offset:0
  ds_write_b32 v227, v229 offset:64
  ds_write_b32 v227, v230 offset:128
  ds_write_b32 v227, v231 offset:192
  ds_write_b32 v227, v232 offset:256
  s_waitcnt lgkmcnt(0)
  s_barrier
  s_xor_b32 s21, s18, 1
  s_add_u32 s21, s31, s21
  s_mul_i32 s21, s21, 320
  s_add_u32 s21, s21, 151616
  v_add_u32 v227, s21, v226
  ds_read_b32 v234, v227 offset:0
  ds_read_b32 v235, v227 offset:64
  ds_read_b32 v236, v227 offset:128
  ds_read_b32 v237, v227 offset:192
  ds_read_b32 v238, v227 offset:256
  s_mul_i32 s21, s17, 320
  s_add_u32 s21, s21, 152896
  v_add_u32 v227, s21, v226
  s_waitcnt lgkmcnt(0)
  v_max3_f32 v228, v228, v234, s26
  v_max3_f32 v229, v229, v235, s26
  v_max3_f32 v230, v230, v236, s26
  v_max3_f32 v231, v231, v237, s26
  v_max3_f32 v232, v232, v238, s26
  v_add_f32 v212, v212, v228
  v_sub_f32 v160, v160, v228
  v_sub_f32 v161, v161, v228
  v_sub_f32 v162, v162, v228
  v_sub_f32 v163, v163, v228
  v_max_f32 v234, 0, v228
  v_sub_f32 v234, 0, v234
  v_add_f32 v213, v213, v229
  v_sub_f32 v164, v164, v229
  v_sub_f32 v165, v165, v229
  v_sub_f32 v166, v166, v229
  v_sub_f32 v167, v167, v229
  v_max_f32 v235, 0, v229
  v_sub_f32 v235, 0, v235
  v_add_f32 v214, v214, v230
  v_sub_f32 v168, v168, v230
  v_sub_f32 v169, v169, v230
  v_sub_f32 v170, v170, v230
  v_sub_f32 v171, v171, v230
  v_max_f32 v236, 0, v230
  v_sub_f32 v236, 0, v236
  v_add_f32 v215, v215, v231
  v_sub_f32 v172, v172, v231
  v_sub_f32 v173, v173, v231
  v_sub_f32 v174, v174, v231
  v_sub_f32 v175, v175, v231
  v_max_f32 v237, 0, v231
  v_sub_f32 v237, 0, v237
  v_add_f32 v216, v216, v232
  v_sub_f32 v176, v176, v232
  v_sub_f32 v177, v177, v232
  v_sub_f32 v178, v178, v232
  v_sub_f32 v179, v179, v232
  v_max_f32 v238, 0, v232
  v_sub_f32 v238, 0, v238
  v_exp_f32 v234, v234
  v_exp_f32 v235, v235
  v_exp_f32 v236, v236
  v_exp_f32 v237, v237
  v_exp_f32 v238, v238
  s_nop 0
  ds_write_b32 v227, v234 offset:0
  ds_write_b32 v227, v235 offset:64
  ds_write_b32 v227, v236 offset:128
  ds_write_b32 v227, v237 offset:192
  ds_write_b32 v227, v238 offset:256
  s_mov_b32 s26, 0
  v_add_u32 v226, s24, v224
  s_waitcnt lgkmcnt(0)
  v_exp_f32 v230, v160
  v_exp_f32 v231, v161
  v_exp_f32 v232, v162
  v_exp_f32 v233, v163
  s_nop 0
  v_cvt_pk_bf16_f32 v234, v230, v231
  v_cvt_pk_bf16_f32 v235, v232, v233
  ds_write_b64 v226, v[234:235] offset:0
  v_exp_f32 v236, v164
  v_exp_f32 v237, v165
  v_exp_f32 v238, v166
  v_exp_f32 v239, v167
  s_nop 0
  v_cvt_pk_bf16_f32 v240, v236, v237
  v_cvt_pk_bf16_f32 v241, v238, v239
  ds_write_b64 v226, v[240:241] offset:1024
  v_exp_f32 v230, v168
  v_exp_f32 v231, v169
  v_exp_f32 v232, v170
  v_exp_f32 v233, v171
  s_nop 0
  v_cvt_pk_bf16_f32 v234, v230, v231
  v_cvt_pk_bf16_f32 v235, v232, v233
  ds_write_b64 v226, v[234:235] offset:2048
  v_exp_f32 v236, v172
  v_exp_f32 v237, v173
  v_exp_f32 v238, v174
  v_exp_f32 v239, v175
  s_nop 0
  v_cvt_pk_bf16_f32 v240, v236, v237
  v_cvt_pk_bf16_f32 v241, v238, v239
  ds_write_b64 v226, v[240:241] offset:3072
  v_exp_f32 v230, v176
  v_exp_f32 v231, v177
  v_exp_f32 v232, v178
  v_exp_f32 v233, v179
  s_nop 0
  v_cvt_pk_bf16_f32 v234, v230, v231
  v_cvt_pk_bf16_f32 v235, v232, v233
  ds_write_b64 v226, v[234:235] offset:4096
  s_waitcnt lgkmcnt(0)
  s_barrier
  s_cmp_eq_u32 s25, 0
  s_cbranch_scc1 L_back_5
  s_cmp_eq_u32 s25, 1
  s_cbranch_scc1 L_back_6
  s_cmp_eq_u32 s25, 2
  s_cbranch_scc1 L_back_7
  s_cmp_eq_u32 s25, 3
  s_cbranch_scc1 L_back_8
  s_cmp_eq_u32 s25, 4
  s_cbranch_scc1 L_back_9
  s_branch L_back_10
L_slow_pv_B:
  s_waitcnt lgkmcnt(0)
  s_barrier
  s_barrier
  v_mbcnt_lo_u32_b32 v252, -1, 0
  v_mbcnt_hi_u32_b32 v252, -1, v252
  v_and_b32 v252, 15, v252
  v_lshlrev_b32 v252, 2, v252
  s_mul_i32 s21, s17, 320
  s_add_u32 s21, s21, 152896
  v_add_u32 v252, s21, v252
  ds_read_b32 v248, v252 offset:0
  ds_read_b32 v249, v252 offset:64
  ds_read_b32 v250, v252 offset:128
  ds_read_b32 v251, v252 offset:192
  ds_read_b32 v253, v252 offset:256
  v_add_u32 v254, s24, v246
  ds_read_b128 v[212:215], v254 offset:0
  ds_read_b128 v[216:219], v254 offset:1024
  ds_read_b128 v[220:223], v254 offset:2048
  ds_read_b128 v[224:227], v254 offset:3072
  ds_read_b128 v[228:231], v254 offset:4096
  s_waitcnt lgkmcnt(0)
  v_mul_f32 v0, v0, v248
  v_mul_f32 v1, v1, v248
  v_mul_f32 v2, v2, v248
  v_mul_f32 v3, v3, v248
  v_mul_f32 v4, v4, v249
  v_mul_f32 v5, v5, v249
  v_mul_f32 v6, v6, v249
  v_mul_f32 v7, v7, v249
  v_mul_f32 v8, v8, v250
  v_mul_f32 v9, v9, v250
  v_mul_f32 v10, v10, v250
  v_mul_f32 v11, v11, v250
  v_mul_f32 v12, v12, v251
  v_mul_f32 v13, v13, v251
  v_mul_f32 v14, v14, v251
  v_mul_f32 v15, v15, v251
  v_mul_f32 v16, v16, v253
  v_mul_f32 v17, v17, v253
  v_mul_f32 v18, v18, v253
  v_mul_f32 v19, v19, v253
  v_mul_f32 v20, v20, v248
  v_mul_f32 v21, v21, v248
  v_mul_f32 v22, v22, v248
  v_mul_f32 v23, v23, v248
  v_mul_f32 v24, v24, v249
  v_mul_f32 v25, v25, v249
  v_mul_f32 v26, v26, v249
  v_mul_f32 v27, v27, v249
  v_mul_f32 v28, v28, v250
  v_mul_f32 v29, v29, v250
  v_mul_f32 v30, v30, v250
  v_mul_f32 v31, v31, v250
  v_mul_f32 v32, v32, v251
  v_mul_f32 v33, v33, v251
  v_mul_f32 v34, v34, v251
  v_mul_f32 v35, v35, v251
  v_mul_f32 v36, v36, v253
  v_mul_f32 v37, v37, v253
  v_mul_f32 v38, v38, v253
  v_mul_f32 v39, v39, v253
  v_mul_f32 v40, v40, v248
  v_mul_f32 v41, v41, v248
  v_mul_f32 v42, v42, v248
  v_mul_f32 v43, v43, v248
  v_mul_f32 v44, v44, v249
  v_mul_f32 v45, v45, v249
  v_mul_f32 v46, v46, v249
  v_mul_f32 v47, v47, v249
  v_mul_f32 v48, v48, v250
  v_mul_f32 v49, v49, v250
  v_mul_f32 v50, v50, v250
  v_mul_f32 v51, v51, v250
  v_mul_f32 v52, v52, v251
  v_mul_f32 v53, v53, v251
  v_mul_f32 v54, v54, v251
  v_mul_f32 v55, v55, v251
  v_mul_f32 v56, v56, v253
  v_mul_f32 v57, v57, v253
  v_mul_f32 v58, v58, v253
  v_mul_f32 v59, v59, v253
  v_mul_f32 v60, v60, v248
  v_mul_f32 v61, v61, v248
  v_mul_f32 v62, v62, v248
  v_mul_f32 v63, v63, v248
  v_mul_f32 v64, v64, v249
  v_mul_f32 v65, v65, v249
  v_mul_f32 v66, v66, v249
  v_mul_f32 v67, v67, v249
  v_mul_f32 v68, v68, v250
  v_mul_f32 v69, v69, v250
  v_mul_f32 v70, v70, v250
  v_mul_f32 v71, v71, v250
  v_mul_f32 v72, v72, v251
  v_mul_f32 v73, v73, v251
  v_mul_f32 v74, v74, v251
  v_mul_f32 v75, v75, v251
  v_mul_f32 v76, v76, v253
  v_mul_f32 v77, v77, v253
  v_mul_f32 v78, v78, v253
  v_mul_f32 v79, v79, v253
  v_mul_f32 v80, v80, v248
  v_mul_f32 v81, v81, v248
  v_mul_f32 v82, v82, v248
  v_mul_f32 v83, v83, v248
  v_mul_f32 v84, v84, v249
  v_mul_f32 v85, v85, v249
  v_mul_f32 v86, v86, v249
  v_mul_f32 v87, v87, v249
  v_mul_f32 v88, v88, v250
  v_mul_f32 v89, v89, v250
  v_mul_f32 v90, v90, v250
  v_mul_f32 v91, v91, v250
  v_mul_f32 v92, v92, v251
  v_mul_f32 v93, v93, v251
  v_mul_f32 v94, v94, v251
  v_mul_f32 v95, v95, v251
  v_mul_f32 v96, v96, v253
  v_mul_f32 v97, v97, v253
  v_mul_f32 v98, v98, v253
  v_mul_f32 v99, v99, v253
  v_mul_f32 v100, v100, v248
  v_mul_f32 v101, v101, v248
  v_mul_f32 v102, v102, v248
  v_mul_f32 v103, v103, v248
  v_mul_f32 v104, v104, v249
  v_mul_f32 v105, v105, v249
  v_mul_f32 v106, v106, v249
  v_mul_f32 v107, v107, v249
  v_mul_f32 v108, v108, v250
  v_mul_f32 v109, v109, v250
  v_mul_f32 v110, v110, v250
  v_mul_f32 v111, v111, v250
  v_mul_f32 v112, v112, v251
  v_mul_f32 v113, v113, v251
  v_mul_f32 v114, v114, v251
  v_mul_f32 v115, v115, v251
  v_mul_f32 v116, v116, v253
  v_mul_f32 v117, v117, v253
  v_mul_f32 v118, v118, v253
  v_mul_f32 v119, v119, v253
  v_mul_f32 v120, v120, v248
  v_mul_f32 v121, v121, v248
  v_mul_f32 v122, v122, v248
  v_mul_f32 v123, v123, v248
  v_mul_f32 v124, v124, v249
  v_mul_f32 v125, v125, v249
  v_mul_f32 v126, v126, v249
  v_mul_f32 v127, v127, v249
  v_mul_f32 v128, v128, v250
  v_mul_f32 v129, v129, v250
  v_mul_f32 v130, v130, v250
  v_mul_f32 v131, v131, v250
  v_mul_f32 v132, v132, v251
  v_mul_f32 v133, v133, v251
  v_mul_f32 v134, v134, v251
  v_mul_f32 v135, v135, v251
  v_mul_f32 v136, v136, v253
  v_mul_f32 v137, v137, v253
  v_mul_f32 v138, v138, v253
  v_mul_f32 v139, v139, v253
  v_mul_f32 v140, v140, v248
  v_mul_f32 v141, v141, v248
  v_mul_f32 v142, v142, v248
  v_mul_f32 v143, v143, v248
  v_mul_f32 v144, v144, v249
  v_mul_f32 v145, v145, v249
  v_mul_f32 v146, v146, v249
  v_mul_f32 v147, v147, v249
  v_mul_f32 v148, v148, v250
  v_mul_f32 v149, v149, v250
  v_mul_f32 v150, v150, v250
  v_mul_f32 v151, v151, v250
  v_mul_f32 v152, v152, v251
  v_mul_f32 v153, v153, v251
  v_mul_f32 v154, v154, v251
  v_mul_f32 v155, v155, v251
  v_mul_f32 v156, v156, v253
  v_mul_f32 v157, v157, v253
  v_mul_f32 v158, v158, v253
  v_mul_f32 v159, v159, v253
  v_mul_f32 v160, v160, v248
  v_mul_f32 v161, v161, v248
  v_mul_f32 v162, v162, v248
  v_mul_f32 v163, v163, v248
  v_mul_f32 v164, v164, v249
  v_mul_f32 v165, v165, v249
  v_mul_f32 v166, v166, v249
  v_mul_f32 v167, v167, v249
  v_mul_f32 v168, v168, v250
  v_mul_f32 v169, v169, v250
  v_mul_f32 v170, v170, v250
  v_mul_f32 v171, v171, v250
  v_mul_f32 v172, v172, v251
  v_mul_f32 v173, v173, v251
  v_mul_f32 v174, v174, v251
  v_mul_f32 v175, v175, v251
  v_mul_f32 v176, v176, v253
  v_mul_f32 v177, v177, v253
  v_mul_f32 v178, v178, v253
  v_mul_f32 v179, v179, v253
  s_nop 1
  s_cmp_eq_u32 s25, 0
  s_cbranch_scc1 L_back_16
  s_cmp_eq_u32 s25, 1
  s_cbranch_scc1 L_back_18
  s_cmp_eq_u32 s25, 2
  s_cbranch_scc1 L_back_19
  s_cmp_eq_u32 s25, 3
  s_cbranch_scc1 L_back_20
  s_cmp_eq_u32 s25, 4
  s_cbranch_scc1 L_back_21
  s_branch L_back_22
L_slow_qk_A:
  s_waitcnt lgkmcnt(0)
  v_max3_f32 v228, v160, v161, v162
  v_max_f32 v228, v228, v163
  v_max3_f32 v229, v164, v165, v166
  v_max_f32 v229, v229, v167
  v_max3_f32 v230, v168, v169, v170
  v_max_f32 v230, v230, v171
  v_max3_f32 v231, v172, v173, v174
  v_max_f32 v231, v231, v175
  v_max3_f32 v232, v176, v177, v178
  v_max_f32 v232, v232, v179
  v_mov_b32 v234, v228
  v_mov_b32 v235, v229
  v_mov_b32 v236, v230
  v_mov_b32 v237, v231
  v_mov_b32 v238, v232
  s_nop 1
  v_permlane32_swap_b32 v228, v234
  v_permlane32_swap_b32 v229, v235
  v_permlane32_swap_b32 v230, v236
  v_permlane32_swap_b32 v231, v237
  v_permlane32_swap_b32 v232, v238
  s_nop 0
  v_max_f32 v228, v228, v234
  v_max_f32 v229, v229, v235
  v_max_f32 v230, v230, v236
  v_max_f32 v231, v231, v237
  v_max_f32 v232, v232, v238
  v_mov_b32 v234, v228
  v_mov_b32 v235, v229
  v_mov_b32 v236, v230
  v_mov_b32 v237, v231
  v_mov_b32 v238, v232
  s_nop 1
  v_permlane16_swap_b32 v228, v234
  v_permlane16_swap_b32 v229, v235
  v_permlane16_swap_b32 v230, v236
  v_permlane16_swap_b32 v231, v237
  v_permlane16_swap_b32 v232, v238
  s_nop 0
  v_max_f32 v228, v228, v234
  v_max_f32 v229, v229, v235
  v_max_f32 v230, v230, v236
  v_max_f32 v231, v231, v237
  v_max_f32 v232, v232, v238
  v_mbcnt_lo_u32_b32 v226, -1, 0
  v_mbcnt_hi_u32_b32 v226, -1, v226
  v_and_b32 v226, 15, v226
  v_lshlrev_b32 v226, 2, v226
  s_lshl_b32 s31, s17, 1
  s_add_u32 s21, s31, s18
  s_mul_i32 s21, s21, 320
  s_add_u32 s21, s21, 151616
  v_add_u32 v227, s21, v226
  ds_write_b32 v227, v228 offset:0
  ds_write_b32 v227, v229 offset:64
  ds_write_b32 v227, v230 offset:128
  ds_write_b32 v227, v231 offset:192
  ds_write_b32 v227, v232 offset:256
  s_waitcnt lgkmcnt(0)
  s_barrier
  s_xor_b32 s21, s18, 1
  s_add_u32 s21, s31, s21
  s_mul_i32 s21, s21, 320
  s_add_u32 s21, s21, 151616
  v_add_u32 v227, s21, v226
  ds_read_b32 v234, v227 offset:0
  ds_read_b32 v235, v227 offset:64
  ds_read_b32 v236, v227 offset:128
  ds_read_b32 v237, v227 offset:192
  ds_read_b32 v238, v227 offset:256
  s_mul_i32 s21, s17, 320
  s_add_u32 s21, s21, 152896
  v_add_u32 v227, s21, v226
  s_waitcnt lgkmcnt(0)
  v_max3_f32 v228, v228, v234, s26
  v_max3_f32 v229, v229, v235, s26
  v_max3_f32 v230, v230, v236, s26
  v_max3_f32 v231, v231, v237, s26
  v_max3_f32 v232, v232, v238, s26
  v_add_f32 v212, v212, v228
  v_sub_f32 v160, v160, v228
  v_sub_f32 v161, v161, v228
  v_sub_f32 v162, v162, v228
  v_sub_f32 v163, v163, v228
  v_max_f32 v234, 0, v228
  v_sub_f32 v234, 0, v234
  v_add_f32 v213, v213, v229
  v_sub_f32 v164, v164, v229
  v_sub_f32 v165, v165, v229
  v_sub_f32 v166, v166, v229
  v_sub_f32 v167, v167, v229
  v_max_f32 v235, 0, v229
  v_sub_f32 v235, 0, v235
  v_add_f32 v214, v214, v230
  v_sub_f32 v168, v168, v230
  v_sub_f32 v169, v169, v230
  v_sub_f32 v170, v170, v230
  v_sub_f32 v171, v171, v230
  v_max_f32 v236, 0, v230
  v_sub_f32 v236, 0, v236
  v_add_f32 v215, v215, v231
  v_sub_f32 v172, v172, v231
  v_sub_f32 v173, v173, v231
  v_sub_f32 v174, v174, v231
  v_sub_f32 v175, v175, v231
  v_max_f32 v237, 0, v231
  v_sub_f32 v237, 0, v237
  v_add_f32 v216, v216, v232
  v_sub_f32 v176, v176, v232
  v_sub_f32 v177, v177, v232
  v_sub_f32 v178, v178, v232
  v_sub_f32 v179, v179, v232
  v_max_f32 v238, 0, v232
  v_sub_f32 v238, 0, v238
  v_exp_f32 v234, v234
  v_exp_f32 v235, v235
  v_exp_f32 v236, v236
  v_exp_f32 v237, v237
  v_exp_f32 v238, v238
  s_nop 0
  ds_write_b32 v227, v234 offset:0
  ds_write_b32 v227, v235 offset:64
  ds_write_b32 v227, v236 offset:128
  ds_write_b32 v227, v237 offset:192
  ds_write_b32 v227, v238 offset:256
  s_mov_b32 s26, 0
  v_add_u32 v226, s24, v224
  s_waitcnt lgkmcnt(0)
  v_exp_f32 v230, v160
  v_exp_f32 v231, v161
  v_exp_f32 v232, v162
  v_exp_f32 v233, v163
  s_nop 0
  v_cvt_pk_bf16_f32 v234, v230, v231
  v_cvt_pk_bf16_f32 v235, v232, v233
  ds_write_b64 v226, v[234:235] offset:0
  v_exp_f32 v236, v164
  v_exp_f32 v237, v165
  v_exp_f32 v238, v166
  v_exp_f32 v239, v167
  s_nop 0
  v_cvt_pk_bf16_f32 v240, v236, v237
  v_cvt_pk_bf16_f32 v241, v238, v239
  ds_write_b64 v226, v[240:241] offset:1024
  v_exp_f32 v230, v168
  v_exp_f32 v231, v169
  v_exp_f32 v232, v170
  v_exp_f32 v233, v171
  s_nop 0
  v_cvt_pk_bf16_f32 v234, v230, v231
  v_cvt_pk_bf16_f32 v235, v232, v233
  ds_write_b64 v226, v[234:235] offset:2048
  v_exp_f32 v236, v172
  v_exp_f32 v237, v173
  v_exp_f32 v238, v174
  v_exp_f32 v239, v175
  s_nop 0
  v_cvt_pk_bf16_f32 v240, v236, v237
  v_cvt_pk_bf16_f32 v241, v238, v239
  ds_write_b64 v226, v[240:241] offset:3072
  v_exp_f32 v230, v176
  v_exp_f32 v231, v177
  v_exp_f32 v232, v178
  v_exp_f32 v233, v179
  s_nop 0
  v_cvt_pk_bf16_f32 v234, v230, v231
  v_cvt_pk_bf16_f32 v235, v232, v233
  ds_write_b64 v226, v[234:235] offset:4096
  s_waitcnt lgkmcnt(0)
  s_barrier
  s_cmp_eq_u32 s25, 0
  s_cbranch_scc1 L_back_12
  s_cmp_eq_u32 s25, 1
  s_cbranch_scc1 L_back_13
  s_cmp_eq_u32 s25, 2
  s_cbranch_scc1 L_back_14
  s_branch L_back_15
L_slow_pv_A:
  s_waitcnt lgkmcnt(0)
  s_barrier
  s_barrier
  v_mbcnt_lo_u32_b32 v252, -1, 0
  v_mbcnt_hi_u32_b32 v252, -1, v252
  v_and_b32 v252, 15, v252
  v_lshlrev_b32 v252, 2, v252
  s_mul_i32 s21, s17, 320
  s_add_u32 s21, s21, 152896
  v_add_u32 v252, s21, v252
  ds_read_b32 v248, v252 offset:0
  ds_read_b32 v249, v252 offset:64
  ds_read_b32 v250, v252 offset:128
  ds_read_b32 v251, v252 offset:192
  ds_read_b32 v253, v252 offset:256
  v_add_u32 v254, s24, v246
  ds_read_b128 v[212:215], v254 offset:0
  ds_read_b128 v[216:219], v254 offset:1024
  ds_read_b128 v[220:223], v254 offset:2048
  ds_read_b128 v[224:227], v254 offset:3072
  ds_read_b128 v[228:231], v254 offset:4096
  s_waitcnt lgkmcnt(0)
  v_mul_f32 v0, v0, v248
  v_mul_f32 v1, v1, v248
  v_mul_f32 v2, v2, v248
  v_mul_f32 v3, v3, v248
  v_mul_f32 v4, v4, v249
  v_mul_f32 v5, v5, v249
  v_mul_f32 v6, v6, v249
  v_mul_f32 v7, v7, v249
  v_mul_f32 v8, v8, v250
  v_mul_f32 v9, v9, v250
  v_mul_f32 v10, v10, v250
  v_mul_f32 v11, v11, v250
  v_mul_f32 v12, v12, v251
  v_mul_f32 v13, v13, v251
  v_mul_f32 v14, v14, v251
  v_mul_f32 v15, v15, v251
  v_mul_f32 v16, v16, v253
  v_mul_f32 v17, v17, v253
  v_mul_f32 v18, v18, v253
  v_mul_f32 v19, v19, v253
  v_mul_f32 v20, v20, v248
  v_mul_f32 v21, v21, v248
  v_mul_f32 v22, v22, v248
  v_mul_f32 v23, v23, v248
  v_mul_f32 v24, v24, v249
  v_mul_f32 v25, v25, v249
  v_mul_f32 v26, v26, v249
  v_mul_f32 v27, v27, v249
  v_mul_f32 v28, v28, v250
  v_mul_f32 v29, v29, v250
  v_mul_f32 v30, v30, v250
  v_mul_f32 v31, v31, v250
  v_mul_f32 v32, v32, v251
  v_mul_f32 v33, v33, v251
  v_mul_f32 v34, v34, v251
  v_mul_f32 v35, v35, v251
  v_mul_f32 v36, v36, v253
  v_mul_f32 v37, v37, v253
  v_mul_f32 v38, v38, v253
  v_mul_f32 v39, v39, v253
  v_mul_f32 v40, v40, v248
  v_mul_f32 v41, v41, v248
  v_mul_f32 v42, v42, v248
  v_mul_f32 v43, v43, v248
  v_mul_f32 v44, v44, v249
  v_mul_f32 v45, v45, v249
  v_mul_f32 v46, v46, v249
  v_mul_f32 v47, v47, v249
  v_mul_f32 v48, v48, v250
  v_mul_f32 v49, v49, v250
  v_mul_f32 v50, v50, v250
  v_mul_f32 v51, v51, v250
  v_mul_f32 v52, v52, v251
  v_mul_f32 v53, v53, v251
  v_mul_f32 v54, v54, v251
  v_mul_f32 v55, v55, v251
  v_mul_f32 v56, v56, v253
  v_mul_f32 v57, v57, v253
  v_mul_f32 v58, v58, v253
  v_mul_f32 v59, v59, v253
  v_mul_f32 v60, v60, v248
  v_mul_f32 v61, v61, v248
  v_mul_f32 v62, v62, v248
  v_mul_f32 v63, v63, v248
  v_mul_f32 v64, v64, v249
  v_mul_f32 v65, v65, v249
  v_mul_f32 v66, v66, v249
  v_mul_f32 v67, v67, v249
  v_mul_f32 v68, v68, v250
  v_mul_f32 v69, v69, v250
  v_mul_f32 v70, v70, v250
  v_mul_f32 v71, v71, v250
  v_mul_f32 v72, v72, v251
  v_mul_f32 v73, v73, v251
  v_mul_f32 v74, v74, v251
  v_mul_f32 v75, v75, v251
  v_mul_f32 v76, v76, v253
  v_mul_f32 v77, v77, v253
  v_mul_f32 v78, v78, v253
  v_mul_f32 v79, v79, v253
  v_mul_f32 v80, v80, v248
  v_mul_f32 v81, v81, v248
  v_mul_f32 v82, v82, v248
  v_mul_f32 v83, v83, v248
  v_mul_f32 v84, v84, v249
  v_mul_f32 v85, v85, v249
  v_mul_f32 v86, v86, v249
  v_mul_f32 v87, v87, v249
  v_mul_f32 v88, v88, v250
  v_mul_f32 v89, v89, v250
  v_mul_f32 v90, v90, v250
  v_mul_f32 v91, v91, v250
  v_mul_f32 v92, v92, v251
  v_mul_f32 v93, v93, v251
  v_mul_f32 v94, v94, v251
  v_mul_f32 v95, v95, v251
  v_mul_f32 v96, v96, v253
  v_mul_f32 v97, v97, v253
  v_mul_f32 v98, v98, v253
  v_mul_f32 v99, v99, v253
  v_mul_f32 v100, v100, v248
  v_mul_f32 v101, v101, v248
  v_mul_f32 v102, v102, v248
  v_mul_f32 v103, v103, v248
  v_mul_f32 v104, v104, v249
  v_mul_f32 v105, v105, v249
  v_mul_f32 v106, v106, v249
  v_mul_f32 v107, v107, v249
  v_mul_f32 v108, v108, v250
  v_mul_f32 v109, v109, v250
  v_mul_f32 v110, v110, v250
  v_mul_f32 v111, v111, v250
  v_mul_f32 v112, v112, v251
  v_mul_f32 v113, v113, v251
  v_mul_f32 v114, v114, v251
  v_mul_f32 v115, v115, v251
  v_mul_f32 v116, v116, v253
  v_mul_f32 v117, v117, v253
  v_mul_f32 v118, v118, v253
  v_mul_f32 v119, v119, v253
  v_mul_f32 v120, v120, v248
  v_mul_f32 v121, v121, v248
  v_mul_f32 v122, v122, v248
  v_mul_f32 v123, v123, v248
  v_mul_f32 v124, v124, v249
  v_mul_f32 v125, v125, v249
  v_mul_f32 v126, v126, v249
  v_mul_f32 v127, v127, v249
  v_mul_f32 v128, v128, v250
  v_mul_f32 v129, v129, v250
  v_mul_f32 v130, v130, v250
  v_mul_f32 v131, v131, v250
  v_mul_f32 v132, v132, v251
  v_mul_f32 v133, v133, v251
  v_mul_f32 v134, v134, v251
  v_mul_f32 v135, v135, v251
  v_mul_f32 v136, v136, v253
  v_mul_f32 v137, v137, v253
  v_mul_f32 v138, v138, v253
  v_mul_f32 v139, v139, v253
  v_mul_f32 v140, v140, v248
  v_mul_f32 v141, v141, v248
  v_mul_f32 v142, v142, v248
  v_mul_f32 v143, v143, v248
  v_mul_f32 v144, v144, v249
  v_mul_f32 v145, v145, v249
  v_mul_f32 v146, v146, v249
  v_mul_f32 v147, v147, v249
  v_mul_f32 v148, v148, v250
  v_mul_f32 v149, v149, v250
  v_mul_f32 v150, v150, v250
  v_mul_f32 v151, v151, v250
  v_mul_f32 v152, v152, v251
  v_mul_f32 v153, v153, v251
  v_mul_f32 v154, v154, v251
  v_mul_f32 v155, v155, v251
  v_mul_f32 v156, v156, v253
  v_mul_f32 v157, v157, v253
  v_mul_f32 v158, v158, v253
  v_mul_f32 v159, v159, v253
  v_mul_f32 v160, v160, v248
  v_mul_f32 v161, v161, v248
  v_mul_f32 v162, v162, v248
  v_mul_f32 v163, v163, v248
  v_mul_f32 v164, v164, v249
  v_mul_f32 v165, v165, v249
  v_mul_f32 v166, v166, v249
  v_mul_f32 v167, v167, v249
  v_mul_f32 v168, v168, v250
  v_mul_f32 v169, v169, v250
  v_mul_f32 v170, v170, v250
  v_mul_f32 v171, v171, v250
  v_mul_f32 v172, v172, v251
  v_mul_f32 v173, v173, v251
  v_mul_f32 v174, v174, v251
  v_mul_f32 v175, v175, v251
  v_mul_f32 v176, v176, v253
  v_mul_f32 v177, v177, v253
  v_mul_f32 v178, v178, v253
  v_mul_f32 v179, v179, v253
  s_nop 1
  s_cmp_eq_u32 s25, 0
  s_cbranch_scc1 L_back_23
  s_cmp_eq_u32 s25, 1
  s_cbranch_scc1 L_back_25
  s_cmp_eq_u32 s25, 2
  s_cbranch_scc1 L_back_26
  s_branch L_back_27
L_attn_kernel_codeend:
.globl reduce_proj_kernel
.p2align 8
.type reduce_proj_kernel,@function
reduce_proj_kernel:
  s_cmp_ge_u32 s2, 1280
  s_cbranch_scc1 L_reduce_proj_kernel_done
  s_load_dwordx2 s[8:9], s[0:1], 80
  s_load_dwordx2 s[4:5], s[0:1], 96
  v_readfirstlane_b32 s16, v0
  v_and_b32 v1, 63, v0
  s_lshr_b32 s16, s16, 6
  s_mul_i32 s17, s2, 2
  s_add_u32 s17, s17, s16
  v_and_b32 v3, 15, v1
  v_lshrrev_b32 v4, 4, v1
  v_mul_u32_u24 v3, 1792, v3
  s_cmp_ge_u32 s17, 1920
  s_cbranch_scc1 L_reduce_proj_kernel_single
  s_mul_i32 s18, s17, 2185
  s_lshr_b32 s18, s18, 17
  s_mul_i32 s19, s18, 60
  s_sub_u32 s19, s17, s19
  s_mul_i32 s24, s19, 69
  s_lshr_b32 s24, s24, 10
  s_mul_i32 s21, s24, 15
  s_sub_u32 s19, s19, s21
  s_mul_i32 s25, s19, 43
  s_lshr_b32 s25, s25, 7
  s_mul_i32 s21, s25, 3
  s_sub_u32 s19, s19, s21
  s_lshl_b32 s23, s19, 10
  s_lshl_b32 s22, s19, 6
  s_mul_i32 s20, s18, 573440
  s_mul_i32 s21, s24, 17920
  s_add_u32 s20, s20, s21
  s_mul_i32 s21, s25, 3584
  s_add_u32 s20, s20, s21
  s_add_u32 s20, s20, s23
  s_add_u32 s20, s20, 0x3000000
  s_and_b32 s26, s18, 15
  s_lshr_b32 s27, s18, 4
  s_mul_i32 s26, s26, 80
  s_lshl_b32 s28, s25, 4
  s_add_u32 s26, s26, s28
  s_mul_i32 s26, s26, 1792
  s_mul_i32 s27, s27, 896
  s_add_u32 s26, s26, s27
  s_mul_i32 s28, s24, 224
  s_add_u32 s26, s26, s28
  s_add_u32 s26, s26, s22
  s_waitcnt lgkmcnt(0)
  s_mov_b32 s6, 0x20000000
  s_mov_b32 s7, 0x20000
  s_mov_b32 s10, 2293760
  s_mov_b32 s11, 0x20000
  v_lshlrev_b32 v2, 4, v1
  v_lshl_add_u32 v3, v4, 4, v3
  buffer_load_dwordx4 v[8:11], v2, s[4:7], s20 offen nt
  s_add_u32 s20, s20, 71680
  buffer_load_dwordx4 v[12:15], v2, s[4:7], s20 offen nt
  s_add_u32 s20, s20, 71680
  buffer_load_dwordx4 v[16:19], v2, s[4:7], s20 offen nt
  s_add_u32 s20, s20, 71680
  buffer_load_dwordx4 v[20:23], v2, s[4:7], s20 offen nt
  s_add_u32 s20, s20, 71680
  buffer_load_dwordx4 v[24:27], v2, s[4:7], s20 offen nt
  s_add_u32 s20, s20, 71680
  buffer_load_dwordx4 v[28:31], v2, s[4:7], s20 offen nt
  s_add_u32 s20, s20, 71680
  buffer_load_dwordx4 v[32:35], v2, s[4:7], s20 offen nt
  s_add_u32 s20, s20, 71680
  buffer_load_dwordx4 v[36:39], v2, s[4:7], s20 offen nt
  s_waitcnt vmcnt(7)
  v_lshlrev_b32 v48, 16, v8
  v_and_b32 v49, 0xffff0000, v8
  v_lshlrev_b32 v50, 16, v9
  v_and_b32 v51, 0xffff0000, v9
  v_lshlrev_b32 v52, 16, v10
  v_and_b32 v53, 0xffff0000, v10
  v_lshlrev_b32 v54, 16, v11
  v_and_b32 v55, 0xffff0000, v11
  s_waitcnt vmcnt(6)
  v_lshlrev_b32 v56, 16, v12
  v_and_b32 v57, 0xffff0000, v12
  v_add_f32 v48, v48, v56
  v_add_f32 v49, v49, v57
  v_lshlrev_b32 v56, 16, v13
  v_and_b32 v57, 0xffff0000, v13
  v_add_f32 v50, v50, v56
  v_add_f32 v51, v51, v57
  v_lshlrev_b32 v56, 16, v14
  v_and_b32 v57, 0xffff0000, v14
  v_add_f32 v52, v52, v56
  v_add_f32 v53, v53, v57
  v_lshlrev_b32 v56, 16, v15
  v_and_b32 v57, 0xffff0000, v15
  v_add_f32 v54, v54, v56
  v_add_f32 v55, v55, v57
  s_waitcnt vmcnt(5)
  v_lshlrev_b32 v56, 16, v16
  v_and_b32 v57, 0xffff0000, v16
  v_add_f32 v48, v48, v56
  v_add_f32 v49, v49, v57
  v_lshlrev_b32 v56, 16, v17
  v_and_b32 v57, 0xffff0000, v17
  v_add_f32 v50, v50, v56
  v_add_f32 v51, v51, v57
  v_lshlrev_b32 v56, 16, v18
  v_and_b32 v57, 0xffff0000, v18
  v_add_f32 v52, v52, v56
  v_add_f32 v53, v53, v57
  v_lshlrev_b32 v56, 16, v19
  v_and_b32 v57, 0xffff0000, v19
  v_add_f32 v54, v54, v56
  v_add_f32 v55, v55, v57
  s_waitcnt vmcnt(4)
  v_lshlrev_b32 v56, 16, v20
  v_and_b32 v57, 0xffff0000, v20
  v_add_f32 v48, v48, v56
  v_add_f32 v49, v49, v57
  v_lshlrev_b32 v56, 16, v21
  v_and_b32 v57, 0xffff0000, v21
  v_add_f32 v50, v50, v56
  v_add_f32 v51, v51, v57
  v_lshlrev_b32 v56, 16, v22
  v_and_b32 v57, 0xffff0000, v22
  v_add_f32 v52, v52, v56
  v_add_f32 v53, v53, v57
  v_lshlrev_b32 v56, 16, v23
  v_and_b32 v57, 0xffff0000, v23
  v_add_f32 v54, v54, v56
  v_add_f32 v55, v55, v57
  s_waitcnt vmcnt(3)
  v_lshlrev_b32 v56, 16, v24
  v_and_b32 v57, 0xffff0000, v24
  v_add_f32 v48, v48, v56
  v_add_f32 v49, v49, v57
  v_lshlrev_b32 v56, 16, v25
  v_and_b32 v57, 0xffff0000, v25
  v_add_f32 v50, v50, v56
  v_add_f32 v51, v51, v57
  v_lshlrev_b32 v56, 16, v26
  v_and_b32 v57, 0xffff0000, v26
  v_add_f32 v52, v52, v56
  v_add_f32 v53, v53, v57
  v_lshlrev_b32 v56, 16, v27
  v_and_b32 v57, 0xffff0000, v27
  v_add_f32 v54, v54, v56
  v_add_f32 v55, v55, v57
  s_waitcnt vmcnt(2)
  v_lshlrev_b32 v56, 16, v28
  v_and_b32 v57, 0xffff0000, v28
  v_add_f32 v48, v48, v56
  v_add_f32 v49, v49, v57
  v_lshlrev_b32 v56, 16, v29
  v_and_b32 v57, 0xffff0000, v29
  v_add_f32 v50, v50, v56
  v_add_f32 v51, v51, v57
  v_lshlrev_b32 v56, 16, v30
  v_and_b32 v57, 0xffff0000, v30
  v_add_f32 v52, v52, v56
  v_add_f32 v53, v53, v57
  v_lshlrev_b32 v56, 16, v31
  v_and_b32 v57, 0xffff0000, v31
  v_add_f32 v54, v54, v56
  v_add_f32 v55, v55, v57
  s_waitcnt vmcnt(1)
  v_lshlrev_b32 v56, 16, v32
  v_and_b32 v57, 0xffff0000, v32
  v_add_f32 v48, v48, v56
  v_add_f32 v49, v49, v57
  v_lshlrev_b32 v56, 16, v33
  v_and_b32 v57, 0xffff0000, v33
  v_add_f32 v50, v50, v56
  v_add_f32 v51, v51, v57
  v_lshlrev_b32 v56, 16, v34
  v_and_b32 v57, 0xffff0000, v34
  v_add_f32 v52, v52, v56
  v_add_f32 v53, v53, v57
  v_lshlrev_b32 v56, 16, v35
  v_and_b32 v57, 0xffff0000, v35
  v_add_f32 v54, v54, v56
  v_add_f32 v55, v55, v57
  s_waitcnt vmcnt(0)
  v_lshlrev_b32 v56, 16, v36
  v_and_b32 v57, 0xffff0000, v36
  v_add_f32 v48, v48, v56
  v_add_f32 v49, v49, v57
  v_lshlrev_b32 v56, 16, v37
  v_and_b32 v57, 0xffff0000, v37
  v_add_f32 v50, v50, v56
  v_add_f32 v51, v51, v57
  v_lshlrev_b32 v56, 16, v38
  v_and_b32 v57, 0xffff0000, v38
  v_add_f32 v52, v52, v56
  v_add_f32 v53, v53, v57
  v_lshlrev_b32 v56, 16, v39
  v_and_b32 v57, 0xffff0000, v39
  v_add_f32 v54, v54, v56
  v_add_f32 v55, v55, v57
  v_cvt_pk_bf16_f32 v60, v48, v49
  v_cvt_pk_bf16_f32 v61, v50, v51
  v_cvt_pk_bf16_f32 v62, v52, v53
  v_cvt_pk_bf16_f32 v63, v54, v55
  s_nop 1
  v_permlane32_swap_b32 v60, v62
  v_permlane32_swap_b32 v61, v63
  s_nop 1
  v_permlane16_swap_b32 v60, v62
  v_permlane16_swap_b32 v61, v63
  s_nop 1
  buffer_store_dwordx4 v[60:63], v3, s[8:11], s26 offen
  s_branch L_reduce_proj_kernel_done
L_reduce_proj_kernel_single:
  s_sub_u32 s17, s17, 1920
  s_mul_i32 s18, s17, 3277
  s_lshr_b32 s18, s18, 16
  s_mul_i32 s19, s18, 20
  s_sub_u32 s19, s17, s19
  s_mul_i32 s24, s19, 52
  s_lshr_b32 s24, s24, 8
  s_mul_i32 s21, s24, 5
  s_sub_u32 s25, s19, s21
  s_mov_b32 s23, 3072
  s_mov_b32 s22, 192
  s_mul_i32 s20, s18, 573440
  s_mul_i32 s21, s24, 17920
  s_add_u32 s20, s20, s21
  s_mul_i32 s21, s25, 3584
  s_add_u32 s20, s20, s21
  s_add_u32 s20, s20, s23
  s_add_u32 s20, s20, 0x3000000
  s_and_b32 s26, s18, 15
  s_lshr_b32 s27, s18, 4
  s_mul_i32 s26, s26, 80
  s_lshl_b32 s28, s25, 4
  s_add_u32 s26, s26, s28
  s_mul_i32 s26, s26, 1792
  s_mul_i32 s27, s27, 896
  s_add_u32 s26, s26, s27
  s_mul_i32 s28, s24, 224
  s_add_u32 s26, s26, s28
  s_add_u32 s26, s26, s22
  s_waitcnt lgkmcnt(0)
  s_mov_b32 s6, 0x20000000
  s_mov_b32 s7, 0x20000
  s_mov_b32 s10, 2293760
  s_mov_b32 s11, 0x20000
  v_lshlrev_b32 v2, 3, v1
  v_lshl_add_u32 v3, v4, 3, v3
  buffer_load_dwordx2 v[8:9], v2, s[4:7], s20 offen nt
  s_add_u32 s20, s20, 71680
  buffer_load_dwordx2 v[12:13], v2, s[4:7], s20 offen nt
  s_add_u32 s20, s20, 71680
  buffer_load_dwordx2 v[16:17], v2, s[4:7], s20 offen nt
  s_add_u32 s20, s20, 71680
  buffer_load_dwordx2 v[20:21], v2, s[4:7], s20 offen nt
  s_add_u32 s20, s20, 71680
  buffer_load_dwordx2 v[24:25], v2, s[4:7], s20 offen nt
  s_add_u32 s20, s20, 71680
  buffer_load_dwordx2 v[28:29], v2, s[4:7], s20 offen nt
  s_add_u32 s20, s20, 71680
  buffer_load_dwordx2 v[32:33], v2, s[4:7], s20 offen nt
  s_add_u32 s20, s20, 71680
  buffer_load_dwordx2 v[36:37], v2, s[4:7], s20 offen nt
  s_waitcnt vmcnt(7)
  v_lshlrev_b32 v48, 16, v8
  v_and_b32 v49, 0xffff0000, v8
  v_lshlrev_b32 v50, 16, v9
  v_and_b32 v51, 0xffff0000, v9
  s_waitcnt vmcnt(6)
  v_lshlrev_b32 v56, 16, v12
  v_and_b32 v57, 0xffff0000, v12
  v_add_f32 v48, v48, v56
  v_add_f32 v49, v49, v57
  v_lshlrev_b32 v56, 16, v13
  v_and_b32 v57, 0xffff0000, v13
  v_add_f32 v50, v50, v56
  v_add_f32 v51, v51, v57
  s_waitcnt vmcnt(5)
  v_lshlrev_b32 v56, 16, v16
  v_and_b32 v57, 0xffff0000, v16
  v_add_f32 v48, v48, v56
  v_add_f32 v49, v49, v57
  v_lshlrev_b32 v56, 16, v17
  v_and_b32 v57, 0xffff0000, v17
  v_add_f32 v50, v50, v56
  v_add_f32 v51, v51, v57
  s_waitcnt vmcnt(4)
  v_lshlrev_b32 v56, 16, v20
  v_and_b32 v57, 0xffff0000, v20
  v_add_f32 v48, v48, v56
  v_add_f32 v49, v49, v57
  v_lshlrev_b32 v56, 16, v21
  v_and_b32 v57, 0xffff0000, v21
  v_add_f32 v50, v50, v56
  v_add_f32 v51, v51, v57
  s_waitcnt vmcnt(3)
  v_lshlrev_b32 v56, 16, v24
  v_and_b32 v57, 0xffff0000, v24
  v_add_f32 v48, v48, v56
  v_add_f32 v49, v49, v57
  v_lshlrev_b32 v56, 16, v25
  v_and_b32 v57, 0xffff0000, v25
  v_add_f32 v50, v50, v56
  v_add_f32 v51, v51, v57
  s_waitcnt vmcnt(2)
  v_lshlrev_b32 v56, 16, v28
  v_and_b32 v57, 0xffff0000, v28
  v_add_f32 v48, v48, v56
  v_add_f32 v49, v49, v57
  v_lshlrev_b32 v56, 16, v29
  v_and_b32 v57, 0xffff0000, v29
  v_add_f32 v50, v50, v56
  v_add_f32 v51, v51, v57
  s_waitcnt vmcnt(1)
  v_lshlrev_b32 v56, 16, v32
  v_and_b32 v57, 0xffff0000, v32
  v_add_f32 v48, v48, v56
  v_add_f32 v49, v49, v57
  v_lshlrev_b32 v56, 16, v33
  v_and_b32 v57, 0xffff0000, v33
  v_add_f32 v50, v50, v56
  v_add_f32 v51, v51, v57
  s_waitcnt vmcnt(0)
  v_lshlrev_b32 v56, 16, v36
  v_and_b32 v57, 0xffff0000, v36
  v_add_f32 v48, v48, v56
  v_add_f32 v49, v49, v57
  v_lshlrev_b32 v56, 16, v37
  v_and_b32 v57, 0xffff0000, v37
  v_add_f32 v50, v50, v56
  v_add_f32 v51, v51, v57
  v_cvt_pk_bf16_f32 v60, v48, v49
  v_cvt_pk_bf16_f32 v61, v50, v51
  s_nop 0
  buffer_store_dwordx2 v[60:61], v3, s[8:11], s26 offen
L_reduce_proj_kernel_done:
  s_endpgm
.section .rodata,"a"
.p2align 6
.amdhsa_kernel reduce_proj_kernel
  .amdhsa_next_free_vgpr 64
  .amdhsa_next_free_sgpr 40
  .amdhsa_accum_offset 64
  .amdhsa_group_segment_fixed_size 0
  .amdhsa_kernarg_size 104
  .amdhsa_user_sgpr_count 2
  .amdhsa_user_sgpr_kernarg_segment_ptr 1
  .amdhsa_system_sgpr_workgroup_id_x 1
.end_amdhsa_kernel
.p2align 6
.amdhsa_kernel attn_kernel
  .amdhsa_next_free_vgpr 256
  .amdhsa_next_free_sgpr 102
  .amdhsa_accum_offset 256
  .amdhsa_group_segment_fixed_size 0
  .amdhsa_kernarg_size 104
  .amdhsa_user_sgpr_count 2
  .amdhsa_user_sgpr_kernarg_segment_ptr 1
  .amdhsa_system_sgpr_workgroup_id_x 1
.end_amdhsa_kernel
```
